```python
import torch

def _softmax(x, axis=-1):
    return torch.softmax(x, dim=axis)

def _gelu(x):
    return torch.nn.functional.gelu(x, approximate='tanh')

def _silu(x):
    return torch.nn.functional.silu(x)

def _sigmoid(x):
    return torch.sigmoid(x)

def _layernorm(x, axis=-1, eps=1e-05):
    m = x.mean(dim=axis, keepdim=True)
    v = x.var(dim=axis, keepdim=True, unbiased=False)
    return (x - m) / torch.sqrt(v + eps)

def _scatter_add(tgt, idx, src, axis=0):
    return tgt.clone().index_add_(axis, idx, src)

def _segment_sum(src, seg, n):
    out = torch.zeros((n,) + src.shape[1:], dtype=src.dtype)
    return out.index_add_(0, seg, src)

def _pad(x, pw):
    flat = tuple((v for pair in reversed(pw) for v in pair))
    return torch.nn.functional.pad(x, flat)
kernel_name = 'gather_scatter__tensor_product_equiv_equiformer__graph'

def setup_inputs():

    _w = lambda a: (lambda t: t.to(torch.bfloat16) if t.is_floating_point() else t)(torch.as_tensor(a))
    N, deg, C, De = (25000, 32, 64, max(0, 1))
    E = N * deg
    src = (lambda lo, hi, *s: torch.randint(lo, hi, s))(0, N, E).to(torch.int64)
    dst = (lambda lo, hi, *s: torch.randint(lo, hi, s))(0, N, E).to(torch.int64)
    rvec = (lambda *s: torch.randn(*s, dtype=torch.bfloat16) * 0.05)(E, 3).to(float)
    rn = (torch.linalg.norm(rvec, dim=-1, keepdim=True) + 1e-06).to(float)
    rhat = (rvec / rn).to(float)
    eps = torch.zeros((3, 3, 3), dtype=float)
    eps[0, 1, 2] = eps[1, 2, 0] = eps[2, 0, 1] = 1.0
    eps[0, 2, 1] = eps[2, 1, 0] = eps[1, 0, 2] = -1.0
    return {'x': _w((lambda *s: torch.randn(*s, dtype=torch.bfloat16) * 0.4)(N, 4 * C).to(float)), 'rhat': _w(rhat), 'e_attr': _w((lambda *s: torch.randn(*s, dtype=torch.bfloat16) * 0.4)(E, De).to(float)), 'src': _w(src), 'dst': _w(dst), 'w_rad': _w((lambda *s: torch.randn(*s, dtype=torch.bfloat16) * 0.4)(De, 5 * C).to(float)), 'w_si0': _w((lambda *s: torch.randn(*s, dtype=torch.bfloat16) * 0.4)(2 * C, C).to(float)), 'w_si1': _w((lambda *s: torch.randn(*s, dtype=torch.bfloat16) * 0.05)(3 * C, C).to(float)), 'cg_eps': _w(eps)}

def reference(x, rhat, e_attr, src, dst, w_rad, w_si0, w_si1, cg_eps):
    N = x.shape[0]
    C = w_si0.shape[1]
    E = rhat.shape[0]
    x0 = x[:, :C].clone()
    x1 = x[:, C:].reshape(N, 3, C)
    R = (e_attr @ w_rad).reshape(E, 5, C)
    f0 = x0[src]
    f1 = x1[src]
    Y1 = rhat
    p00_0 = f0 * R[:, 0, :]
    p11_0 = torch.einsum('ejc,ej->ec', f1, Y1) * R[:, 1, :]
    p01_1 = torch.einsum('ec,ej->ejc', f0, Y1) * R[:, 2, :][:, None, :]
    p10_1 = f1 * R[:, 3, :][:, None, :]
    p11_1 = torch.einsum('ijk,ekc,ej->eic', cg_eps, f1, Y1) * R[:, 4, :][:, None, :]
    m0 = torch.concatenate([p00_0, p11_0], axis=-1) @ w_si0
    m1 = torch.einsum('ejp,pc->ejc', torch.concatenate([p01_1, p10_1, p11_1], axis=-1), w_si1)
    agg0 = _segment_sum(m0, dst, N)
    agg1 = _segment_sum(m1.reshape(E, 3 * C), dst, N).reshape(N, 3, C)
    gate = _sigmoid(agg0)
    out1 = agg1 * gate[:, None, :]
    return torch.concatenate([agg0, out1.reshape(N, 3 * C)], axis=-1)
```

```asm
; @launch grid=(256,1,1) block=(256,1,1) lds=163520
.amdgcn_target "amdgcn-amd-amdhsa--gfx950"
.text
.globl gather_scatter__tensor_product_equiv_equiformer__graph_kernel
.p2align 8
.type gather_scatter__tensor_product_equiv_equiformer__graph_kernel,@function
gather_scatter__tensor_product_equiv_equiformer__graph_kernel:
    s_cmp_ge_u32 s2, 256
    s_cbranch_scc1 K2_end
    s_and_b32 s27, s2, 7
    s_lshl_b32 s27, s27, 5
    s_lshr_b32 s43, s2, 3
    s_or_b32 s27, s27, s43
    s_load_dwordx2 s[16:17], s[0:1], 88
    s_load_dwordx4 s[4:7], s[0:1], 8
    s_load_dwordx4 s[8:11], s[0:1], 24
    s_load_dwordx2 s[28:29], s[0:1], 0
    v_lshrrev_b32 v4, 6, v0
    v_lshlrev_b32 v1, 2, v0
    v_readfirstlane_b32 s18, v4
    v_mov_b32 v5, 0
    s_mul_i32 s15, s2, 12800
    s_mul_i32 s14, s2, 6400
    s_mul_i32 s13, s2, 19200
    v_lshl_add_u32 v2, v0, 4, s15
    v_lshl_add_u32 v3, v0, 3, s14
    v_mul_u32_u24 v6, 24, v0
    v_add_u32_e64 v6, s13, v6
    ds_write_b32 v1, v5 offset:38400
    s_cmp_ge_u32 s2, 250
    s_waitcnt lgkmcnt(0)
    s_cbranch_scc1 F_helper
    global_load_dwordx4 v[16:19], v2, s[10:11]
    v_add_u32 v201, 4096, v2
    v_add_u32 v205, 2048, v3
    v_add_u32 v209, 6144, v6
    global_load_dwordx4 v[56:59], v201, s[10:11]
    v_add_u32 v202, 8192, v2
    v_add_u32 v206, 4096, v3
    v_add_u32 v210, 12288, v6
    global_load_dwordx4 v[96:99], v202, s[10:11]
    s_cmp_lg_u32 s18, 0
    s_cbranch_scc1 F_ld_1
    s_mov_b32 exec_hi, 0
    v_add_u32 v203, 12288, v2
    v_add_u32 v207, 6144, v3
    v_add_u32 v211, 18432, v6
    global_load_dwordx4 v[136:139], v203, s[10:11]
    global_load_dwordx4 v[140:143], v203, s[8:9]
    global_load_dwordx2 v[144:145], v207, s[6:7]
    global_load_dwordx4 v[146:149], v211, s[4:5]
    global_load_dwordx2 v[150:151], v211, s[4:5] offset:16
    s_mov_b32 exec_hi, -1
F_ld_1:
    global_load_dwordx4 v[20:23], v2, s[8:9]
    global_load_dwordx2 v[24:25], v3, s[6:7]
    global_load_dwordx4 v[26:29], v6, s[4:5]
    global_load_dwordx2 v[30:31], v6, s[4:5] offset:16
    global_load_dwordx4 v[60:63], v201, s[8:9]
    global_load_dwordx2 v[64:65], v205, s[6:7]
    global_load_dwordx4 v[66:69], v209, s[4:5]
    global_load_dwordx2 v[70:71], v209, s[4:5] offset:16
    global_load_dwordx4 v[100:103], v202, s[8:9]
    global_load_dwordx2 v[104:105], v206, s[6:7]
    global_load_dwordx4 v[106:109], v210, s[4:5]
    global_load_dwordx2 v[110:111], v210, s[4:5] offset:16
    v_mov_b32 v176, 0
    v_mov_b32 v177, 0
    v_mov_b32 v178, 0
    v_mov_b32 v179, 0
    v_lshlrev_b32 v184, 4, v0
    v_and_b32 v185, 48, v184
    v_add_u32 v185, 122368, v185
    ds_write_b128 v185, v[176:179]
    v_add_u32 v184, 65536, v184
    v_mov_b32 v180, 0xffff0000
    v_mov_b32 v181, 0xffff0000
    v_mov_b32 v182, 0xffff0000
    v_mov_b32 v183, 0xffff0000
    ds_write_b128 v184, v[180:183] offset:0
    ds_write_b128 v184, v[180:183] offset:4096
    ds_write_b128 v184, v[180:183] offset:8192
    ds_write_b128 v184, v[180:183] offset:12288
    ds_write_b128 v184, v[180:183] offset:16384
    s_mov_b32 s20, 42800
    s_mov_b32 s21, -98
    s_mov_b32 s22, 0xf803
    v_mov_b32 v5, 12
    s_waitcnt lgkmcnt(0)
    s_barrier
    s_load_dword s3, s[16:17], 656384
    s_waitcnt vmcnt(14)
    v_mul_u32_u24 v4, s20, v16
    v_lshrrev_b32 v4, 22, v4
    v_mad_i32_i24 v52, v4, s21, v16
    v_lshlrev_b32 v32, 2, v4
    ds_add_rtn_u32 v36, v32, v5 offset:38400
    v_mul_u32_u24 v4, s20, v17
    v_lshrrev_b32 v4, 22, v4
    v_mad_i32_i24 v53, v4, s21, v17
    v_lshlrev_b32 v33, 2, v4
    ds_add_rtn_u32 v37, v33, v5 offset:38400
    v_mul_u32_u24 v4, s20, v18
    v_lshrrev_b32 v4, 22, v4
    v_mad_i32_i24 v54, v4, s21, v18
    v_lshlrev_b32 v34, 2, v4
    ds_add_rtn_u32 v38, v34, v5 offset:38400
    v_mul_u32_u24 v4, s20, v19
    v_lshrrev_b32 v4, 22, v4
    v_mad_i32_i24 v55, v4, s21, v19
    v_lshlrev_b32 v35, 2, v4
    ds_add_rtn_u32 v39, v35, v5 offset:38400
    s_waitcnt vmcnt(13)
    v_mul_u32_u24 v4, s20, v56
    v_lshrrev_b32 v4, 22, v4
    v_mad_i32_i24 v92, v4, s21, v56
    v_lshlrev_b32 v72, 2, v4
    ds_add_rtn_u32 v76, v72, v5 offset:38400
    v_mul_u32_u24 v4, s20, v57
    v_lshrrev_b32 v4, 22, v4
    v_mad_i32_i24 v93, v4, s21, v57
    v_lshlrev_b32 v73, 2, v4
    ds_add_rtn_u32 v77, v73, v5 offset:38400
    v_mul_u32_u24 v4, s20, v58
    v_lshrrev_b32 v4, 22, v4
    v_mad_i32_i24 v94, v4, s21, v58
    v_lshlrev_b32 v74, 2, v4
    ds_add_rtn_u32 v78, v74, v5 offset:38400
    v_mul_u32_u24 v4, s20, v59
    v_lshrrev_b32 v4, 22, v4
    v_mad_i32_i24 v95, v4, s21, v59
    v_lshlrev_b32 v75, 2, v4
    ds_add_rtn_u32 v79, v75, v5 offset:38400
    s_waitcnt vmcnt(12)
    v_mul_u32_u24 v4, s20, v96
    v_lshrrev_b32 v4, 22, v4
    v_mad_i32_i24 v132, v4, s21, v96
    v_lshlrev_b32 v112, 2, v4
    ds_add_rtn_u32 v116, v112, v5 offset:38400
    v_mul_u32_u24 v4, s20, v97
    v_lshrrev_b32 v4, 22, v4
    v_mad_i32_i24 v133, v4, s21, v97
    v_lshlrev_b32 v113, 2, v4
    ds_add_rtn_u32 v117, v113, v5 offset:38400
    v_mul_u32_u24 v4, s20, v98
    v_lshrrev_b32 v4, 22, v4
    v_mad_i32_i24 v134, v4, s21, v98
    v_lshlrev_b32 v114, 2, v4
    ds_add_rtn_u32 v118, v114, v5 offset:38400
    v_mul_u32_u24 v4, s20, v99
    v_lshrrev_b32_e64 v4, 22, v4
    v_mad_i32_i24 v135, v4, s21, v99
    v_lshlrev_b32 v115, 2, v4
    ds_add_rtn_u32 v119, v115, v5 offset:38400
    s_cmp_lg_u32 s18, 0
    s_cbranch_scc1 F_bin_2
    s_mov_b32 exec_hi, 0
    s_waitcnt vmcnt(16)
    v_mul_u32_u24 v4, s20, v136
    v_lshrrev_b32 v4, 22, v4
    v_mad_i32_i24 v172, v4, s21, v136
    v_lshlrev_b32 v152, 2, v4
    ds_add_rtn_u32 v156, v152, v5 offset:38400
    v_mul_u32_u24 v4, s20, v137
    v_lshrrev_b32 v4, 22, v4
    v_mad_i32_i24 v173, v4, s21, v137
    v_lshlrev_b32 v153, 2, v4
    ds_add_rtn_u32 v157, v153, v5 offset:38400
    v_mul_u32_u24 v4, s20, v138
    v_lshrrev_b32 v4, 22, v4
    v_mad_i32_i24 v174, v4, s21, v138
    v_lshlrev_b32 v154, 2, v4
    ds_add_rtn_u32 v158, v154, v5 offset:38400
    v_mul_u32_u24 v4, s20, v139
    v_lshrrev_b32 v4, 22, v4
    v_mad_i32_i24 v175, v4, s21, v139
    v_lshlrev_b32 v155, 2, v4
    ds_add_rtn_u32 v159, v155, v5 offset:38400
    s_mov_b32 exec_hi, -1
F_bin_2:
    s_waitcnt lgkmcnt(0)
    s_mul_i32 s3, s3, 0x9e3779b1
    s_add_u32 s3, s3, 0x7f4a7c15
    s_barrier
    v_and_b32 v4, 63, v0
    v_lshlrev_b32 v4, 4, v4
    ds_read_b128 v[176:179], v4 offset:38400
    ds_read_b32 v189, v1 offset:38400
    s_waitcnt lgkmcnt(1)
    v_add_u32 v180, v176, v177
    v_add_u32 v181, v180, v178
    v_add_u32 v182, v181, v179
    v_mov_b32 v183, v182
    s_nop 1
    v_add_u32_dpp v183, v183, v183 row_shr:1 row_mask:0xf bank_mask:0xf bound_ctrl:0
    s_nop 1
    v_add_u32_dpp v183, v183, v183 row_shr:2 row_mask:0xf bank_mask:0xf bound_ctrl:0
    s_nop 1
    v_add_u32_dpp v183, v183, v183 row_shr:4 row_mask:0xf bank_mask:0xf bound_ctrl:0
    s_nop 1
    v_add_u32_dpp v183, v183, v183 row_shr:8 row_mask:0xf bank_mask:0xf bound_ctrl:0
    s_nop 1
    v_add_u32_dpp v183, v183, v183 row_bcast:15 row_mask:0xa bank_mask:0xf
    s_nop 1
    v_add_u32_dpp v183, v183, v183 row_bcast:31 row_mask:0xc bank_mask:0xf
    v_sub_u32 v184, v183, v182
    v_add_u32 v185, v184, v176
    v_add_u32 v186, v184, v180
    v_add_u32_e64 v187, v184, v181
    ds_write_b128 v4, v[184:187] offset:39424
    ds_read_b32 v188, v1 offset:39424
    s_cmp_lg_u32 s18, 0
    s_cbranch_scc1 F_lk_3
    s_mov_b32 exec_hi, 0
    ds_read_b32 v136, v152 offset:39424
    ds_read_b32 v137, v153 offset:39424
    ds_read_b32 v138, v154 offset:39424
    ds_read_b32 v139, v155 offset:39424
    s_mov_b32 exec_hi, -1
F_lk_3:
    ds_read_b32 v16, v32 offset:39424
    ds_read_b32 v17, v33 offset:39424
    ds_read_b32 v18, v34 offset:39424
    ds_read_b32 v19, v35 offset:39424
    ds_read_b32 v56, v72 offset:39424
    ds_read_b32 v57, v73 offset:39424
    ds_read_b32 v58, v74 offset:39424
    ds_read_b32 v59, v75 offset:39424
    ds_read_b32 v96, v112 offset:39424
    ds_read_b32 v97, v113 offset:39424
    ds_read_b32 v98, v114 offset:39424
    ds_read_b32 v99, v115 offset:39424
    s_cmp_lg_u32 s18, 0
    s_cbranch_scc1 F_key_4
    s_mov_b32 exec_hi, 0
    s_waitcnt vmcnt(12)
    v_lshl_or_b32 v160, v172, 9, v172
    v_lshrrev_b32_e64 v4, 12, v140
    v_and_or_b32 v160, v160, s22, 4
    v_lshl_or_b32 v160, v4, 8, v160
    v_lshl_or_b32 v160, v140, 16, v160
    v_lshl_or_b32 v161, v173, 9, v173
    v_lshrrev_b32 v4, 12, v141
    v_and_or_b32 v161, v161, s22, 4
    v_lshl_or_b32 v161, v4, 8, v161
    v_lshl_or_b32 v161, v141, 16, v161
    v_lshl_or_b32 v162, v174, 9, v174
    v_lshrrev_b32 v4, 12, v142
    v_and_or_b32 v162, v162, s22, 4
    v_lshl_or_b32 v162, v4, 8, v162
    v_lshl_or_b32 v162, v142, 16, v162
    v_lshl_or_b32 v163, v175, 9, v175
    v_lshrrev_b32 v4, 12, v143
    v_and_or_b32 v163, v163, s22, 4
    v_lshl_or_b32 v163, v4, 8, v163
    v_lshl_or_b32 v163, v143, 16, v163
    v_lshlrev_b32 v10, 16, v144
    v_lshlrev_b32 v11, 16, v146
    v_and_b32 v12, 0xffff0000, v146
    v_lshlrev_b32 v13, 16, v147
    v_mul_f32 v11, v10, v11
    v_mul_f32 v12, v10, v12
    v_mul_f32 v13, v10, v13
    v_cvt_pk_bf16_f32 v164, v10, v11
    v_cvt_pk_bf16_f32 v165, v12, v13
    v_and_b32 v10, 0xffff0000, v144
    v_and_b32 v11, 0xffff0000, v147
    v_lshlrev_b32 v12, 16, v148
    v_and_b32 v13, 0xffff0000, v148
    v_mul_f32 v11, v10, v11
    v_mul_f32 v12, v10, v12
    v_mul_f32 v13, v10, v13
    v_cvt_pk_bf16_f32 v166, v10, v11
    v_cvt_pk_bf16_f32 v167, v12, v13
    v_lshlrev_b32 v10, 16, v145
    v_lshlrev_b32 v11, 16, v149
    v_and_b32 v12, 0xffff0000, v149
    v_lshlrev_b32 v13, 16, v150
    v_mul_f32 v11, v10, v11
    v_mul_f32 v12, v10, v12
    v_mul_f32 v13, v10, v13
    v_cvt_pk_bf16_f32 v168, v10, v11
    v_cvt_pk_bf16_f32 v169, v12, v13
    v_and_b32 v10, 0xffff0000, v145
    v_and_b32 v11, 0xffff0000, v150
    v_lshlrev_b32 v12, 16, v151
    v_and_b32 v13, 0xffff0000, v151
    v_mul_f32 v11, v10, v11
    v_mul_f32 v12, v10, v12
    v_mul_f32_e64 v13, v10, v13
    v_cvt_pk_bf16_f32 v170, v10, v11
    v_cvt_pk_bf16_f32 v171, v12, v13
    s_waitcnt lgkmcnt(0)
    v_add_u32 v136, v136, v156
    ds_write2_b32 v136, v164, v165 offset0:0 offset1:1
    ds_write_b32 v136, v160 offset:8
    v_add_u32 v137, v137, v157
    ds_write2_b32 v137, v166, v167 offset0:0 offset1:1
    ds_write_b32 v137, v161 offset:8
    v_add_u32 v138, v138, v158
    ds_write2_b32 v138, v168, v169 offset0:0 offset1:1
    ds_write_b32 v138, v162 offset:8
    v_add_u32 v139, v139, v159
    ds_write2_b32 v139, v170, v171 offset0:0 offset1:1
    ds_write_b32 v139, v163 offset:8
    s_mov_b32 exec_hi, -1
F_key_4:
    s_waitcnt vmcnt(11)
    v_lshl_or_b32 v40, v52, 9, v52
    v_lshrrev_b32 v4, 12, v20
    v_and_or_b32 v40, v40, s22, 4
    v_lshl_or_b32 v40, v4, 8, v40
    v_lshl_or_b32 v40, v20, 16, v40
    v_lshl_or_b32 v41, v53, 9, v53
    v_lshrrev_b32 v4, 12, v21
    v_and_or_b32 v41, v41, s22, 4
    v_lshl_or_b32 v41, v4, 8, v41
    v_lshl_or_b32 v41, v21, 16, v41
    v_lshl_or_b32 v42, v54, 9, v54
    v_lshrrev_b32 v4, 12, v22
    v_and_or_b32 v42, v42, s22, 4
    v_lshl_or_b32 v42, v4, 8, v42
    v_lshl_or_b32 v42, v22, 16, v42
    v_lshl_or_b32 v43, v55, 9, v55
    v_lshrrev_b32 v4, 12, v23
    v_and_or_b32 v43, v43, s22, 4
    v_lshl_or_b32 v43, v4, 8, v43
    v_lshl_or_b32 v43, v23, 16, v43
    s_waitcnt vmcnt(8)
    v_lshlrev_b32 v10, 16, v24
    v_lshlrev_b32 v11, 16, v26
    v_and_b32 v12, 0xffff0000, v26
    v_lshlrev_b32 v13, 16, v27
    v_mul_f32 v11, v10, v11
    v_mul_f32 v12, v10, v12
    v_mul_f32 v13, v10, v13
    v_cvt_pk_bf16_f32 v44, v10, v11
    v_cvt_pk_bf16_f32 v45, v12, v13
    v_and_b32 v10, 0xffff0000, v24
    v_and_b32 v11, 0xffff0000, v27
    v_lshlrev_b32 v12, 16, v28
    v_and_b32 v13, 0xffff0000, v28
    v_mul_f32 v11, v10, v11
    v_mul_f32 v12, v10, v12
    v_mul_f32 v13, v10, v13
    v_cvt_pk_bf16_f32 v46, v10, v11
    v_cvt_pk_bf16_f32 v47, v12, v13
    v_lshlrev_b32 v10, 16, v25
    v_lshlrev_b32 v11, 16, v29
    v_and_b32 v12, 0xffff0000, v29
    v_lshlrev_b32 v13, 16, v30
    v_mul_f32 v11, v10, v11
    v_mul_f32 v12, v10, v12
    v_mul_f32 v13, v10, v13
    v_cvt_pk_bf16_f32 v48, v10, v11
    v_cvt_pk_bf16_f32 v49, v12, v13
    v_and_b32 v10, 0xffff0000, v25
    v_and_b32 v11, 0xffff0000, v30
    v_lshlrev_b32 v12, 16, v31
    v_and_b32 v13, 0xffff0000, v31
    v_mul_f32 v11, v10, v11
    v_mul_f32 v12, v10, v12
    v_mul_f32 v13, v10, v13
    v_cvt_pk_bf16_f32 v50, v10, v11
    v_cvt_pk_bf16_f32 v51, v12, v13
    s_waitcnt lgkmcnt(0)
    v_add_u32 v16, v16, v36
    ds_write2_b32 v16, v44, v45 offset0:0 offset1:1
    ds_write_b32 v16, v40 offset:8
    v_add_u32 v17, v17, v37
    ds_write2_b32 v17, v46, v47 offset0:0 offset1:1
    ds_write_b32 v17, v41 offset:8
    v_add_u32 v18, v18, v38
    ds_write2_b32 v18, v48, v49 offset0:0 offset1:1
    ds_write_b32 v18, v42 offset:8
    v_add_u32 v19, v19, v39
    ds_write2_b32 v19, v50, v51 offset0:0 offset1:1
    ds_write_b32 v19, v43 offset:8
    s_waitcnt vmcnt(7)
    v_lshl_or_b32 v80, v92, 9, v92
    v_lshrrev_b32_e64 v4, 12, v60
    v_and_or_b32 v80, v80, s22, 4
    v_lshl_or_b32 v80, v4, 8, v80
    v_lshl_or_b32 v80, v60, 16, v80
    v_lshl_or_b32 v81, v93, 9, v93
    v_lshrrev_b32 v4, 12, v61
    v_and_or_b32 v81, v81, s22, 4
    v_lshl_or_b32 v81, v4, 8, v81
    v_lshl_or_b32 v81, v61, 16, v81
    v_lshl_or_b32 v82, v94, 9, v94
    v_lshrrev_b32 v4, 12, v62
    v_and_or_b32 v82, v82, s22, 4
    v_lshl_or_b32 v82, v4, 8, v82
    v_lshl_or_b32 v82, v62, 16, v82
    v_lshl_or_b32 v83, v95, 9, v95
    v_lshrrev_b32 v4, 12, v63
    v_and_or_b32 v83, v83, s22, 4
    v_lshl_or_b32 v83, v4, 8, v83
    v_lshl_or_b32 v83, v63, 16, v83
    s_waitcnt vmcnt(4)
    v_lshlrev_b32 v10, 16, v64
    v_lshlrev_b32 v11, 16, v66
    v_and_b32 v12, 0xffff0000, v66
    v_lshlrev_b32 v13, 16, v67
    v_mul_f32 v11, v10, v11
    v_mul_f32 v12, v10, v12
    v_mul_f32 v13, v10, v13
    v_cvt_pk_bf16_f32 v84, v10, v11
    v_cvt_pk_bf16_f32 v85, v12, v13
    v_and_b32 v10, 0xffff0000, v64
    v_and_b32 v11, 0xffff0000, v67
    v_lshlrev_b32 v12, 16, v68
    v_and_b32 v13, 0xffff0000, v68
    v_mul_f32 v11, v10, v11
    v_mul_f32 v12, v10, v12
    v_mul_f32 v13, v10, v13
    v_cvt_pk_bf16_f32 v86, v10, v11
    v_cvt_pk_bf16_f32 v87, v12, v13
    v_lshlrev_b32 v10, 16, v65
    v_lshlrev_b32 v11, 16, v69
    v_and_b32 v12, 0xffff0000, v69
    v_lshlrev_b32 v13, 16, v70
    v_mul_f32 v11, v10, v11
    v_mul_f32 v12, v10, v12
    v_mul_f32 v13, v10, v13
    v_cvt_pk_bf16_f32 v88, v10, v11
    v_cvt_pk_bf16_f32 v89, v12, v13
    v_and_b32 v10, 0xffff0000, v65
    v_and_b32 v11, 0xffff0000, v70
    v_lshlrev_b32 v12, 16, v71
    v_and_b32 v13, 0xffff0000, v71
    v_mul_f32 v11, v10, v11
    v_mul_f32 v12, v10, v12
    v_mul_f32 v13, v10, v13
    v_cvt_pk_bf16_f32 v90, v10, v11
    v_cvt_pk_bf16_f32 v91, v12, v13
    v_add_u32 v56, v56, v76
    ds_write2_b32 v56, v84, v85 offset0:0 offset1:1
    ds_write_b32 v56, v80 offset:8
    v_add_u32 v57, v57, v77
    ds_write2_b32 v57, v86, v87 offset0:0 offset1:1
    ds_write_b32 v57, v81 offset:8
    v_add_u32_e64 v58, v58, v78
    ds_write2_b32 v58, v88, v89 offset0:0 offset1:1
    ds_write_b32 v58, v82 offset:8
    v_add_u32 v59, v59, v79
    ds_write2_b32 v59, v90, v91 offset0:0 offset1:1
    ds_write_b32 v59, v83 offset:8
    s_waitcnt vmcnt(3)
    v_lshl_or_b32 v120, v132, 9, v132
    v_lshrrev_b32_e64 v4, 12, v100
    v_and_or_b32 v120, v120, s22, 4
    v_lshl_or_b32 v120, v4, 8, v120
    v_lshl_or_b32 v120, v100, 16, v120
    v_lshl_or_b32 v121, v133, 9, v133
    v_lshrrev_b32 v4, 12, v101
    v_and_or_b32 v121, v121, s22, 4
    v_lshl_or_b32 v121, v4, 8, v121
    v_lshl_or_b32 v121, v101, 16, v121
    v_lshl_or_b32 v122, v134, 9, v134
    v_lshrrev_b32 v4, 12, v102
    v_and_or_b32 v122, v122, s22, 4
    v_lshl_or_b32 v122, v4, 8, v122
    v_lshl_or_b32 v122, v102, 16, v122
    v_lshl_or_b32 v123, v135, 9, v135
    v_lshrrev_b32 v4, 12, v103
    v_and_or_b32 v123, v123, s22, 4
    v_lshl_or_b32 v123, v4, 8, v123
    v_lshl_or_b32 v123, v103, 16, v123
    s_waitcnt vmcnt(0)
    v_lshlrev_b32 v10, 16, v104
    v_lshlrev_b32 v11, 16, v106
    v_and_b32 v12, 0xffff0000, v106
    v_lshlrev_b32 v13, 16, v107
    v_mul_f32 v11, v10, v11
    v_mul_f32 v12, v10, v12
    v_mul_f32 v13, v10, v13
    v_cvt_pk_bf16_f32 v124, v10, v11
    v_cvt_pk_bf16_f32 v125, v12, v13
    v_and_b32 v10, 0xffff0000, v104
    v_and_b32 v11, 0xffff0000, v107
    v_lshlrev_b32 v12, 16, v108
    v_and_b32 v13, 0xffff0000, v108
    v_mul_f32 v11, v10, v11
    v_mul_f32 v12, v10, v12
    v_mul_f32 v13, v10, v13
    v_cvt_pk_bf16_f32 v126, v10, v11
    v_cvt_pk_bf16_f32 v127, v12, v13
    v_lshlrev_b32 v10, 16, v105
    v_lshlrev_b32 v11, 16, v109
    v_and_b32 v12, 0xffff0000, v109
    v_lshlrev_b32 v13, 16, v110
    v_mul_f32 v11, v10, v11
    v_mul_f32 v12, v10, v12
    v_mul_f32 v13, v10, v13
    v_cvt_pk_bf16_f32 v128, v10, v11
    v_cvt_pk_bf16_f32 v129, v12, v13
    v_and_b32 v10, 0xffff0000, v105
    v_and_b32 v11, 0xffff0000, v110
    v_lshlrev_b32 v12, 16, v111
    v_and_b32 v13, 0xffff0000, v111
    v_mul_f32 v11, v10, v11
    v_mul_f32 v12, v10, v12
    v_mul_f32 v13, v10, v13
    v_cvt_pk_bf16_f32 v130, v10, v11
    v_cvt_pk_bf16_f32 v131, v12, v13
    v_add_u32 v96, v96, v116
    ds_write2_b32 v96, v124, v125 offset0:0 offset1:1
    ds_write_b32 v96, v120 offset:8
    v_add_u32 v97, v97, v117
    ds_write2_b32 v97, v126, v127 offset0:0 offset1:1
    ds_write_b32 v97, v121 offset:8
    v_add_u32_e64 v98, v98, v118
    ds_write2_b32 v98, v128, v129 offset0:0 offset1:1
    ds_write_b32 v98, v122 offset:8
    v_add_u32 v99, v99, v119
    ds_write2_b32 v99, v130, v131 offset0:0 offset1:1
    ds_write_b32 v99, v123 offset:8
    v_lshl_or_b32 v188, v189, 16, v188
    s_lshl_b32 s15, s2, 7
    s_add_u32 s15, s15, 0
    v_lshrrev_b32 v189, 4, v0
    v_lshlrev_b32 v189, 15, v189
    v_and_b32 v190, 15, v0
    v_lshl_add_u32 v190, v190, 3, s15
    v_add_u32_e64 v190, v190, v189
    v_mov_b32_e64 v189, s3
    global_store_dwordx2 v190, v[188:189], s[16:17] sc0 sc1
    s_mul_i32 s15, s2, 38400
    s_add_u32 s15, s15, 720896
    s_add_u32 s22, s16, s15
    s_addc_u32 s23, s17, 0
    v_lshlrev_b32_e64 v4, 4, v0
    s_waitcnt lgkmcnt(0)
    s_barrier
    ds_read_b128 v[16:19], v4 offset:0
    ds_read_b128 v[20:23], v4 offset:4096
    ds_read_b128 v[24:27], v4 offset:8192
    ds_read_b128 v[28:31], v4 offset:12288
    ds_read_b128 v[32:35], v4 offset:16384
    ds_read_b128 v[36:39], v4 offset:20480
    ds_read_b128 v[40:43], v4 offset:24576
    ds_read_b128 v[44:47], v4 offset:28672
    ds_read_b128 v[48:51], v4 offset:32768
    s_cmp_gt_u32 s18, 1
    s_cbranch_scc1 F_no10a
    s_cmp_eq_u32 s18, 1
    s_cselect_b32 exec_hi, 0, -1
    ds_read_b128 v[52:55], v4 offset:36864
    v_add_u32 v6, 36864, v4
    s_waitcnt lgkmcnt(0)
    global_store_dwordx4 v6, v[52:55], s[22:23] sc0 sc1
    s_mov_b32 exec_hi, -1
F_no10a:
    s_waitcnt lgkmcnt(8)
    global_store_dwordx4 v4, v[16:19], s[22:23] sc0 sc1
    v_add_u32 v5, 4096, v4
    s_waitcnt lgkmcnt(7)
    global_store_dwordx4 v5, v[20:23], s[22:23] sc0 sc1
    v_add_u32 v5, 8192, v4
    s_waitcnt lgkmcnt(6)
    global_store_dwordx4 v5, v[24:27], s[22:23] sc0 sc1
    v_add_u32 v5, 12288, v4
    s_waitcnt lgkmcnt(5)
    global_store_dwordx4 v5, v[28:31], s[22:23] sc0 sc1
    v_add_u32 v5, 16384, v4
    s_waitcnt lgkmcnt(4)
    global_store_dwordx4 v5, v[32:35], s[22:23] sc0 sc1
    v_add_u32 v5, 20480, v4
    s_waitcnt lgkmcnt(3)
    global_store_dwordx4 v5, v[36:39], s[22:23] sc0 sc1
    v_add_u32 v5, 24576, v4
    s_nop 0
    s_waitcnt lgkmcnt(2)
    global_store_dwordx4 v5, v[40:43], s[22:23] sc0 sc1
    v_add_u32 v5, 28672, v4
    s_waitcnt lgkmcnt(1)
    global_store_dwordx4 v5, v[44:47], s[22:23] sc0 sc1
    v_add_u32 v5, 32768, v4
    s_waitcnt lgkmcnt(0)
    global_store_dwordx4 v5, v[48:51], s[22:23] sc0 sc1
    s_branch F_join
    s_nop 0
    s_nop 0
    s_nop 0
    s_nop 0
    s_nop 0
    s_nop 0
    s_nop 0
    s_nop 0
    s_nop 0
    s_nop 0
    s_nop 0
    s_nop 0
    s_nop 0
    s_nop 0
    s_nop 0
F_helper:
    s_load_dwordx4 s[4:7], s[0:1], 40
    s_load_dwordx2 s[8:9], s[0:1], 56
    s_load_dword s3, s[16:17], 656384
    v_mov_b32 v176, 0
    v_mov_b32 v177, 0
    v_mov_b32 v178, 0
    v_mov_b32 v179, 0
    v_lshlrev_b32 v184, 4, v0
    v_and_b32 v185, 48, v184
    v_add_u32 v185, 122368, v185
    ds_write_b128 v185, v[176:179]
    v_add_u32 v184, 65536, v184
    v_mov_b32 v180, 0xffff0000
    v_mov_b32 v181, 0xffff0000
    v_mov_b32 v182, 0xffff0000
    v_mov_b32 v183, 0xffff0000
    ds_write_b128 v184, v[180:183] offset:0
    ds_write_b128 v184, v[180:183] offset:4096
    ds_write_b128 v184, v[180:183] offset:8192
    ds_write_b128 v184, v[180:183] offset:12288
    ds_write_b128 v184, v[180:183] offset:16384
    v_mov_b32 v188, 0
    v_mov_b32 v198, 0
    v_and_b32 v1, 63, v0
    s_waitcnt lgkmcnt(0)
    s_mul_i32 s3, s3, 0x9e3779b1
    s_add_u32 s3, s3, 0x7f4a7c15
    s_lshl_b32 s15, s2, 7
    s_add_u32 s15, s15, 0
    v_lshrrev_b32 v189, 4, v0
    v_lshlrev_b32 v189, 15, v189
    v_and_b32 v190, 15, v0
    v_lshl_add_u32 v190, v190, 3, s15
    v_add_u32 v190, v190, v189
    v_mov_b32 v189, s3
    global_store_dwordx2 v190, v[188:189], s[16:17] sc0 sc1
    s_cmp_lg_u32 s18, 0
    s_cbranch_scc1 F_hnoflag
    s_lshl_b32 s15, s2, 4
    s_add_u32 s15, s15, 671744
    v_lshl_add_u32 v2, v0, 12, s15
    s_mov_b64 exec, 0xff
    s_mov_b32 exec_hi, 0
    global_store_dword v2, v189, s[16:17] sc0 sc1
    s_mov_b64 exec, -1
F_hnoflag:
    s_cmp_ge_u32 s2, 255
    s_cbranch_scc1 F_wdone
    s_sub_u32 s26, s2, 250
    s_lshl_b32 s26, s26, 2
    s_add_u32 s26, s26, s18
    v_lshrrev_b32 v2, 4, v1
    v_and_b32 v3, 15, v1
    v_lshrrev_b32 v5, 2, v3
    v_and_b32_e64 v7, 3, v3
    v_lshl_add_u32 v7, v5, 3, v7
    s_add_u32 s15, s26, 0
    s_lshr_b32 s14, s15, 3
    s_bfe_u32 s13, s15, 0x10002
    s_and_b32 s12, s15, 3
    s_cmp_lt_u32 s14, 2
    s_cselect_b32 s10, s6, s8
    s_cselect_b32 s11, s7, s9
    s_cselect_b32 s19, 0, 2
    s_sub_u32 s19, s14, s19
    s_lshl_b32 s19, s19, 13
    s_lshl_b32 s20, s13, 5
    v_lshl_add_u32 v4, v2, 2, s20
    s_lshr_b32 s21, s12, 1
    s_lshl_b32 s21, s21, 5
    s_and_b32 s22, s12, 1
    s_lshl_b32 s22, s22, 2
    s_add_u32 s21, s21, s22
    v_add_u32 v5, s21, v7
    v_lshlrev_b32 v6, 7, v4
    v_lshl_add_u32 v6, v5, 1, v6
    v_add_u32_e64 v6, s19, v6
    s_lshl_b32 s23, s14, 7
    v_lshl_add_u32 v8, v4, 1, s23
    global_load_ushort v16, v6, s[10:11] offset:0
    global_load_ushort v24, v8, s[4:5] offset:0
    global_load_ushort v17, v6, s[10:11] offset:128
    global_load_ushort v25, v8, s[4:5] offset:2
    global_load_ushort v18, v6, s[10:11] offset:256
    global_load_ushort v26, v8, s[4:5] offset:4
    global_load_ushort v19, v6, s[10:11] offset:384
    global_load_ushort v27, v8, s[4:5] offset:6
    global_load_ushort v20, v6, s[10:11] offset:2048
    global_load_ushort v28, v8, s[4:5] offset:32
    global_load_ushort v21, v6, s[10:11] offset:2176
    global_load_ushort v29, v8, s[4:5] offset:34
    global_load_ushort v22, v6, s[10:11] offset:2304
    global_load_ushort v30, v8, s[4:5] offset:36
    global_load_ushort v23, v6, s[10:11] offset:2432
    global_load_ushort v31, v8, s[4:5] offset:38
    s_add_u32 s15, s26, 20
    s_lshr_b32 s14, s15, 3
    s_bfe_u32 s13, s15, 0x10002
    s_and_b32 s12, s15, 3
    s_cmp_lt_u32 s14, 2
    s_cselect_b32 s10, s6, s8
    s_cselect_b32 s11, s7, s9
    s_cselect_b32 s19, 0, 2
    s_sub_u32 s19, s14, s19
    s_lshl_b32 s19, s19, 13
    s_lshl_b32 s20, s13, 5
    v_lshl_add_u32 v4, v2, 2, s20
    s_lshr_b32 s21, s12, 1
    s_lshl_b32 s21, s21, 5
    s_and_b32 s22, s12, 1
    s_lshl_b32 s22, s22, 2
    s_add_u32 s21, s21, s22
    v_add_u32 v5, s21, v7
    v_lshlrev_b32_e64 v6, 7, v4
    v_lshl_add_u32 v6, v5, 1, v6
    v_add_u32 v6, s19, v6
    s_lshl_b32 s23, s14, 7
    v_lshl_add_u32 v8, v4, 1, s23
    global_load_ushort v40, v6, s[10:11] offset:0
    global_load_ushort v48, v8, s[4:5] offset:0
    global_load_ushort v41, v6, s[10:11] offset:128
    global_load_ushort v49, v8, s[4:5] offset:2
    global_load_ushort v42, v6, s[10:11] offset:256
    global_load_ushort v50, v8, s[4:5] offset:4
    global_load_ushort v43, v6, s[10:11] offset:384
    global_load_ushort v51, v8, s[4:5] offset:6
    global_load_ushort v44, v6, s[10:11] offset:2048
    global_load_ushort v52, v8, s[4:5] offset:32
    global_load_ushort v45, v6, s[10:11] offset:2176
    global_load_ushort v53, v8, s[4:5] offset:34
    global_load_ushort v46, v6, s[10:11] offset:2304
    global_load_ushort v54, v8, s[4:5] offset:36
    global_load_ushort v47, v6, s[10:11] offset:2432
    global_load_ushort v55, v8, s[4:5] offset:38
    s_waitcnt vmcnt(16)
    v_lshlrev_b32 v16, 16, v16
    v_lshlrev_b32 v24, 16, v24
    v_mul_f32 v16, v16, v24
    v_lshlrev_b32 v17, 16, v17
    v_lshlrev_b32 v25, 16, v25
    v_mul_f32 v17, v17, v25
    v_lshlrev_b32 v18, 16, v18
    v_lshlrev_b32 v26, 16, v26
    v_mul_f32 v18, v18, v26
    v_lshlrev_b32 v19, 16, v19
    v_lshlrev_b32 v27, 16, v27
    v_mul_f32 v19, v19, v27
    v_lshlrev_b32 v20, 16, v20
    v_lshlrev_b32 v28, 16, v28
    v_mul_f32 v20, v20, v28
    v_lshlrev_b32 v21, 16, v21
    v_lshlrev_b32 v29, 16, v29
    v_mul_f32 v21, v21, v29
    v_lshlrev_b32 v22, 16, v22
    v_lshlrev_b32 v30, 16, v30
    v_mul_f32 v22, v22, v30
    v_lshlrev_b32 v23, 16, v23
    v_lshlrev_b32 v31, 16, v31
    v_mul_f32_e64 v23, v23, v31
    v_cvt_pk_bf16_f32 v32, v16, v17
    v_cvt_pk_bf16_f32 v33, v18, v19
    v_cvt_pk_bf16_f32 v34, v20, v21
    v_cvt_pk_bf16_f32 v35, v22, v23
    s_add_u32 s15, s26, 0
    s_lshl_b32 s25, s15, 10
    s_add_u32 s25, s25, 589824
    v_lshl_add_u32 v2, v1, 4, s25
    global_store_dwordx4 v2, v[32:35], s[16:17] sc0 sc1
    s_waitcnt vmcnt(1)
    v_lshlrev_b32 v40, 16, v40
    v_lshlrev_b32 v48, 16, v48
    v_mul_f32 v40, v40, v48
    v_lshlrev_b32 v41, 16, v41
    v_lshlrev_b32 v49, 16, v49
    v_mul_f32 v41, v41, v49
    v_lshlrev_b32 v42, 16, v42
    v_lshlrev_b32 v50, 16, v50
    v_mul_f32 v42, v42, v50
    v_lshlrev_b32 v43, 16, v43
    v_lshlrev_b32 v51, 16, v51
    v_mul_f32 v43, v43, v51
    v_lshlrev_b32 v44, 16, v44
    v_lshlrev_b32 v52, 16, v52
    v_mul_f32 v44, v44, v52
    v_lshlrev_b32 v45, 16, v45
    v_lshlrev_b32 v53, 16, v53
    v_mul_f32 v45, v45, v53
    v_lshlrev_b32 v46, 16, v46
    v_lshlrev_b32 v54, 16, v54
    v_mul_f32 v46, v46, v54
    v_lshlrev_b32 v47, 16, v47
    v_lshlrev_b32 v55, 16, v55
    v_mul_f32_e64 v47, v47, v55
    v_cvt_pk_bf16_f32 v56, v40, v41
    v_cvt_pk_bf16_f32 v57, v42, v43
    v_cvt_pk_bf16_f32 v58, v44, v45
    v_cvt_pk_bf16_f32 v59, v46, v47
    s_add_u32 s15, s26, 20
    s_lshl_b32 s25, s15, 10
    s_add_u32 s25, s25, 589824
    v_lshl_add_u32 v2, v1, 4, s25
    global_store_dwordx4 v2, v[56:59], s[16:17] sc0 sc1
    s_waitcnt vmcnt(0)
    s_barrier
    s_lshl_b32 s15, s2, 2
    s_add_u32 s15, s15, 654360
    v_mov_b32 v2, s15
    v_mov_b32 v3, s3
    global_store_dword v2, v3, s[16:17] sc0 sc1
F_wdone:
F_join:
    s_load_dwordx2 s[12:13], s[0:1], 72
    v_and_b32 v15, 63, v0
    s_mov_b32 s4, s28
    s_mov_b32 s5, s29
    s_lshr_b32 s53, s27, 4
    s_lshl_b32 s53, s53, 15
    s_and_b32 s43, s27, 15
    s_lshl_b32 s43, s43, 3
    s_add_u32 s53, s53, s43
    s_add_u32 s53, s53, 0
    s_add_u32 s56, s16, s53
    s_addc_u32 s57, s17, 0
    s_mov_b32 s27, s27
    s_movk_i32 s21, 512
    s_mov_b32 s50, 65536
    s_mov_b32 s51, 84480
    s_mov_b32 s39, 0
    s_mov_b32 s40, 0
    s_movk_i32 s41, 256
    s_mov_b32 s49, 0
    s_mov_b32 s63, 0
    s_mov_b32 s54, 0
    s_mul_i32 s19, s18, 16384
    s_sub_u32 s4, s4, 3072
    s_subb_u32 s5, s5, 0
    s_mov_b32 s6, 12803072
    s_mov_b32 s7, 0x20000
    s_mul_i32 s101, s2, 98
    s_mul_i32 s43, s18, 25
    s_add_u32 s101, s101, s43
    s_lshl_b32 s101, s101, 9
    s_add_u32 s101, s101, 3072
    s_mov_b32 s14, 12800000
    s_mov_b32 s15, 0x20000
    v_bfe_u32 v88, v15, 2, 3
    v_lshrrev_b32 v89, 5, v15
    v_bfe_u32 v90, v15, 1, 1
    v_bfe_u32 v91, v15, 4, 1
    v_xor_b32 v90, v90, v91
    v_lshl_add_u32 v90, v89, 1, v90
    v_and_b32 v1, 1, v15
    v_lshl_add_u32 v1, v90, 1, v1
    v_lshlrev_b32 v1, 4, v1
    v_lshl_add_u32 v2, v88, 4, s50
    v_lshl_add_u32 v3, v89, 3, v2
    v_lshlrev_b32 v4, 4, v89
    v_xor_b32 v4, 16, v4
    v_add_u32 v4, 122368, v4
    v_and_or_b32 v5, v15, 3, 4
    v_and_b32 v90, 3, v15
    v_lshlrev_b32 v90, 3, v90
    v_lshl_add_u32 v90, v88, 6, v90
    v_lshl_add_u32 v90, v89, 11, v90
    v_lshl_add_u32 v90, v91, 5, v90
    v_add_u32 v8, s19, v90
    v_xor_b32 v9, 32, v8
    s_mov_b32 s94, 0x55555555
    s_mov_b32 s95, 0x55555555
    s_mov_b32 s96, 0x33333333
    s_mov_b32 s97, 0x33333333
    s_mov_b32 s100, 4294920704
    s_mov_b32 s55, 0x80008000
    v_mov_b32 v16, 0
    v_mov_b32 v17, 0
    v_mov_b32 v18, 0
    v_mov_b32 v19, 0
    v_mov_b32 v20, 0
    v_mov_b32 v21, 0
    v_mov_b32 v22, 0
    v_mov_b32 v23, 0
    v_mov_b32 v24, 0
    v_mov_b32 v25, 0
    v_mov_b32 v26, 0
    v_mov_b32 v27, 0
    v_mov_b32 v28, 0
    v_mov_b32 v29, 0
    v_mov_b32 v30, 0
    v_mov_b32 v31, 0
    v_mov_b32 v32, 0
    v_mov_b32 v33, 0
    v_mov_b32 v34, 0
    v_mov_b32 v35, 0
    v_mov_b32 v36, 0
    v_mov_b32 v37, 0
    v_mov_b32 v38, 0
    v_mov_b32 v39, 0
    v_mov_b32 v40, 0
    v_mov_b32 v41, 0
    v_mov_b32 v42, 0
    v_mov_b32 v43, 0
    v_mov_b32 v44, 0
    v_mov_b32 v45, 0
    v_mov_b32 v46, 0
    v_mov_b32 v47, 0
    v_mov_b32 v48, 0
    v_mov_b32 v49, 0
    v_mov_b32 v50, 0
    v_mov_b32 v51, 0
    v_mov_b32 v52, 0
    v_mov_b32 v53, 0
    v_mov_b32 v54, 0
    v_mov_b32 v55, 0
    v_mov_b32 v56, 0
    v_mov_b32 v57, 0
    v_mov_b32 v58, 0
    v_mov_b32 v59, 0
    v_mov_b32 v60, 0
    v_mov_b32 v61, 0
    v_mov_b32 v62, 0
    v_mov_b32 v63, 0
    v_mov_b32 v64, 0
    v_mov_b32 v65, 0
    v_mov_b32 v66, 0
    v_mov_b32 v67, 0
    v_mov_b32 v68, 0
    v_mov_b32 v69, 0
    v_mov_b32 v70, 0
    v_mov_b32 v71, 0
    v_mov_b32 v72, 0
    v_mov_b32 v73, 0
    v_mov_b32 v74, 0
    v_mov_b32 v75, 0
    v_mov_b32 v76, 0
    v_mov_b32 v77, 0
    v_mov_b32_e64 v78, 0
    v_mov_b32_e64 v79, 0
    v_accvgpr_write_b32 a160, 0
    v_accvgpr_write_b32 a161, 0
    v_accvgpr_write_b32 a162, 0
    v_accvgpr_write_b32 a163, 0
    v_accvgpr_write_b32 a164, 0
    v_accvgpr_write_b32 a165, 0
    v_accvgpr_write_b32 a166, 0
    v_accvgpr_write_b32 a167, 0
    v_accvgpr_write_b32 a168, 0
    v_accvgpr_write_b32 a169, 0
    v_accvgpr_write_b32 a170, 0
    v_accvgpr_write_b32 a171, 0
    v_accvgpr_write_b32 a172, 0
    v_accvgpr_write_b32 a173, 0
    v_accvgpr_write_b32 a174, 0
    v_accvgpr_write_b32 a175, 0
    v_accvgpr_write_b32 a176, 0
    v_accvgpr_write_b32 a177, 0
    v_accvgpr_write_b32 a178, 0
    v_accvgpr_write_b32 a179, 0
    v_accvgpr_write_b32 a180, 0
    v_accvgpr_write_b32 a181, 0
    v_accvgpr_write_b32 a182, 0
    v_accvgpr_write_b32 a183, 0
    v_accvgpr_write_b32 a184, 0
    v_accvgpr_write_b32 a185, 0
    v_accvgpr_write_b32 a186, 0
    v_accvgpr_write_b32 a187, 0
    v_accvgpr_write_b32 a188, 0
    v_accvgpr_write_b32 a189, 0
    v_accvgpr_write_b32 a190, 0
    v_accvgpr_write_b32 a191, 0
    v_accvgpr_write_b32 a192, 0
    v_accvgpr_write_b32 a193, 0
    v_accvgpr_write_b32 a194, 0
    v_accvgpr_write_b32 a195, 0
    v_accvgpr_write_b32 a196, 0
    v_accvgpr_write_b32 a197, 0
    v_accvgpr_write_b32 a198, 0
    v_accvgpr_write_b32 a199, 0
    v_accvgpr_write_b32 a200, 0
    v_accvgpr_write_b32 a201, 0
    v_accvgpr_write_b32 a202, 0
    v_accvgpr_write_b32 a203, 0
    v_accvgpr_write_b32 a204, 0
    v_accvgpr_write_b32 a205, 0
    v_accvgpr_write_b32 a206, 0
    v_accvgpr_write_b32 a207, 0
    v_accvgpr_write_b32 a208, 0
    v_accvgpr_write_b32 a209, 0
    v_accvgpr_write_b32 a210, 0
    v_accvgpr_write_b32 a211, 0
    v_accvgpr_write_b32 a212, 0
    v_accvgpr_write_b32 a213, 0
    v_accvgpr_write_b32 a214, 0
    v_accvgpr_write_b32 a215, 0
    v_accvgpr_write_b32 a216, 0
    v_accvgpr_write_b32 a217, 0
    v_accvgpr_write_b32 a218, 0
    v_accvgpr_write_b32 a219, 0
    v_accvgpr_write_b32 a220, 0
    v_accvgpr_write_b32 a221, 0
    v_accvgpr_write_b32 a222, 0
    v_accvgpr_write_b32 a223, 0
    s_lshl_b32 s43, s2, 4
    s_add_u32 s43, s43, 671744
    v_lshl_add_u32 v190, v0, 12, s43
    v_mov_b32 v189, s3
    v_min_u32 v96, 4, v15
    v_lshlrev_b32 v96, 2, v96
    v_add_u32 v96, 655360, v96
    global_load_dword v97, v96, s[16:17] sc1
    s_waitcnt vmcnt(0) lgkmcnt(0)
    s_barrier
    s_cmp_lg_u32 s18, 0
    s_cbranch_scc1 K2_noflagst
    s_mov_b64 exec, 0xff
    s_mov_b32 exec_hi, 0
    global_store_dword v190, v189, s[16:17] sc0 sc1
    s_mov_b64 exec, -1
K2_noflagst:
    s_mov_b32 s43, 0
K2_wchk:
    v_cmp_ne_u32 vcc, s3, v97
    s_cbranch_vccnz K2_wwait
    s_add_u32 s68, s16, 589824
    s_addc_u32 s69, s17, 0
    s_mov_b32 s70, 40960
    s_mov_b32 s71, 0x20000
    s_mul_i32 s43, s18, 10240
    s_add_u32 s53, s43, 122560
    s_mov_b32 m0, s53
    v_lshlrev_b32 v88, 4, v15
    buffer_load_dwordx4 v88, s[68:71], s43 offen sc1 lds
    buffer_load_dwordx4 v88, s[68:71], s43 offen offset:1024 sc1 lds
    buffer_load_dwordx4 v88, s[68:71], s43 offen offset:2048 sc1 lds
    buffer_load_dwordx4 v88, s[68:71], s43 offen offset:3072 sc1 lds
    s_add_u32 s43, s43, 4096
    s_add_u32 m0, m0, 4096
    s_nop 0
    buffer_load_dwordx4 v88, s[68:71], s43 offen sc1 lds
    buffer_load_dwordx4 v88, s[68:71], s43 offen offset:1024 sc1 lds
    buffer_load_dwordx4 v88, s[68:71], s43 offen offset:2048 sc1 lds
    buffer_load_dwordx4 v88, s[68:71], s43 offen offset:3072 sc1 lds
    s_add_u32 s43, s43, 4096
    s_add_u32 m0, m0, 4096
    s_nop 0
    buffer_load_dwordx4 v88, s[68:71], s43 offen sc1 lds
    buffer_load_dwordx4 v88, s[68:71], s43 offen offset:1024 sc1 lds
    s_add_u32 s8, s16, 720896
    s_addc_u32 s9, s17, 0
    s_mov_b32 s10, 9600000
    s_mov_b32 s11, 0x20000
    v_mov_b32 v92, 0
    v_lshlrev_b32 v90, 2, v0
    ds_write_b32 v90, v92 offset:0
    v_and_b32 v88, 15, v15
    v_add_u32 v80, s39, v88
    v_mul_u32_u24 v80, 12, v80
    v_add_u32 v81, 192, v80
    v_lshrrev_b32 v89, 4, v0
    v_lshlrev_b32 v105, 6, v89
    v_lshlrev_b32 v89, 4, v89
    s_mov_b32 s43, 38400
    v_mul_lo_u32 v90, v89, s43
    v_add_u32 v82, v80, v90
    v_mov_b32 v84, 0x80000000
    v_mov_b32 v85, 1
    v_mul_u32_u24 v87, s43, v0
    v_lshlrev_b32 v104, 2, v0
    v_lshlrev_b32 v106, 3, v0
    s_lshl_b32 s43, s18, 9
    v_mov_b32 v107, s43
    v_lshrrev_b32 v89, 4, v15
    v_lshl_add_u32 v108, v89, 7, s43
    v_mov_b32 v110, 0
    v_mov_b32 v111, 0
    s_and_b32 s53, s2, 7
    s_lshl_b32 s53, s53, 12
    s_add_u32 s53, s53, 671744
    v_lshlrev_b32 v89, 7, v0
    v_lshl_add_u32 v91, v0, 4, s53
    s_mov_b32 s43, 0
    s_mov_b64 s[46:47], -1
    s_mov_b64 s[58:59], -1
K2_poll:
    s_mov_b64 exec, s[46:47]
    s_cbranch_execz K2_poll_a
    global_load_dword v92, v91, s[16:17] sc1
K2_poll_a:
    s_mov_b64 exec, s[58:59]
    s_cbranch_execz K2_poll_b
    global_load_dwordx2 v[94:95], v89, s[56:57] sc1
K2_poll_b:
    s_mov_b64 exec, -1
    s_add_u32 s43, s43, 1
    s_cmp_gt_u32 s43, 8000000
    s_cbranch_scc1 K2_end
    s_waitcnt vmcnt(0)
    v_cmp_ne_u32 s[46:47], s3, v92
    v_cmp_ne_u32 s[58:59], s3, v95
    s_or_b64 vcc, s[46:47], s[58:59]
    s_cbranch_scc1 K2_poll
    v_mov_b32 v86, v94
    s_branch K2_pass_body
    s_nop 0
    s_nop 0
    s_nop 0
    s_nop 0
    s_nop 0
    s_nop 0
    s_nop 0
K2_pass:
    v_lshl_add_u32 v0, s18, 6, v15
    v_lshlrev_b32 v89, 7, v0
    global_load_dword v86, v89, s[56:57] sc1
    v_mov_b32 v92, 0
    v_lshlrev_b32 v90, 2, v0
    ds_write_b32 v90, v92 offset:0
    v_mov_b32 v93, 0
    v_mov_b32 v94, 0
    v_mov_b32 v95, 0
    v_lshlrev_b32 v90, 4, v15
    v_and_b32 v91, 48, v90
    v_add_u32 v91, 122368, v91
    ds_write_b128 v91, v[92:95]
    v_lshl_add_u32 v90, v0, 4, s50
    v_mov_b32 v96, 0xffff0000
    v_mov_b32 v97, 0xffff0000
    v_mov_b32 v98, 0xffff0000
    v_mov_b32 v99, 0xffff0000
    ds_write_b128 v90, v[96:99] offset:0
    ds_write_b128 v90, v[96:99] offset:4096
    ds_write_b128 v90, v[96:99] offset:8192
    ds_write_b128 v90, v[96:99] offset:12288
    ds_write_b128 v90, v[96:99] offset:16384
    v_and_b32 v88, 15, v15
    v_add_u32 v80, s39, v88
    v_mul_u32_u24 v80, 12, v80
    v_add_u32 v81, 192, v80
    v_lshrrev_b32 v89, 4, v0
    v_lshlrev_b32 v105, 6, v89
    v_lshlrev_b32 v89, 4, v89
    s_mov_b32 s43, 38400
    v_mul_lo_u32 v90, v89, s43
    v_add_u32 v82, v80, v90
    v_mov_b32 v84, 0x80000000
    v_mov_b32 v85, 1
    v_mul_u32_u24 v87, s43, v0
    v_lshlrev_b32 v104, 2, v0
    v_lshlrev_b32 v106, 3, v0
    s_lshl_b32 s43, s18, 9
    v_mov_b32 v107, s43
    v_lshrrev_b32 v89, 4, v15
    v_lshl_add_u32 v108, v89, 7, s43
    v_mov_b32 v110, 0
    v_mov_b32 v111, 0
    v_subrev_u32 v89, s40, v0
    v_cmp_gt_u32 vcc, s41, v89
    s_nop 0
    s_waitcnt vmcnt(0)
    v_cndmask_b32 v86, 0, v86, vcc
K2_pass_body:
    s_mul_i32 s53, s39, 12
    s_add_u32 s43, s53, 192
    s_add_u32 s53, s53, 384
    v_cmp_lt_u32_sdwa vcc, s43, v86 src0_sel:DWORD src1_sel:WORD_1
    v_cmp_lt_u32_sdwa s[46:47], s53, v86 src0_sel:DWORD src1_sel:WORD_1
    ds_write_b32 v104, v86 offset:3072
    ds_write_b64 v106, v[110:111] offset:4096
    v_mbcnt_lo_u32_b32 v88, vcc_lo, 0
    v_mbcnt_hi_u32_b32 v88, vcc_hi, v88
    s_bcnt1_i32_b64 s42, vcc
    v_and_b32 v89, 3, v88
    v_lshrrev_b32 v88, 2, v88
    v_lshl_add_u32 v88, v89, 4, v88
    v_lshl_add_u32 v88, v88, 3, v107
    s_mov_b64 exec, vcc
    ds_write_b64 v88, v[86:87] offset:4096
    s_mov_b64 exec, -1
    ds_read_b128 v[96:99], v108 offset:4096
    ds_read_b128 v[100:103], v108 offset:4112
    ds_read_b128 v[112:115], v105 offset:3072
    ds_read_b128 v[116:119], v105 offset:3088
    ds_read_b128 v[120:123], v105 offset:3104
    ds_read_b128 v[124:127], v105 offset:3120
    s_add_u32 s42, s42, 3
    s_lshr_b32 s42, s42, 2
    s_cmp_lg_u64 s[46:47], 0
    s_cselect_b32 s48, 2, 0
    s_waitcnt lgkmcnt(4)
    s_cmp_gt_u32 s42, 0
    v_cmp_lt_u32_sdwa vcc, v81, v96 src0_sel:DWORD src1_sel:WORD_1
    s_cbranch_scc0 K2_s1done
    v_add_u32_sdwa v90, v81, v96 dst_sel:DWORD dst_unused:UNUSED_PAD src0_sel:DWORD src1_sel:WORD_0
    v_add_u32 v90, v90, v97
    v_cndmask_b32 v90, v84, v90, vcc
    buffer_load_dwordx3 v[192:194], v90, s[8:11], 0 offen sc1
    s_cmp_gt_u32 s42, 1
    v_cmp_lt_u32_sdwa vcc, v81, v98 src0_sel:DWORD src1_sel:WORD_1
    s_cbranch_scc0 K2_s1done
    v_add_u32_sdwa v90, v81, v98 dst_sel:DWORD dst_unused:UNUSED_PAD src0_sel:DWORD src1_sel:WORD_0
    v_add_u32 v90, v90, v99
    v_cndmask_b32 v90, v84, v90, vcc
    buffer_load_dwordx3 v[196:198], v90, s[8:11], 0 offen sc1
    s_cmp_gt_u32 s42, 2
    v_cmp_lt_u32_sdwa vcc, v81, v100 src0_sel:DWORD src1_sel:WORD_1
    s_cbranch_scc0 K2_s1done
    v_add_u32_sdwa v90, v81, v100 dst_sel:DWORD dst_unused:UNUSED_PAD src0_sel:DWORD src1_sel:WORD_0
    v_add_u32 v90, v90, v101
    v_cndmask_b32 v90, v84, v90, vcc
    buffer_load_dwordx3 v[200:202], v90, s[8:11], 0 offen sc1
    s_cmp_gt_u32 s42, 3
    v_cmp_lt_u32_sdwa vcc, v81, v102 src0_sel:DWORD src1_sel:WORD_1
    s_cbranch_scc0 K2_s1done
    v_add_u32_sdwa v90, v81, v102 dst_sel:DWORD dst_unused:UNUSED_PAD src0_sel:DWORD src1_sel:WORD_0
    v_add_u32 v90, v90, v103
    v_cndmask_b32_e64 v90, v84, v90, vcc
    buffer_load_dwordx3 v[204:206], v90, s[8:11], 0 offen sc1
    s_cmp_gt_u32 s42, 4
    s_cbranch_scc0 K2_s1done
    ds_read_b64 v[96:97], v108 offset:4128
    s_waitcnt lgkmcnt(0)
    v_cmp_lt_u32_sdwa vcc, v81, v96 src0_sel:DWORD src1_sel:WORD_1
    v_add_u32_sdwa v90, v81, v96 dst_sel:DWORD dst_unused:UNUSED_PAD src0_sel:DWORD src1_sel:WORD_0
    v_add_u32 v90, v90, v97
    v_cndmask_b32_e64 v90, v84, v90, vcc
    buffer_load_dwordx3 v[208:210], v90, s[8:11], 0 offen sc1
    s_cmp_gt_u32 s42, 5
    s_cbranch_scc0 K2_s1done
    ds_read_b64 v[96:97], v108 offset:4136
    s_waitcnt lgkmcnt(0)
    v_cmp_lt_u32_sdwa vcc, v81, v96 src0_sel:DWORD src1_sel:WORD_1
    v_add_u32_sdwa v90, v81, v96 dst_sel:DWORD dst_unused:UNUSED_PAD src0_sel:DWORD src1_sel:WORD_0
    v_add_u32 v90, v90, v97
    v_cndmask_b32 v90, v84, v90, vcc
    buffer_load_dwordx3 v[212:214], v90, s[8:11], 0 offen sc1
    s_cmp_gt_u32 s42, 6
    s_cbranch_scc0 K2_s1done
    ds_read_b64 v[96:97], v108 offset:4144
    s_waitcnt lgkmcnt(0)
    v_cmp_lt_u32_sdwa vcc, v81, v96 src0_sel:DWORD src1_sel:WORD_1
    v_add_u32_sdwa v90, v81, v96 dst_sel:DWORD dst_unused:UNUSED_PAD src0_sel:DWORD src1_sel:WORD_0
    v_add_u32 v90, v90, v97
    v_cndmask_b32 v90, v84, v90, vcc
    buffer_load_dwordx3 v[216:218], v90, s[8:11], 0 offen sc1
    s_cmp_gt_u32 s42, 7
    s_cbranch_scc0 K2_s1done
    ds_read_b64 v[96:97], v108 offset:4152
    s_waitcnt lgkmcnt(0)
    v_cmp_lt_u32_sdwa vcc, v81, v96 src0_sel:DWORD src1_sel:WORD_1
    v_add_u32_sdwa v90, v81, v96 dst_sel:DWORD dst_unused:UNUSED_PAD src0_sel:DWORD src1_sel:WORD_0
    v_add_u32 v90, v90, v97
    v_cndmask_b32 v90, v84, v90, vcc
    buffer_load_dwordx3 v[220:222], v90, s[8:11], 0 offen sc1
    s_cmp_gt_u32 s42, 8
    s_cbranch_scc0 K2_s1done
    ds_read_b64 v[96:97], v108 offset:4160
    s_waitcnt lgkmcnt(0)
    v_cmp_lt_u32_sdwa vcc, v81, v96 src0_sel:DWORD src1_sel:WORD_1
    v_add_u32_sdwa v90, v81, v96 dst_sel:DWORD dst_unused:UNUSED_PAD src0_sel:DWORD src1_sel:WORD_0
    v_add_u32 v90, v90, v97
    v_cndmask_b32_e64 v90, v84, v90, vcc
    buffer_load_dwordx3 v[224:226], v90, s[8:11], 0 offen sc1
    s_cmp_gt_u32 s42, 9
    s_cbranch_scc0 K2_s1done
    ds_read_b64 v[96:97], v108 offset:4168
    s_waitcnt lgkmcnt(0)
    v_cmp_lt_u32_sdwa vcc, v81, v96 src0_sel:DWORD src1_sel:WORD_1
    v_add_u32_sdwa v90, v81, v96 dst_sel:DWORD dst_unused:UNUSED_PAD src0_sel:DWORD src1_sel:WORD_0
    v_add_u32 v90, v90, v97
    v_cndmask_b32 v90, v84, v90, vcc
    buffer_load_dwordx3 v[228:230], v90, s[8:11], 0 offen sc1
    s_cmp_gt_u32 s42, 10
    s_cbranch_scc0 K2_s1done
    ds_read_b64 v[96:97], v108 offset:4176
    s_waitcnt lgkmcnt(0)
    v_cmp_lt_u32_sdwa vcc, v81, v96 src0_sel:DWORD src1_sel:WORD_1
    v_add_u32_sdwa v90, v81, v96 dst_sel:DWORD dst_unused:UNUSED_PAD src0_sel:DWORD src1_sel:WORD_0
    v_add_u32 v90, v90, v97
    v_cndmask_b32_e64 v90, v84, v90, vcc
    buffer_load_dwordx3 v[232:234], v90, s[8:11], 0 offen sc1
    s_cmp_gt_u32 s42, 11
    s_cbranch_scc0 K2_s1done
    ds_read_b64 v[96:97], v108 offset:4184
    s_waitcnt lgkmcnt(0)
    v_cmp_lt_u32_sdwa vcc, v81, v96 src0_sel:DWORD src1_sel:WORD_1
    v_add_u32_sdwa v90, v81, v96 dst_sel:DWORD dst_unused:UNUSED_PAD src0_sel:DWORD src1_sel:WORD_0
    v_add_u32 v90, v90, v97
    v_cndmask_b32 v90, v84, v90, vcc
    buffer_load_dwordx3 v[236:238], v90, s[8:11], 0 offen sc1
    s_cmp_gt_u32 s42, 12
    s_cbranch_scc0 K2_s1done
    ds_read_b64 v[96:97], v108 offset:4192
    s_waitcnt lgkmcnt(0)
    v_cmp_lt_u32_sdwa vcc, v81, v96 src0_sel:DWORD src1_sel:WORD_1
    v_add_u32_sdwa v90, v81, v96 dst_sel:DWORD dst_unused:UNUSED_PAD src0_sel:DWORD src1_sel:WORD_0
    v_add_u32 v90, v90, v97
    v_cndmask_b32 v90, v84, v90, vcc
    buffer_load_dwordx3 v[240:242], v90, s[8:11], 0 offen sc1
    s_cmp_gt_u32 s42, 13
    s_cbranch_scc0 K2_s1done
    ds_read_b64 v[96:97], v108 offset:4200
    s_waitcnt lgkmcnt(0)
    v_cmp_lt_u32_sdwa vcc, v81, v96 src0_sel:DWORD src1_sel:WORD_1
    v_add_u32_sdwa v90, v81, v96 dst_sel:DWORD dst_unused:UNUSED_PAD src0_sel:DWORD src1_sel:WORD_0
    v_add_u32 v90, v90, v97
    v_cndmask_b32 v90, v84, v90, vcc
    buffer_load_dwordx3 v[244:246], v90, s[8:11], 0 offen sc1
    s_cmp_gt_u32 s42, 14
    s_cbranch_scc0 K2_s1done
    ds_read_b64 v[96:97], v108 offset:4208
    s_waitcnt lgkmcnt(0)
    v_cmp_lt_u32_sdwa vcc, v81, v96 src0_sel:DWORD src1_sel:WORD_1
    v_add_u32_sdwa v90, v81, v96 dst_sel:DWORD dst_unused:UNUSED_PAD src0_sel:DWORD src1_sel:WORD_0
    v_add_u32 v90, v90, v97
    v_cndmask_b32_e64 v90, v84, v90, vcc
    buffer_load_dwordx3 v[248:250], v90, s[8:11], 0 offen sc1
    s_cmp_gt_u32 s42, 15
    s_cbranch_scc0 K2_s1done
    ds_read_b64 v[96:97], v108 offset:4216
    s_waitcnt lgkmcnt(0)
    v_cmp_lt_u32_sdwa vcc, v81, v96 src0_sel:DWORD src1_sel:WORD_1
    v_add_u32_sdwa v90, v81, v96 dst_sel:DWORD dst_unused:UNUSED_PAD src0_sel:DWORD src1_sel:WORD_0
    v_add_u32 v90, v90, v97
    v_cndmask_b32_e64 v90, v84, v90, vcc
    buffer_load_dwordx3 v[252:254], v90, s[8:11], 0 offen sc1
K2_s1done:
    s_mov_b32 s43, 0
    s_waitcnt lgkmcnt(0)
    v_cmp_lt_u32_sdwa vcc, v80, v112 src0_sel:DWORD src1_sel:WORD_1
    v_cmp_lt_u32_sdwa s[46:47], v80, v113 src0_sel:DWORD src1_sel:WORD_1
    v_add_u32_sdwa v90, v82, v112 dst_sel:DWORD dst_unused:UNUSED_PAD src0_sel:DWORD src1_sel:WORD_0
    v_add_u32_sdwa v91, v82, v113 dst_sel:DWORD dst_unused:UNUSED_PAD src0_sel:DWORD src1_sel:WORD_0
    v_cndmask_b32_e64 v90, v84, v90, vcc
    v_cndmask_b32 v91, v84, v91, s[46:47]
    s_add_u32 s53, s43, 38400
    buffer_load_dwordx3 v[128:130], v90, s[8:11], s43 offen sc1
    buffer_load_dwordx3 v[132:134], v91, s[8:11], s53 offen sc1
    s_add_u32 s43, s43, 76800
    v_cmp_lt_u32_sdwa vcc, v80, v114 src0_sel:DWORD src1_sel:WORD_1
    v_cmp_lt_u32_sdwa s[46:47], v80, v115 src0_sel:DWORD src1_sel:WORD_1
    v_add_u32_sdwa v90, v82, v114 dst_sel:DWORD dst_unused:UNUSED_PAD src0_sel:DWORD src1_sel:WORD_0
    v_add_u32_sdwa v91, v82, v115 dst_sel:DWORD dst_unused:UNUSED_PAD src0_sel:DWORD src1_sel:WORD_0
    v_cndmask_b32_e64 v90, v84, v90, vcc
    v_cndmask_b32 v91, v84, v91, s[46:47]
    s_add_u32 s53, s43, 38400
    buffer_load_dwordx3 v[136:138], v90, s[8:11], s43 offen sc1
    buffer_load_dwordx3 v[140:142], v91, s[8:11], s53 offen sc1
    s_add_u32 s43, s43, 76800
    v_cmp_lt_u32_sdwa vcc, v80, v116 src0_sel:DWORD src1_sel:WORD_1
    v_cmp_lt_u32_sdwa s[46:47], v80, v117 src0_sel:DWORD src1_sel:WORD_1
    v_add_u32_sdwa v90, v82, v116 dst_sel:DWORD dst_unused:UNUSED_PAD src0_sel:DWORD src1_sel:WORD_0
    v_add_u32_sdwa v91, v82, v117 dst_sel:DWORD dst_unused:UNUSED_PAD src0_sel:DWORD src1_sel:WORD_0
    v_cndmask_b32_e64 v90, v84, v90, vcc
    v_cndmask_b32 v91, v84, v91, s[46:47]
    s_add_u32 s53, s43, 38400
    buffer_load_dwordx3 v[144:146], v90, s[8:11], s43 offen sc1
    buffer_load_dwordx3 v[148:150], v91, s[8:11], s53 offen sc1
    s_add_u32 s43, s43, 76800
    v_cmp_lt_u32_sdwa vcc, v80, v118 src0_sel:DWORD src1_sel:WORD_1
    v_cmp_lt_u32_sdwa s[46:47], v80, v119 src0_sel:DWORD src1_sel:WORD_1
    v_add_u32_sdwa v90, v82, v118 dst_sel:DWORD dst_unused:UNUSED_PAD src0_sel:DWORD src1_sel:WORD_0
    v_add_u32_sdwa v91, v82, v119 dst_sel:DWORD dst_unused:UNUSED_PAD src0_sel:DWORD src1_sel:WORD_0
    v_cndmask_b32_e64 v90, v84, v90, vcc
    v_cndmask_b32 v91, v84, v91, s[46:47]
    s_add_u32 s53, s43, 38400
    buffer_load_dwordx3 v[152:154], v90, s[8:11], s43 offen sc1
    buffer_load_dwordx3 v[156:158], v91, s[8:11], s53 offen sc1
    s_add_u32 s43, s43, 76800
    v_cmp_lt_u32_sdwa vcc, v80, v120 src0_sel:DWORD src1_sel:WORD_1
    v_cmp_lt_u32_sdwa s[46:47], v80, v121 src0_sel:DWORD src1_sel:WORD_1
    v_add_u32_sdwa v90, v82, v120 dst_sel:DWORD dst_unused:UNUSED_PAD src0_sel:DWORD src1_sel:WORD_0
    v_add_u32_sdwa v91, v82, v121 dst_sel:DWORD dst_unused:UNUSED_PAD src0_sel:DWORD src1_sel:WORD_0
    v_cndmask_b32_e64 v90, v84, v90, vcc
    v_cndmask_b32 v91, v84, v91, s[46:47]
    s_add_u32 s53, s43, 38400
    buffer_load_dwordx3 v[160:162], v90, s[8:11], s43 offen sc1
    buffer_load_dwordx3 v[164:166], v91, s[8:11], s53 offen sc1
    s_add_u32 s43, s43, 76800
    v_cmp_lt_u32_sdwa vcc, v80, v122 src0_sel:DWORD src1_sel:WORD_1
    v_cmp_lt_u32_sdwa s[46:47], v80, v123 src0_sel:DWORD src1_sel:WORD_1
    v_add_u32_sdwa v90, v82, v122 dst_sel:DWORD dst_unused:UNUSED_PAD src0_sel:DWORD src1_sel:WORD_0
    v_add_u32_sdwa v91, v82, v123 dst_sel:DWORD dst_unused:UNUSED_PAD src0_sel:DWORD src1_sel:WORD_0
    v_cndmask_b32_e64 v90, v84, v90, vcc
    v_cndmask_b32 v91, v84, v91, s[46:47]
    s_add_u32 s53, s43, 38400
    buffer_load_dwordx3 v[168:170], v90, s[8:11], s43 offen sc1
    buffer_load_dwordx3 v[172:174], v91, s[8:11], s53 offen sc1
    s_add_u32 s43, s43, 76800
    v_cmp_lt_u32_sdwa vcc, v80, v124 src0_sel:DWORD src1_sel:WORD_1
    v_cmp_lt_u32_sdwa s[46:47], v80, v125 src0_sel:DWORD src1_sel:WORD_1
    v_add_u32_sdwa v90, v82, v124 dst_sel:DWORD dst_unused:UNUSED_PAD src0_sel:DWORD src1_sel:WORD_0
    v_add_u32_sdwa v91, v82, v125 dst_sel:DWORD dst_unused:UNUSED_PAD src0_sel:DWORD src1_sel:WORD_0
    v_cndmask_b32_e64 v90, v84, v90, vcc
    v_cndmask_b32 v91, v84, v91, s[46:47]
    s_add_u32 s53, s43, 38400
    buffer_load_dwordx3 v[176:178], v90, s[8:11], s43 offen sc1
    buffer_load_dwordx3 v[180:182], v91, s[8:11], s53 offen sc1
    s_add_u32 s43, s43, 76800
    v_cmp_lt_u32_sdwa vcc, v80, v126 src0_sel:DWORD src1_sel:WORD_1
    v_cmp_lt_u32_sdwa s[46:47], v80, v127 src0_sel:DWORD src1_sel:WORD_1
    v_add_u32_sdwa v90, v82, v126 dst_sel:DWORD dst_unused:UNUSED_PAD src0_sel:DWORD src1_sel:WORD_0
    v_add_u32_sdwa v91, v82, v127 dst_sel:DWORD dst_unused:UNUSED_PAD src0_sel:DWORD src1_sel:WORD_0
    v_cndmask_b32 v90, v84, v90, vcc
    v_cndmask_b32 v91, v84, v91, s[46:47]
    s_add_u32 s53, s43, 38400
    buffer_load_dwordx3 v[184:186], v90, s[8:11], s43 offen sc1
    buffer_load_dwordx3 v[188:190], v91, s[8:11], s53 offen sc1
    s_add_u32 s43, s43, 76800
    s_barrier
    s_cmp_eq_u32 s54, 0
    s_cbranch_scc0 K2_havew
    s_mov_b32 s54, 1
    v_lshlrev_b32 v90, 4, v15
    v_add_u32 v90, 122560, v90
    ds_read_b128 a[0:3], v90 offset:0
    ds_read_b128 a[4:7], v90 offset:1024
    ds_read_b128 a[8:11], v90 offset:2048
    ds_read_b128 a[12:15], v90 offset:3072
    ds_read_b128 a[16:19], v90 offset:4096
    ds_read_b128 a[20:23], v90 offset:5120
    ds_read_b128 a[24:27], v90 offset:6144
    ds_read_b128 a[28:31], v90 offset:7168
    ds_read_b128 a[32:35], v90 offset:8192
    ds_read_b128 a[36:39], v90 offset:9216
    ds_read_b128 a[40:43], v90 offset:10240
    ds_read_b128 a[44:47], v90 offset:11264
    ds_read_b128 a[48:51], v90 offset:12288
    ds_read_b128 a[52:55], v90 offset:13312
    ds_read_b128 a[56:59], v90 offset:14336
    ds_read_b128 a[60:63], v90 offset:15360
    ds_read_b128 a[64:67], v90 offset:16384
    ds_read_b128 a[68:71], v90 offset:17408
    ds_read_b128 a[72:75], v90 offset:18432
    ds_read_b128 a[76:79], v90 offset:19456
    ds_read_b128 a[80:83], v90 offset:20480
    ds_read_b128 a[84:87], v90 offset:21504
    ds_read_b128 a[88:91], v90 offset:22528
    ds_read_b128 a[92:95], v90 offset:23552
    ds_read_b128 a[96:99], v90 offset:24576
    ds_read_b128 a[100:103], v90 offset:25600
    ds_read_b128 a[104:107], v90 offset:26624
    ds_read_b128 a[108:111], v90 offset:27648
    ds_read_b128 a[112:115], v90 offset:28672
    ds_read_b128 a[116:119], v90 offset:29696
    ds_read_b128 a[120:123], v90 offset:30720
    ds_read_b128 a[124:127], v90 offset:31744
    ds_read_b128 a[128:131], v90 offset:32768
    ds_read_b128 a[132:135], v90 offset:33792
    ds_read_b128 a[136:139], v90 offset:34816
    ds_read_b128 a[140:143], v90 offset:35840
    ds_read_b128 a[144:147], v90 offset:36864
    ds_read_b128 a[148:151], v90 offset:37888
    ds_read_b128 a[152:155], v90 offset:38912
    ds_read_b128 a[156:159], v90 offset:39936
K2_havew:
    s_waitcnt vmcnt(16)
    s_cmp_gt_u32 s42, 0
    s_cbranch_scc0 K2_xs_5
    v_cmpx_ne_u32 vcc, 0, v194
    v_lshlrev_b32_sdwa v90, 2, v194 dst_sel:DWORD dst_unused:UNUSED_PAD src0_sel:DWORD src1_sel:BYTE_1
    ds_add_rtn_u32 v195, v90, v85 offset:0
    s_mov_b64 exec, -1
    s_cmp_gt_u32 s42, 1
    s_cbranch_scc0 K2_xs_5
    v_cmpx_ne_u32 vcc, 0, v198
    v_lshlrev_b32_sdwa v90, 2, v198 dst_sel:DWORD dst_unused:UNUSED_PAD src0_sel:DWORD src1_sel:BYTE_1
    ds_add_rtn_u32 v199, v90, v85 offset:0
    s_mov_b64 exec, -1
    s_cmp_gt_u32 s42, 2
    s_cbranch_scc0 K2_xs_5
    v_cmpx_ne_u32 vcc, 0, v202
    v_lshlrev_b32_sdwa v90, 2, v202 dst_sel:DWORD dst_unused:UNUSED_PAD src0_sel:DWORD src1_sel:BYTE_1
    ds_add_rtn_u32 v203, v90, v85 offset:0
    s_mov_b64 exec, -1
    s_cmp_gt_u32 s42, 3
    s_cbranch_scc0 K2_xs_5
    v_cmpx_ne_u32 vcc, 0, v206
    v_lshlrev_b32_sdwa v90, 2, v206 dst_sel:DWORD dst_unused:UNUSED_PAD src0_sel:DWORD src1_sel:BYTE_1
    ds_add_rtn_u32 v207, v90, v85 offset:0
    s_mov_b64 exec, -1
    s_cmp_gt_u32 s42, 4
    s_cbranch_scc0 K2_xs_5
    v_cmpx_ne_u32 vcc, 0, v210
    v_lshlrev_b32_sdwa v90, 2, v210 dst_sel:DWORD dst_unused:UNUSED_PAD src0_sel:DWORD src1_sel:BYTE_1
    ds_add_rtn_u32 v211, v90, v85 offset:0
    s_mov_b64 exec, -1
    s_cmp_gt_u32 s42, 5
    s_cbranch_scc0 K2_xs_5
    v_cmpx_ne_u32 vcc, 0, v214
    v_lshlrev_b32_sdwa v90, 2, v214 dst_sel:DWORD dst_unused:UNUSED_PAD src0_sel:DWORD src1_sel:BYTE_1
    ds_add_rtn_u32 v215, v90, v85 offset:0
    s_mov_b64 exec, -1
    s_cmp_gt_u32 s42, 6
    s_cbranch_scc0 K2_xs_5
    v_cmpx_ne_u32 vcc, 0, v218
    v_lshlrev_b32_sdwa v90, 2, v218 dst_sel:DWORD dst_unused:UNUSED_PAD src0_sel:DWORD src1_sel:BYTE_1
    ds_add_rtn_u32 v219, v90, v85 offset:0
    s_mov_b64 exec, -1
    s_cmp_gt_u32 s42, 7
    s_cbranch_scc0 K2_xs_5
    v_cmpx_ne_u32 vcc, 0, v222
    v_lshlrev_b32_sdwa v90, 2, v222 dst_sel:DWORD dst_unused:UNUSED_PAD src0_sel:DWORD src1_sel:BYTE_1
    ds_add_rtn_u32 v223, v90, v85 offset:0
    s_mov_b64 exec, -1
    s_cmp_gt_u32 s42, 8
    s_cbranch_scc0 K2_xs_5
    v_cmpx_ne_u32 vcc, 0, v226
    v_lshlrev_b32_sdwa v90, 2, v226 dst_sel:DWORD dst_unused:UNUSED_PAD src0_sel:DWORD src1_sel:BYTE_1
    ds_add_rtn_u32 v227, v90, v85 offset:0
    s_mov_b64 exec, -1
    s_cmp_gt_u32 s42, 9
    s_cbranch_scc0 K2_xs_5
    v_cmpx_ne_u32 vcc, 0, v230
    v_lshlrev_b32_sdwa v90, 2, v230 dst_sel:DWORD dst_unused:UNUSED_PAD src0_sel:DWORD src1_sel:BYTE_1
    ds_add_rtn_u32 v231, v90, v85 offset:0
    s_mov_b64 exec, -1
    s_cmp_gt_u32 s42, 10
    s_cbranch_scc0 K2_xs_5
    v_cmpx_ne_u32 vcc, 0, v234
    v_lshlrev_b32_sdwa v90, 2, v234 dst_sel:DWORD dst_unused:UNUSED_PAD src0_sel:DWORD src1_sel:BYTE_1
    ds_add_rtn_u32 v235, v90, v85 offset:0
    s_mov_b64 exec, -1
    s_cmp_gt_u32 s42, 11
    s_cbranch_scc0 K2_xs_5
    v_cmpx_ne_u32 vcc, 0, v238
    v_lshlrev_b32_sdwa v90, 2, v238 dst_sel:DWORD dst_unused:UNUSED_PAD src0_sel:DWORD src1_sel:BYTE_1
    ds_add_rtn_u32 v239, v90, v85 offset:0
    s_mov_b64 exec, -1
    s_cmp_gt_u32 s42, 12
    s_cbranch_scc0 K2_xs_5
    v_cmpx_ne_u32 vcc, 0, v242
    v_lshlrev_b32_sdwa v90, 2, v242 dst_sel:DWORD dst_unused:UNUSED_PAD src0_sel:DWORD src1_sel:BYTE_1
    ds_add_rtn_u32 v243, v90, v85 offset:0
    s_mov_b64 exec, -1
    s_cmp_gt_u32 s42, 13
    s_cbranch_scc0 K2_xs_5
    v_cmpx_ne_u32 vcc, 0, v246
    v_lshlrev_b32_sdwa v90, 2, v246 dst_sel:DWORD dst_unused:UNUSED_PAD src0_sel:DWORD src1_sel:BYTE_1
    ds_add_rtn_u32 v247, v90, v85 offset:0
    s_mov_b64 exec, -1
    s_cmp_gt_u32 s42, 14
    s_cbranch_scc0 K2_xs_5
    v_cmpx_ne_u32 vcc, 0, v250
    v_lshlrev_b32_sdwa v90, 2, v250 dst_sel:DWORD dst_unused:UNUSED_PAD src0_sel:DWORD src1_sel:BYTE_1
    ds_add_rtn_u32 v251, v90, v85 offset:0
    s_mov_b64 exec, -1
    s_cmp_gt_u32 s42, 15
    s_cbranch_scc0 K2_xs_5
    v_cmpx_ne_u32 vcc, 0, v254
    v_lshlrev_b32_sdwa v90, 2, v254 dst_sel:DWORD dst_unused:UNUSED_PAD src0_sel:DWORD src1_sel:BYTE_1
    ds_add_rtn_u32 v255, v90, v85 offset:0
    s_mov_b64 exec, -1
K2_xs_5:
    s_waitcnt vmcnt(14)
    v_cmpx_ne_u32 vcc, 0, v130
    v_lshlrev_b32_sdwa v90, 2, v130 dst_sel:DWORD dst_unused:UNUSED_PAD src0_sel:DWORD src1_sel:BYTE_1
    ds_add_rtn_u32 v131, v90, v85 offset:0
    s_mov_b64 exec, -1
    v_cmpx_ne_u32 vcc, 0, v134
    v_lshlrev_b32_sdwa v90, 2, v134 dst_sel:DWORD dst_unused:UNUSED_PAD src0_sel:DWORD src1_sel:BYTE_1
    ds_add_rtn_u32 v135, v90, v85 offset:0
    s_mov_b64 exec, -1
    s_waitcnt vmcnt(12)
    v_cmpx_ne_u32 vcc, 0, v138
    v_lshlrev_b32_sdwa v90, 2, v138 dst_sel:DWORD dst_unused:UNUSED_PAD src0_sel:DWORD src1_sel:BYTE_1
    ds_add_rtn_u32 v139, v90, v85 offset:0
    s_mov_b64 exec, -1
    v_cmpx_ne_u32 vcc, 0, v142
    v_lshlrev_b32_sdwa v90, 2, v142 dst_sel:DWORD dst_unused:UNUSED_PAD src0_sel:DWORD src1_sel:BYTE_1
    ds_add_rtn_u32 v143, v90, v85 offset:0
    s_mov_b64 exec, -1
    s_waitcnt vmcnt(10)
    v_cmpx_ne_u32 vcc, 0, v146
    v_lshlrev_b32_sdwa v90, 2, v146 dst_sel:DWORD dst_unused:UNUSED_PAD src0_sel:DWORD src1_sel:BYTE_1
    ds_add_rtn_u32 v147, v90, v85 offset:0
    s_mov_b64 exec, -1
    v_cmpx_ne_u32 vcc, 0, v150
    v_lshlrev_b32_sdwa v90, 2, v150 dst_sel:DWORD dst_unused:UNUSED_PAD src0_sel:DWORD src1_sel:BYTE_1
    ds_add_rtn_u32 v151, v90, v85 offset:0
    s_mov_b64 exec, -1
    s_waitcnt vmcnt(8)
    v_cmpx_ne_u32 vcc, 0, v154
    v_lshlrev_b32_sdwa v90, 2, v154 dst_sel:DWORD dst_unused:UNUSED_PAD src0_sel:DWORD src1_sel:BYTE_1
    ds_add_rtn_u32 v155, v90, v85 offset:0
    s_mov_b64 exec, -1
    v_cmpx_ne_u32 vcc, 0, v158
    v_lshlrev_b32_sdwa v90, 2, v158 dst_sel:DWORD dst_unused:UNUSED_PAD src0_sel:DWORD src1_sel:BYTE_1
    ds_add_rtn_u32 v159, v90, v85 offset:0
    s_mov_b64 exec, -1
    s_waitcnt vmcnt(6)
    v_cmpx_ne_u32 vcc, 0, v162
    v_lshlrev_b32_sdwa v90, 2, v162 dst_sel:DWORD dst_unused:UNUSED_PAD src0_sel:DWORD src1_sel:BYTE_1
    ds_add_rtn_u32 v163, v90, v85 offset:0
    s_mov_b64 exec, -1
    v_cmpx_ne_u32 vcc, 0, v166
    v_lshlrev_b32_sdwa v90, 2, v166 dst_sel:DWORD dst_unused:UNUSED_PAD src0_sel:DWORD src1_sel:BYTE_1
    ds_add_rtn_u32 v167, v90, v85 offset:0
    s_mov_b64 exec, -1
    s_waitcnt vmcnt(4)
    v_cmpx_ne_u32 vcc, 0, v170
    v_lshlrev_b32_sdwa v90, 2, v170 dst_sel:DWORD dst_unused:UNUSED_PAD src0_sel:DWORD src1_sel:BYTE_1
    ds_add_rtn_u32 v171, v90, v85 offset:0
    s_mov_b64 exec, -1
    v_cmpx_ne_u32 vcc, 0, v174
    v_lshlrev_b32_sdwa v90, 2, v174 dst_sel:DWORD dst_unused:UNUSED_PAD src0_sel:DWORD src1_sel:BYTE_1
    ds_add_rtn_u32 v175, v90, v85 offset:0
    s_mov_b64 exec, -1
    s_waitcnt vmcnt(2)
    v_cmpx_ne_u32 vcc, 0, v178
    v_lshlrev_b32_sdwa v90, 2, v178 dst_sel:DWORD dst_unused:UNUSED_PAD src0_sel:DWORD src1_sel:BYTE_1
    ds_add_rtn_u32 v179, v90, v85 offset:0
    s_mov_b64 exec, -1
    v_cmpx_ne_u32 vcc, 0, v182
    v_lshlrev_b32_sdwa v90, 2, v182 dst_sel:DWORD dst_unused:UNUSED_PAD src0_sel:DWORD src1_sel:BYTE_1
    ds_add_rtn_u32 v183, v90, v85 offset:0
    s_mov_b64 exec, -1
    s_waitcnt vmcnt(0)
    v_cmpx_ne_u32 vcc, 0, v186
    v_lshlrev_b32_sdwa v90, 2, v186 dst_sel:DWORD dst_unused:UNUSED_PAD src0_sel:DWORD src1_sel:BYTE_1
    ds_add_rtn_u32 v187, v90, v85 offset:0
    s_mov_b64 exec, -1
    v_cmpx_ne_u32 vcc, 0, v190
    v_lshlrev_b32_sdwa v90, 2, v190 dst_sel:DWORD dst_unused:UNUSED_PAD src0_sel:DWORD src1_sel:BYTE_1
    ds_add_rtn_u32 v191, v90, v85 offset:0
    s_mov_b64 exec, -1
    v_and_b32 v90, 63, v15
    v_min_u32 v90, 24, v90
    v_lshlrev_b32 v90, 9, v90
    s_add_u32 s43, s101, 0
    buffer_load_dword v14, v90, s[4:7], s43 offen
    v_and_b32 v90, 63, v15
    v_min_u32 v90, 24, v90
    v_lshlrev_b32 v90, 9, v90
    s_add_u32 s43, s101, 128
    buffer_load_dword v14, v90, s[4:7], s43 offen
    v_lshlrev_b32 v96, 2, v0
    v_lshrrev_b32 v95, 3, v0
    s_movk_i32 s53, 192
    v_mul_u32_u24 v97, s53, v95
    v_lshlrev_b32 v95, 2, v95
    s_waitcnt lgkmcnt(0)
    s_barrier
    ds_read_b32 v88, v96 offset:0
    v_mul_u32_u24 v92, 37, v15
    v_lshrrev_b32 v92, 8, v92
    v_mad_i32_i24 v93, v92, -7, v15
    s_lshl_b32 s43, s18, 3
    v_add_lshl_u32 v93, v93, s43, 2
    v_and_b32 v94, 31, v15
    v_lshlrev_b32 v94, 2, v94
    v_mov_b32 v90, 0
    s_waitcnt lgkmcnt(0)
    v_mov_b32 v89, v88
    s_nop 1
    v_add_u32_dpp v89, v89, v89 row_shr:1 row_mask:0xf bank_mask:0xf bound_ctrl:0
    s_nop 1
    v_add_u32_dpp v89, v89, v89 row_shr:2 row_mask:0xf bank_mask:0xf bound_ctrl:0
    s_nop 1
    v_add_u32_dpp v89, v89, v89 row_shr:4 row_mask:0xf bank_mask:0xf bound_ctrl:0
    s_nop 1
    v_add_u32_dpp v89, v89, v89 row_shr:8 row_mask:0xf bank_mask:0xf bound_ctrl:0
    s_nop 1
    v_mov_b32_dpp v90, v89 row_newbcast:7 row_mask:0xf bank_mask:0xc
    v_sub_u32 v89, v89, v90
    v_sub_u32 v90, v89, v88
    v_add_u32 v90, v90, v97
    ds_write_b32 v96, v90 offset:1024
    s_cmp_eq_u32 s18, 3
    s_cselect_b32 s43, 192 - 128, 0
    s_sub_u32 s43, 192, s43
    v_cmp_lt_u32 vcc, s43, v89
    v_add_u32 v89, 31, v89
    v_lshrrev_b32 v89, 5, v89
    s_mov_b32 exec_lo, 0x80808080
    s_mov_b32 exec_hi, 0x80808080
    ds_write_b32 v95, v89 offset:2048
    s_mov_b64 exec, -1
    s_cbranch_vccz K2_noovf
    s_or_b32 s48, s48, 1
K2_noovf:
    s_cmp_eq_u32 s48, 0
    s_cbranch_scc1 K2_noflag
    v_mov_b32 v91, 122400
    v_mov_b32 v88, s48
    s_mov_b64 exec, 1
    ds_or_b32 v91, v88
    s_mov_b64 exec, -1
K2_noflag:
    v_mov_b32 v91, 122400
    s_waitcnt lgkmcnt(0)
    s_barrier
    ds_read_b32 v91, v91
    ds_read_b32 v88, v94 offset:2048
    v_lshlrev_b32_sdwa v90, 2, v130 dst_sel:DWORD dst_unused:UNUSED_PAD src0_sel:DWORD src1_sel:BYTE_1
    ds_read_b32 v96, v90 offset:1024
    v_lshlrev_b32_sdwa v90, 2, v134 dst_sel:DWORD dst_unused:UNUSED_PAD src0_sel:DWORD src1_sel:BYTE_1
    ds_read_b32 v97, v90 offset:1024
    v_lshlrev_b32_sdwa v90, 2, v138 dst_sel:DWORD dst_unused:UNUSED_PAD src0_sel:DWORD src1_sel:BYTE_1
    ds_read_b32 v98, v90 offset:1024
    v_lshlrev_b32_sdwa v90, 2, v142 dst_sel:DWORD dst_unused:UNUSED_PAD src0_sel:DWORD src1_sel:BYTE_1
    ds_read_b32 v99, v90 offset:1024
    v_lshlrev_b32_sdwa v90, 2, v146 dst_sel:DWORD dst_unused:UNUSED_PAD src0_sel:DWORD src1_sel:BYTE_1
    ds_read_b32 v100, v90 offset:1024
    v_lshlrev_b32_sdwa v90, 2, v150 dst_sel:DWORD dst_unused:UNUSED_PAD src0_sel:DWORD src1_sel:BYTE_1
    ds_read_b32 v101, v90 offset:1024
    v_lshlrev_b32_sdwa v90, 2, v154 dst_sel:DWORD dst_unused:UNUSED_PAD src0_sel:DWORD src1_sel:BYTE_1
    ds_read_b32 v102, v90 offset:1024
    v_lshlrev_b32_sdwa v90, 2, v158 dst_sel:DWORD dst_unused:UNUSED_PAD src0_sel:DWORD src1_sel:BYTE_1
    ds_read_b32 v103, v90 offset:1024
    v_lshlrev_b32_sdwa v90, 2, v162 dst_sel:DWORD dst_unused:UNUSED_PAD src0_sel:DWORD src1_sel:BYTE_1
    ds_read_b32 v104, v90 offset:1024
    v_lshlrev_b32_sdwa v90, 2, v166 dst_sel:DWORD dst_unused:UNUSED_PAD src0_sel:DWORD src1_sel:BYTE_1
    ds_read_b32 v105, v90 offset:1024
    v_lshlrev_b32_sdwa v90, 2, v170 dst_sel:DWORD dst_unused:UNUSED_PAD src0_sel:DWORD src1_sel:BYTE_1
    ds_read_b32 v106, v90 offset:1024
    v_lshlrev_b32_sdwa v90, 2, v174 dst_sel:DWORD dst_unused:UNUSED_PAD src0_sel:DWORD src1_sel:BYTE_1
    ds_read_b32 v107, v90 offset:1024
    v_lshlrev_b32_sdwa v90, 2, v178 dst_sel:DWORD dst_unused:UNUSED_PAD src0_sel:DWORD src1_sel:BYTE_1
    ds_read_b32 v108, v90 offset:1024
    v_lshlrev_b32_sdwa v90, 2, v182 dst_sel:DWORD dst_unused:UNUSED_PAD src0_sel:DWORD src1_sel:BYTE_1
    ds_read_b32 v109, v90 offset:1024
    v_lshlrev_b32_sdwa v90, 2, v186 dst_sel:DWORD dst_unused:UNUSED_PAD src0_sel:DWORD src1_sel:BYTE_1
    ds_read_b32 v110, v90 offset:1024
    v_lshlrev_b32_sdwa v90, 2, v190 dst_sel:DWORD dst_unused:UNUSED_PAD src0_sel:DWORD src1_sel:BYTE_1
    ds_read_b32 v111, v90 offset:1024
    s_waitcnt lgkmcnt(14)
    v_readfirstlane_b32 s48, v91
    v_cmp_lt_u32 vcc, 4, v88
    s_bitcmp1_b32 s48, 0
    s_cbranch_scc1 K2_overflow
    s_lshr_b32 s48, s48, 1
    s_or_b32 s49, s49, s48
    s_mov_b32 s43, 122432
    v_lshl_add_u32 v115, v15, 2, s43
    s_cmp_eq_u32 s63, 0
    s_cbranch_scc0 K2_keepmap
    s_mov_b32 s63, 1
    s_and_b32 s46, vcc_lo, 0xffffff
    s_andn2_b32 s47, 0xffffff, s46
    s_bcnt1_i32_b32 s43, s46
    v_mbcnt_lo_u32_b32 v112, s46, 0
    v_mbcnt_lo_u32_b32 v113, s47, 0
    v_add_u32 v113, s43, v113
    v_cndmask_b32 v112, v113, v112, vcc
    v_subrev_u32 v112, 1, v112
    v_mul_u32_u24 v113, 86, v112
    v_lshrrev_b32 v113, 8, v113
    v_mad_i32_i24 v114, v113, -3, v112
    v_lshl_add_u32 v113, v114, 3, v113
    v_add_u32 v113, 8, v113
    v_subrev_u32 v114, 18, v112
    v_cmp_gt_u32 vcc, 18, v112
    v_min_u32 v114, 5, v114
    s_nop 0
    v_cndmask_b32 v113, v114, v113, vcc
    v_cmp_eq_u32 vcc, 24, v15
    v_cmp_lt_u32 s[46:47], 24, v15
    v_mov_b32_e64 v114, 63
    v_cndmask_b32 v113, v113, 6, vcc
    v_cndmask_b32 v113, v113, v114, s[46:47]
    v_lshlrev_b32 v113, 2, v113
    s_mov_b32 exec_hi, 0
    ds_write_b32 v115, v113
    s_mov_b32 exec_hi, -1
    s_branch K2_gotmap
    s_nop 0
    s_nop 0
    s_nop 0
    s_nop 0
    s_nop 0
    s_nop 0
    s_nop 0
    s_nop 0
    s_nop 0
K2_keepmap:
    v_mov_b32 v113, 252
    s_mov_b32 exec_hi, 0
    ds_read_b32 v113, v115
    s_mov_b32 exec_hi, -1
    s_waitcnt lgkmcnt(0)
K2_gotmap:
    v_lshl_or_b32 v88, v88, 8, v15
    v_or_b32 v88, 0x80, v88
    ds_permute_b32 v112, v113, v88
    s_waitcnt lgkmcnt(0)
    ds_bpermute_b32 v86, v93, v112
    v_add_u32 v131, v131, v96
    v_cmpx_ne_u32 vcc, 0, v130
    v_lshl_add_u32 v90, v131, 2, s50
    v_lshl_add_u32 v131, v131, 3, s51
    ds_write_b32 v90, v130
    ds_write_b64 v131, v[128:129]
    s_mov_b64 exec, -1
    v_add_u32 v135, v135, v97
    v_cmpx_ne_u32 vcc, 0, v134
    v_lshl_add_u32 v90, v135, 2, s50
    v_lshl_add_u32 v135, v135, 3, s51
    ds_write_b32 v90, v134
    ds_write_b64 v135, v[132:133]
    s_mov_b64 exec, -1
    v_add_u32_e64 v139, v139, v98
    v_cmpx_ne_u32 vcc, 0, v138
    v_lshl_add_u32 v90, v139, 2, s50
    v_lshl_add_u32 v139, v139, 3, s51
    ds_write_b32 v90, v138
    ds_write_b64 v139, v[136:137]
    s_mov_b64 exec, -1
    v_add_u32 v143, v143, v99
    v_cmpx_ne_u32 vcc, 0, v142
    v_lshl_add_u32 v90, v143, 2, s50
    v_lshl_add_u32 v143, v143, 3, s51
    ds_write_b32 v90, v142
    ds_write_b64 v143, v[140:141]
    s_mov_b64 exec, -1
    v_add_u32 v147, v147, v100
    v_cmpx_ne_u32 vcc, 0, v146
    v_lshl_add_u32 v90, v147, 2, s50
    v_lshl_add_u32 v147, v147, 3, s51
    ds_write_b32 v90, v146
    ds_write_b64 v147, v[144:145]
    s_mov_b64 exec, -1
    v_add_u32_e64 v151, v151, v101
    v_cmpx_ne_u32 vcc, 0, v150
    v_lshl_add_u32 v90, v151, 2, s50
    v_lshl_add_u32 v151, v151, 3, s51
    ds_write_b32 v90, v150
    ds_write_b64 v151, v[148:149]
    s_mov_b64 exec, -1
    v_add_u32_e64 v155, v155, v102
    v_cmpx_ne_u32 vcc, 0, v154
    v_lshl_add_u32 v90, v155, 2, s50
    v_lshl_add_u32 v155, v155, 3, s51
    ds_write_b32 v90, v154
    ds_write_b64 v155, v[152:153]
    s_mov_b64 exec, -1
    v_add_u32 v159, v159, v103
    v_cmpx_ne_u32 vcc, 0, v158
    v_lshl_add_u32 v90, v159, 2, s50
    v_lshl_add_u32 v159, v159, 3, s51
    ds_write_b32 v90, v158
    ds_write_b64 v159, v[156:157]
    s_mov_b64 exec, -1
    s_waitcnt lgkmcnt(14)
    v_lshrrev_b32 v112, 8, v86
    v_and_b32 v113, 31, v86
    v_cmp_gt_u32 vcc, v112, v92
    s_movk_i32 s53, 768
    v_mul_u32_u24 v113, s53, v113
    s_bcnt1_i32_b64 s28, vcc
    v_lshl_add_u32 v113, v92, 7, v113
    v_mov_b32 v91, 252
    v_mbcnt_lo_u32_b32 v114, vcc_lo, 0
    v_mbcnt_hi_u32_b32 v114, vcc_hi, v114
    v_lshlrev_b32 v114, 2, v114
    v_cndmask_b32_e64 v114, v91, v114, vcc
    ds_permute_b32 v6, v114, v113
    v_readlane_b32 s32, v112, 0
    v_readlane_b32 s33, v112, 1
    v_readlane_b32 s34, v112, 2
    v_readlane_b32 s35, v112, 3
    v_readlane_b32 s36, v112, 4
    v_readlane_b32 s37, v112, 5
    v_readlane_b32 s38, v112, 6
    v_add_u32 v163, v163, v104
    v_cmpx_ne_u32 vcc, 0, v162
    v_lshl_add_u32 v90, v163, 2, s50
    v_lshl_add_u32 v163, v163, 3, s51
    ds_write_b32 v90, v162
    ds_write_b64 v163, v[160:161]
    s_mov_b64 exec, -1
    v_add_u32_e64 v167, v167, v105
    v_cmpx_ne_u32 vcc, 0, v166
    v_lshl_add_u32 v90, v167, 2, s50
    v_lshl_add_u32 v167, v167, 3, s51
    ds_write_b32 v90, v166
    ds_write_b64 v167, v[164:165]
    s_mov_b64 exec, -1
    v_add_u32_e64 v171, v171, v106
    v_cmpx_ne_u32 vcc, 0, v170
    v_lshl_add_u32 v90, v171, 2, s50
    v_lshl_add_u32 v171, v171, 3, s51
    ds_write_b32 v90, v170
    ds_write_b64 v171, v[168:169]
    s_mov_b64 exec, -1
    v_add_u32 v175, v175, v107
    v_cmpx_ne_u32 vcc, 0, v174
    v_lshl_add_u32 v90, v175, 2, s50
    v_lshl_add_u32 v175, v175, 3, s51
    ds_write_b32 v90, v174
    ds_write_b64 v175, v[172:173]
    s_mov_b64 exec, -1
    v_add_u32 v179, v179, v108
    v_cmpx_ne_u32 vcc, 0, v178
    v_lshl_add_u32 v90, v179, 2, s50
    v_lshl_add_u32 v179, v179, 3, s51
    ds_write_b32 v90, v178
    ds_write_b64 v179, v[176:177]
    s_mov_b64 exec, -1
    v_add_u32_e64 v183, v183, v109
    v_cmpx_ne_u32 vcc, 0, v182
    v_lshl_add_u32 v90, v183, 2, s50
    v_lshl_add_u32 v183, v183, 3, s51
    ds_write_b32 v90, v182
    ds_write_b64 v183, v[180:181]
    s_mov_b64 exec, -1
    v_add_u32 v187, v187, v110
    v_cmpx_ne_u32 vcc, 0, v186
    v_lshl_add_u32 v90, v187, 2, s50
    v_lshl_add_u32 v187, v187, 3, s51
    ds_write_b32 v90, v186
    ds_write_b64 v187, v[184:185]
    s_mov_b64 exec, -1
    v_add_u32 v191, v191, v111
    v_cmpx_ne_u32 vcc, 0, v190
    v_lshl_add_u32 v90, v191, 2, s50
    v_lshl_add_u32 v191, v191, 3, s51
    ds_write_b32 v90, v190
    ds_write_b64 v191, v[188:189]
    s_mov_b64 exec, -1
    v_cvt_f32_u32 v112, s28
    v_cvt_f32_u32 v113, v15
    v_rcp_f32 v112, v112
    v_add_f32_e64 v113, 0.5, v113
    v_mov_b32 v114, 0x40400000
    v_mov_b32 v91, 0x40a00000
    v_add_f32 v114, v113, v114
    v_add_f32 v91, v113, v91
    v_mul_f32 v113, v113, v112
    v_mul_f32 v114, v114, v112
    v_mul_f32 v91, v91, v112
    v_cvt_u32_f32 v113, v113
    v_cvt_u32_f32 v114, v114
    v_cvt_u32_f32 v91, v91
    v_mul_u32_u24 v113, s28, v113
    v_mul_u32_u24 v114, s28, v114
    v_mul_u32_u24 v91, s28, v91
    v_sub_u32 v116, v15, v113
    v_add_u32 v117, 3, v15
    v_add_u32 v118, 5, v15
    v_sub_u32 v117, v117, v114
    v_sub_u32 v118, v118, v91
    v_cmp_eq_u32 vcc, 0, v116
    v_lshlrev_b32 v116, 2, v116
    v_lshlrev_b32 v117, 2, v117
    s_mov_b32 s61, vcc_lo
    v_lshlrev_b32 v118, 2, v118
    s_max_u32 s30, s32, s33
    s_max_u32 s30, s30, s34
    s_max_u32 s30, s30, s35
    s_max_u32 s30, s30, s36
    s_max_u32 s30, s30, s37
    s_max_u32 s30, s30, s38
    s_min_u32 s60, s32, s33
    s_min_u32 s60, s60, s34
    s_min_u32 s60, s60, s35
    s_min_u32 s60, s60, s36
    s_min_u32 s60, s60, s37
    s_cmp_gt_u32 s42, 0
    s_cbranch_scc0 K2_xs_6
    v_lshlrev_b32_sdwa v90, 2, v194 dst_sel:DWORD dst_unused:UNUSED_PAD src0_sel:DWORD src1_sel:BYTE_1
    ds_read_b32 v96, v90 offset:1024
    s_cmp_gt_u32 s42, 1
    s_cbranch_scc0 K2_xs_6
    v_lshlrev_b32_sdwa v90, 2, v198 dst_sel:DWORD dst_unused:UNUSED_PAD src0_sel:DWORD src1_sel:BYTE_1
    ds_read_b32 v97, v90 offset:1024
    s_cmp_gt_u32 s42, 2
    s_cbranch_scc0 K2_xs_6
    v_lshlrev_b32_sdwa v90, 2, v202 dst_sel:DWORD dst_unused:UNUSED_PAD src0_sel:DWORD src1_sel:BYTE_1
    ds_read_b32 v98, v90 offset:1024
    s_cmp_gt_u32 s42, 3
    s_cbranch_scc0 K2_xs_6
    v_lshlrev_b32_sdwa v90, 2, v206 dst_sel:DWORD dst_unused:UNUSED_PAD src0_sel:DWORD src1_sel:BYTE_1
    ds_read_b32 v99, v90 offset:1024
    s_cmp_gt_u32 s42, 4
    s_cbranch_scc0 K2_xs_6
    v_lshlrev_b32_sdwa v90, 2, v210 dst_sel:DWORD dst_unused:UNUSED_PAD src0_sel:DWORD src1_sel:BYTE_1
    ds_read_b32 v100, v90 offset:1024
    s_cmp_gt_u32 s42, 5
    s_cbranch_scc0 K2_xs_6
    v_lshlrev_b32_sdwa v90, 2, v214 dst_sel:DWORD dst_unused:UNUSED_PAD src0_sel:DWORD src1_sel:BYTE_1
    ds_read_b32 v101, v90 offset:1024
    s_cmp_gt_u32 s42, 6
    s_cbranch_scc0 K2_xs_6
    v_lshlrev_b32_sdwa v90, 2, v218 dst_sel:DWORD dst_unused:UNUSED_PAD src0_sel:DWORD src1_sel:BYTE_1
    ds_read_b32 v102, v90 offset:1024
    s_cmp_gt_u32 s42, 7
    s_cbranch_scc0 K2_xs_6
    v_lshlrev_b32_sdwa v90, 2, v222 dst_sel:DWORD dst_unused:UNUSED_PAD src0_sel:DWORD src1_sel:BYTE_1
    ds_read_b32 v103, v90 offset:1024
    s_cmp_gt_u32 s42, 8
    s_cbranch_scc0 K2_xs_6
    v_lshlrev_b32_sdwa v90, 2, v226 dst_sel:DWORD dst_unused:UNUSED_PAD src0_sel:DWORD src1_sel:BYTE_1
    ds_read_b32 v104, v90 offset:1024
    s_cmp_gt_u32 s42, 9
    s_cbranch_scc0 K2_xs_6
    v_lshlrev_b32_sdwa v90, 2, v230 dst_sel:DWORD dst_unused:UNUSED_PAD src0_sel:DWORD src1_sel:BYTE_1
    ds_read_b32 v105, v90 offset:1024
    s_cmp_gt_u32 s42, 10
    s_cbranch_scc0 K2_xs_6
    v_lshlrev_b32_sdwa v90, 2, v234 dst_sel:DWORD dst_unused:UNUSED_PAD src0_sel:DWORD src1_sel:BYTE_1
    ds_read_b32 v106, v90 offset:1024
    s_cmp_gt_u32 s42, 11
    s_cbranch_scc0 K2_xs_6
    v_lshlrev_b32_sdwa v90, 2, v238 dst_sel:DWORD dst_unused:UNUSED_PAD src0_sel:DWORD src1_sel:BYTE_1
    ds_read_b32 v107, v90 offset:1024
    s_cmp_gt_u32 s42, 12
    s_cbranch_scc0 K2_xs_6
    v_lshlrev_b32_sdwa v90, 2, v242 dst_sel:DWORD dst_unused:UNUSED_PAD src0_sel:DWORD src1_sel:BYTE_1
    ds_read_b32 v108, v90 offset:1024
    s_cmp_gt_u32 s42, 13
    s_cbranch_scc0 K2_xs_6
    v_lshlrev_b32_sdwa v90, 2, v246 dst_sel:DWORD dst_unused:UNUSED_PAD src0_sel:DWORD src1_sel:BYTE_1
    ds_read_b32 v109, v90 offset:1024
    s_cmp_gt_u32 s42, 14
    s_cbranch_scc0 K2_xs_6
    v_lshlrev_b32_sdwa v90, 2, v250 dst_sel:DWORD dst_unused:UNUSED_PAD src0_sel:DWORD src1_sel:BYTE_1
    ds_read_b32 v110, v90 offset:1024
    s_cmp_gt_u32 s42, 15
    s_cbranch_scc0 K2_xs_6
    v_lshlrev_b32_sdwa v90, 2, v254 dst_sel:DWORD dst_unused:UNUSED_PAD src0_sel:DWORD src1_sel:BYTE_1
    ds_read_b32 v111, v90 offset:1024
K2_xs_6:
    s_waitcnt lgkmcnt(0)
    ds_bpermute_b32 v93, v116, v6
    ds_bpermute_b32 v94, v117, v6
    ds_bpermute_b32 v95, v118, v6
    v_mov_b32 v112, 0x80000000
    v_cmp_eq_u32 s[58:59], 0, v118
    s_cmp_gt_u32 s42, 0
    s_cbranch_scc0 K2_xs_7
    v_add_u32 v195, v195, v96
    v_cmpx_ne_u32 vcc, 0, v194
    v_lshl_add_u32 v90, v195, 2, s50
    v_lshl_add_u32 v195, v195, 3, s51
    ds_write_b32 v90, v194
    ds_write_b64 v195, v[192:193]
    s_mov_b64 exec, -1
    s_cmp_gt_u32 s42, 1
    s_cbranch_scc0 K2_xs_7
    v_add_u32 v199, v199, v97
    v_cmpx_ne_u32 vcc, 0, v198
    v_lshl_add_u32 v90, v199, 2, s50
    v_lshl_add_u32 v199, v199, 3, s51
    ds_write_b32 v90, v198
    ds_write_b64 v199, v[196:197]
    s_mov_b64 exec, -1
    s_cmp_gt_u32 s42, 2
    s_cbranch_scc0 K2_xs_7
    v_add_u32_e64 v203, v203, v98
    v_cmpx_ne_u32 vcc, 0, v202
    v_lshl_add_u32 v90, v203, 2, s50
    v_lshl_add_u32 v203, v203, 3, s51
    ds_write_b32 v90, v202
    ds_write_b64 v203, v[200:201]
    s_mov_b64 exec, -1
    s_cmp_gt_u32 s42, 3
    s_cbranch_scc0 K2_xs_7
    v_add_u32_e64 v207, v207, v99
    v_cmpx_ne_u32 vcc, 0, v206
    v_lshl_add_u32 v90, v207, 2, s50
    v_lshl_add_u32 v207, v207, 3, s51
    ds_write_b32 v90, v206
    ds_write_b64 v207, v[204:205]
    s_mov_b64 exec, -1
    s_cmp_gt_u32 s42, 4
    s_cbranch_scc0 K2_xs_7
    v_add_u32_e64 v211, v211, v100
    v_cmpx_ne_u32 vcc, 0, v210
    v_lshl_add_u32 v90, v211, 2, s50
    v_lshl_add_u32 v211, v211, 3, s51
    ds_write_b32 v90, v210
    ds_write_b64 v211, v[208:209]
    s_mov_b64 exec, -1
    s_cmp_gt_u32 s42, 5
    s_cbranch_scc0 K2_xs_7
    v_add_u32 v215, v215, v101
    v_cmpx_ne_u32 vcc, 0, v214
    v_lshl_add_u32 v90, v215, 2, s50
    v_lshl_add_u32 v215, v215, 3, s51
    ds_write_b32 v90, v214
    ds_write_b64 v215, v[212:213]
    s_mov_b64 exec, -1
    s_cmp_gt_u32 s42, 6
    s_cbranch_scc0 K2_xs_7
    v_add_u32 v219, v219, v102
    v_cmpx_ne_u32 vcc, 0, v218
    v_lshl_add_u32 v90, v219, 2, s50
    v_lshl_add_u32 v219, v219, 3, s51
    ds_write_b32 v90, v218
    ds_write_b64 v219, v[216:217]
    s_mov_b64 exec, -1
    s_cmp_gt_u32 s42, 7
    s_cbranch_scc0 K2_xs_7
    v_add_u32 v223, v223, v103
    v_cmpx_ne_u32 vcc, 0, v222
    v_lshl_add_u32 v90, v223, 2, s50
    v_lshl_add_u32 v223, v223, 3, s51
    ds_write_b32 v90, v222
    ds_write_b64 v223, v[220:221]
    s_mov_b64 exec, -1
    s_cmp_gt_u32 s42, 8
    s_cbranch_scc0 K2_xs_7
    v_add_u32 v227, v227, v104
    v_cmpx_ne_u32 vcc, 0, v226
    v_lshl_add_u32 v90, v227, 2, s50
    v_lshl_add_u32 v227, v227, 3, s51
    ds_write_b32 v90, v226
    ds_write_b64 v227, v[224:225]
    s_mov_b64 exec, -1
    s_cmp_gt_u32 s42, 9
    s_cbranch_scc0 K2_xs_7
    v_add_u32_e64 v231, v231, v105
    v_cmpx_ne_u32 vcc, 0, v230
    v_lshl_add_u32 v90, v231, 2, s50
    v_lshl_add_u32 v231, v231, 3, s51
    ds_write_b32 v90, v230
    ds_write_b64 v231, v[228:229]
    s_mov_b64 exec, -1
    s_cmp_gt_u32 s42, 10
    s_cbranch_scc0 K2_xs_7
    v_add_u32_e64 v235, v235, v106
    v_cmpx_ne_u32 vcc, 0, v234
    v_lshl_add_u32 v90, v235, 2, s50
    v_lshl_add_u32 v235, v235, 3, s51
    ds_write_b32 v90, v234
    ds_write_b64 v235, v[232:233]
    s_mov_b64 exec, -1
    s_cmp_gt_u32 s42, 11
    s_cbranch_scc0 K2_xs_7
    v_add_u32 v239, v239, v107
    v_cmpx_ne_u32 vcc, 0, v238
    v_lshl_add_u32 v90, v239, 2, s50
    v_lshl_add_u32 v239, v239, 3, s51
    ds_write_b32 v90, v238
    ds_write_b64 v239, v[236:237]
    s_mov_b64 exec, -1
    s_cmp_gt_u32 s42, 12
    s_cbranch_scc0 K2_xs_7
    v_add_u32 v243, v243, v108
    v_cmpx_ne_u32 vcc, 0, v242
    v_lshl_add_u32 v90, v243, 2, s50
    v_lshl_add_u32 v243, v243, 3, s51
    ds_write_b32 v90, v242
    ds_write_b64 v243, v[240:241]
    s_mov_b64 exec, -1
    s_cmp_gt_u32 s42, 13
    s_cbranch_scc0 K2_xs_7
    v_add_u32 v247, v247, v109
    v_cmpx_ne_u32 vcc, 0, v246
    v_lshl_add_u32 v90, v247, 2, s50
    v_lshl_add_u32 v247, v247, 3, s51
    ds_write_b32 v90, v246
    ds_write_b64 v247, v[244:245]
    s_mov_b64 exec, -1
    s_cmp_gt_u32 s42, 14
    s_cbranch_scc0 K2_xs_7
    v_add_u32 v251, v251, v110
    v_cmpx_ne_u32 vcc, 0, v250
    v_lshl_add_u32 v90, v251, 2, s50
    v_lshl_add_u32 v251, v251, 3, s51
    ds_write_b32 v90, v250
    ds_write_b64 v251, v[248:249]
    s_mov_b64 exec, -1
    s_cmp_gt_u32 s42, 15
    s_cbranch_scc0 K2_xs_7
    v_add_u32_e64 v255, v255, v111
    v_cmpx_ne_u32 vcc, 0, v254
    v_lshl_add_u32 v90, v255, 2, s50
    v_lshl_add_u32 v255, v255, 3, s51
    ds_write_b32 v90, v254
    ds_write_b64 v255, v[252:253]
    s_mov_b64 exec, -1
K2_xs_7:
    s_add_u32 s43, s40, s41
    s_cmp_ge_u32 s43, 256
    s_cselect_b32 s62, 1, 0
    s_cmp_eq_u32 s49, 0
    s_cselect_b32 s62, s62, 0
    v_cndmask_b32 v112, 0, v112, s[58:59]
    s_waitcnt lgkmcnt(0)
    v_lshl_or_b32 v6, v94, 16, v95
    v_or_b32 v6, v6, v112
    s_barrier
    s_cmp_eq_u32 s28, 0
    s_cbranch_scc1 K2_nochunks
    s_mov_b32 s26, 0
    s_mov_b32 s31, 0
    s_movk_i32 s22, 3072
    s_movk_i32 s23, 2048
    s_movk_i32 s24, 1024
    s_mov_b32 s25, 0
    v_readlane_b32 s58, v93, 0
    v_readlane_b32 s59, v93, 1
    v_readlane_b32 s44, v93, 2
    v_readlane_b32 s53, v93, 3
    v_readlane_b32 s46, v93, 4
    v_readlane_b32 s45, v6, 0
    v_add_u32 v13, s58, v2
    ds_read_b128 v[112:115], v13
    v_add_u32 v12, s58, v3
    v_lshl_add_u32 v7, v12, 1, s100
    ds_read_b64 v[104:105], v12
    v_add_u32_e64 v13, s59, v2
    ds_read_b128 v[116:119], v13
    v_add_u32 v13, s44, v2
    ds_read_b128 v[120:123], v13
    v_add_u32 v13, s53, v2
    ds_read_b128 v[124:127], v13
    v_add_u32 v13, s46, v2
    ds_read_b128 v[100:103], v13
    v_add_u32 v12, s59, v3
    ds_read_b64 v[80:81], v12
    s_add_u32 m0, s19, 0
    s_waitcnt lgkmcnt(6)
    v_mad_u32_u16 v112, v112, s21, v1 op_sel:[1,0,0,0]
    v_mad_u32_u16 v113, v113, s21, v1 op_sel:[1,0,0,0]
    v_mad_u32_u16 v114, v114, s21, v1 op_sel:[1,0,0,0]
    v_mad_u32_u16 v115, v115, s21, v1 op_sel:[1,0,0,0]
    buffer_load_dwordx4 v112, s[4:7], s22 offen lds
    v_mov_b32 v144, 0
    v_mov_b32 v145, 0
    v_mov_b32 v146, 0
    v_mov_b32 v147, 0
    v_mov_b32 v148, 0
    v_mov_b32 v149, 0
    v_mov_b32 v150, 0
    buffer_load_dwordx4 v113, s[4:7], s23 offen offset:1024 lds
    v_mov_b32 v151, 0
    v_mov_b32 v152, 0
    v_mov_b32 v153, 0
    v_mov_b32 v154, 0
    v_mov_b32 v155, 0
    v_mov_b32 v156, 0
    v_mov_b32 v157, 0
    buffer_load_dwordx4 v114, s[4:7], s24 offen offset:2048 lds
    v_mov_b32 v158, 0
    v_mov_b32 v159, 0
    v_mov_b32 v160, 0
    v_mov_b32 v161, 0
    v_mov_b32 v162, 0
    v_mov_b32 v163, 0
    v_mov_b32 v164, 0
    buffer_load_dwordx4 v115, s[4:7], s25 offen offset:3072 lds
    v_mov_b32 v165, 0
    v_mov_b32 v166, 0
    v_mov_b32 v167, 0
    v_mov_b32 v168, 0
    v_mov_b32 v169, 0
    v_mov_b32 v170, 0
    v_mov_b32 v171, 0
    s_bitcmp1_b32 s61, 1
    s_cbranch_scc1 K2_pb_8
K2_pb_8_ret:
    s_add_u32 m0, s19, 4096
    s_waitcnt lgkmcnt(4)
    v_mad_u32_u16 v116, v116, s21, v1 op_sel:[1,0,0,0]
    v_mad_u32_u16 v117, v117, s21, v1 op_sel:[1,0,0,0]
    v_mad_u32_u16 v118, v118, s21, v1 op_sel:[1,0,0,0]
    v_mad_u32_u16 v119, v119, s21, v1 op_sel:[1,0,0,0]
    buffer_load_dwordx4 v116, s[4:7], s22 offen lds
    v_mov_b32 v172, 0
    v_mov_b32 v173, 0
    v_mov_b32 v174, 0
    v_mov_b32 v175, 0
    v_mov_b32 v176, 0
    v_mov_b32 v177, 0
    v_mov_b32 v178, 0
    buffer_load_dwordx4 v117, s[4:7], s23 offen offset:1024 lds
    v_mov_b32 v179, 0
    v_mov_b32 v180, 0
    v_mov_b32 v181, 0
    v_mov_b32 v182, 0
    v_mov_b32 v183, 0
    v_mov_b32 v184, 0
    v_mov_b32 v185, 0
    buffer_load_dwordx4 v118, s[4:7], s24 offen offset:2048 lds
    v_mov_b32 v186, 0
    v_mov_b32 v187, 0
    v_mov_b32 v188, 0
    v_mov_b32 v189, 0
    v_mov_b32 v190, 0
    v_mov_b32 v191, 0
    v_mov_b32 v192, 0
    buffer_load_dwordx4 v119, s[4:7], s25 offen offset:3072 lds
    v_mov_b32 v193, 0
    v_mov_b32 v194, 0
    v_mov_b32 v195, 0
    v_mov_b32 v196, 0
    v_mov_b32 v197, 0
    v_mov_b32 v198, 0
    v_mov_b32_e64 v199, 0
    s_bitcmp1_b32 s61, 2
    s_cbranch_scc1 K2_pb_9
K2_pb_9_ret:
    s_add_u32 m0, s19, 8192
    s_waitcnt lgkmcnt(3)
    v_mad_u32_u16 v120, v120, s21, v1 op_sel:[1,0,0,0]
    v_mad_u32_u16 v121, v121, s21, v1 op_sel:[1,0,0,0]
    v_mad_u32_u16 v122, v122, s21, v1 op_sel:[1,0,0,0]
    v_mad_u32_u16 v123, v123, s21, v1 op_sel:[1,0,0,0]
    buffer_load_dwordx4 v120, s[4:7], s22 offen lds
    v_mov_b32 v200, 0
    v_mov_b32 v201, 0
    v_mov_b32 v202, 0
    v_mov_b32 v203, 0
    v_mov_b32 v204, 0
    v_mov_b32 v205, 0
    v_mov_b32 v206, 0
    buffer_load_dwordx4 v121, s[4:7], s23 offen offset:1024 lds
    v_mov_b32 v207, 0
    v_mov_b32 v208, 0
    v_mov_b32 v209, 0
    v_mov_b32 v210, 0
    v_mov_b32 v211, 0
    v_mov_b32 v212, 0
    v_mov_b32 v213, 0
    buffer_load_dwordx4 v122, s[4:7], s24 offen offset:2048 lds
    v_mov_b32 v214, 0
    v_mov_b32 v215, 0
    v_mov_b32 v216, 0
    v_mov_b32 v217, 0
    v_mov_b32 v218, 0
    v_mov_b32 v219, 0
    v_mov_b32 v220, 0
    buffer_load_dwordx4 v123, s[4:7], s25 offen offset:3072 lds
    v_mov_b32 v221, 0
    v_mov_b32 v222, 0
    v_mov_b32 v223, 0
    v_mov_b32 v224, 0
    v_mov_b32 v225, 0
    v_mov_b32 v226, 0
    v_mov_b32 v227, 0
    s_bitcmp1_b32 s61, 3
    s_cbranch_scc1 K2_pb_10
K2_pb_10_ret:
    s_add_u32 m0, s19, 12288
    s_waitcnt lgkmcnt(2)
    v_mad_u32_u16 v124, v124, s21, v1 op_sel:[1,0,0,0]
    v_mad_u32_u16 v125, v125, s21, v1 op_sel:[1,0,0,0]
    v_mad_u32_u16 v126, v126, s21, v1 op_sel:[1,0,0,0]
    v_mad_u32_u16 v127, v127, s21, v1 op_sel:[1,0,0,0]
    buffer_load_dwordx4 v124, s[4:7], s22 offen lds
    v_mov_b32 v228, 0
    v_mov_b32 v229, 0
    v_mov_b32 v230, 0
    v_mov_b32 v231, 0
    v_mov_b32 v232, 0
    v_mov_b32 v233, 0
    v_mov_b32 v234, 0
    buffer_load_dwordx4 v125, s[4:7], s23 offen offset:1024 lds
    v_mov_b32 v235, 0
    v_mov_b32 v236, 0
    v_mov_b32 v237, 0
    v_mov_b32 v238, 0
    v_mov_b32 v239, 0
    v_mov_b32 v240, 0
    v_mov_b32 v241, 0
    buffer_load_dwordx4 v126, s[4:7], s24 offen offset:2048 lds
    v_mov_b32 v242, 0
    v_mov_b32 v243, 0
    v_mov_b32 v244, 0
    v_mov_b32 v245, 0
    v_mov_b32 v246, 0
    v_mov_b32 v247, 0
    v_mov_b32 v248, 0
    buffer_load_dwordx4 v127, s[4:7], s25 offen offset:3072 lds
    v_mov_b32 v249, 0
    v_mov_b32 v250, 0
    v_mov_b32 v251, 0
    v_mov_b32 v252, 0
    v_mov_b32 v253, 0
    v_mov_b32 v254, 0
    v_mov_b32 v255, 0
    s_bitcmp1_b32 s61, 4
    s_cbranch_scc1 K2_pb_11
K2_pb_11_ret:
    s_waitcnt lgkmcnt(0)
    v_cmp_eq_u32_sdwa vcc, v104, v5 src0_sel:BYTE_0 src1_sel:DWORD
    v_cmp_eq_u32_sdwa s[46:47], v105, v5 src0_sel:BYTE_0 src1_sel:DWORD
    s_mov_b32 s20, 0
    v_mad_u32_u16 v100, v100, s21, v1 op_sel:[1,0,0,0]
    v_mad_u32_u16 v101, v101, s21, v1 op_sel:[1,0,0,0]
    v_cndmask_b32_e64 v106, v4, v7, vcc
    v_cndmask_b32 v107, v4, v7, s[46:47]
    ds_read_b64_tr_b16 v[96:97], v106
    ds_read_b64_tr_b16 v[98:99], v107 offset:8
    v_add_u32_e64 v108, s20, v8
    v_add_u32_e64 v109, s20, v9
    v_mov_b32_e64 v104, v80
    v_mov_b32_e64 v105, v81
    v_lshl_add_u32 v7, v12, 1, s100
    v_cmp_eq_u32_sdwa vcc, v104, v5 src0_sel:BYTE_0 src1_sel:DWORD
    v_cmp_eq_u32_sdwa s[46:47], v105, v5 src0_sel:BYTE_0 src1_sel:DWORD
    v_mad_u32_u16 v102, v102, s21, v1 op_sel:[1,0,0,0]
    v_mad_u32_u16 v103, v103, s21, v1 op_sel:[1,0,0,0]
    v_cndmask_b32 v106, v4, v7, vcc
    v_cndmask_b32 v107, v4, v7, s[46:47]
    v_add_u32_e64 v12, s44, v3
    v_lshl_add_u32 v7, v12, 1, s100
    v_mov_b32_e64 v110, v86
    s_waitcnt vmcnt(12)
    ds_read_b64_tr_b16 v[80:81], v108
    ds_read_b64_tr_b16 v[82:83], v108 offset:1024
    ds_read_b64_tr_b16 v[84:85], v109
    ds_read_b64_tr_b16 v[86:87], v109 offset:1024
    ds_read_b64_tr_b16 v[88:89], v108 offset:512
    ds_read_b64_tr_b16 v[90:91], v108 offset:1536
    ds_read_b64_tr_b16 v[92:93], v109 offset:512
    ds_read_b64_tr_b16 v[94:95], v109 offset:1536
    s_add_u32 m0, s19, s20
    s_add_u32 s20, s20, 4096
    s_and_b32 s20, s20, 16383
    v_add_u32_e64 v108, s20, v8
    v_add_u32_e64 v109, s20, v9
    s_waitcnt lgkmcnt(0)
    buffer_load_dwordx4 v100, s[4:7], s22 offen lds
    buffer_load_dwordx4 v101, s[4:7], s23 offen offset:1024 lds
    buffer_load_dwordx4 v102, s[4:7], s24 offen offset:2048 lds
    buffer_load_dwordx4 v103, s[4:7], s25 offen offset:3072 lds
    s_mov_b32 s52, 0
    s_mov_b32 s29, 0
K2_fastchk:
    s_cmp_lt_u32 s29, s60
    s_nop 0
    s_cbranch_scc0 K2_stepchk
K2_fast:
    s_waitcnt vmcnt(12)
    v_mfma_f32_16x16x32_bf16 v[144:147], v[80:83], v[96:99], v[144:147]
    v_add_u32_sdwa v13, s45, v2 dst_sel:DWORD dst_unused:UNUSED_PAD src0_sel:WORD_0 src1_sel:DWORD
    ds_read_b64_tr_b16 v[80:81], v108
    ds_read_b64_tr_b16 v[82:83], v108 offset:1024
    ds_read_b64 v[104:105], v12
    ds_read_b128 v[100:103], v13
    v_mfma_f32_16x16x32_bf16 v[148:151], v[84:87], v[96:99], v[148:151]
    ds_read_b64_tr_b16 v[84:85], v109
    ds_read_b64_tr_b16 v[86:87], v109 offset:1024
    v_mfma_f32_16x16x32_bf16 v[152:155], v[88:91], v[96:99], v[152:155]
    ds_read_b64_tr_b16 v[88:89], v108 offset:512
    ds_read_b64_tr_b16 v[90:91], v108 offset:1536
    v_mfma_f32_16x16x32_bf16 v[156:159], v[92:95], v[96:99], v[156:159]
    ds_read_b64_tr_b16 v[92:93], v109 offset:512
    ds_read_b64_tr_b16 v[94:95], v109 offset:1536
    ds_read_b64_tr_b16 v[96:97], v106
    ds_read_b64_tr_b16 v[98:99], v107 offset:8
    s_add_u32 m0, s19, s20
    s_add_u32 s20, s20, 4096
    s_and_b32 s20, s20, 16383
    s_cmp_lt_i32 s45, 0
    v_add_u32_e64 v108, s20, v8
    v_add_u32_e64 v109, s20, v9
    s_cbranch_scc1 K2_wrap_12
K2_wrap_12_ret:
    s_waitcnt lgkmcnt(8)
    v_cmp_eq_u32_sdwa vcc, v104, v5 src0_sel:BYTE_0 src1_sel:DWORD
    v_cmp_eq_u32_sdwa s[46:47], v105, v5 src0_sel:BYTE_0 src1_sel:DWORD
    v_mad_u32_u16 v100, v100, s21, v1 op_sel:[1,0,0,0]
    v_mad_u32_u16 v101, v101, s21, v1 op_sel:[1,0,0,0]
    v_cndmask_b32_e64 v106, v4, v7, vcc
    v_cndmask_b32 v107, v4, v7, s[46:47]
    v_mad_u32_u16 v102, v102, s21, v1 op_sel:[1,0,0,0]
    v_mad_u32_u16 v103, v103, s21, v1 op_sel:[1,0,0,0]
    v_add_u32_sdwa v12, s45, v3 dst_sel:DWORD dst_unused:UNUSED_PAD src0_sel:WORD_1 src1_sel:DWORD
    v_lshl_add_u32 v7, v12, 1, s100
    s_add_u32 s26, s26, 1
    s_waitcnt lgkmcnt(0)
    buffer_load_dwordx4 v100, s[4:7], s22 offen lds
    v_readlane_b32 s45, v6, s26
    buffer_load_dwordx4 v101, s[4:7], s23 offen offset:1024 lds
    buffer_load_dwordx4 v102, s[4:7], s24 offen offset:2048 lds
    buffer_load_dwordx4 v103, s[4:7], s25 offen offset:3072 lds
    s_waitcnt vmcnt(12)
    v_mfma_f32_16x16x32_bf16 v[160:163], v[80:83], v[96:99], v[160:163]
    v_add_u32_sdwa v13, s45, v2 dst_sel:DWORD dst_unused:UNUSED_PAD src0_sel:WORD_0 src1_sel:DWORD
    ds_read_b64_tr_b16 v[80:81], v108
    s_nop 0
    ds_read_b64_tr_b16 v[82:83], v108 offset:1024
    ds_read_b64 v[104:105], v12
    ds_read_b128 v[100:103], v13
    v_mfma_f32_16x16x32_bf16 v[164:167], v[84:87], v[96:99], v[164:167]
    ds_read_b64_tr_b16 v[84:85], v109
    ds_read_b64_tr_b16 v[86:87], v109 offset:1024
    v_mfma_f32_16x16x32_bf16 v[168:171], v[88:91], v[96:99], v[168:171]
    ds_read_b64_tr_b16 v[88:89], v108 offset:512
    ds_read_b64_tr_b16 v[90:91], v108 offset:1536
    v_mfma_f32_16x16x32_bf16 v[172:175], v[92:95], v[96:99], v[172:175]
    ds_read_b64_tr_b16 v[92:93], v109 offset:512
    ds_read_b64_tr_b16 v[94:95], v109 offset:1536
    ds_read_b64_tr_b16 v[96:97], v106
    ds_read_b64_tr_b16 v[98:99], v107 offset:8
    s_add_u32 m0, s19, s20
    s_add_u32 s20, s20, 4096
    s_and_b32 s20, s20, 16383
    s_cmp_lt_i32 s45, 0
    v_add_u32 v108, s20, v8
    v_add_u32 v109, s20, v9
    s_cbranch_scc1 K2_wrap_13
K2_wrap_13_ret:
    s_waitcnt lgkmcnt(8)
    v_cmp_eq_u32_sdwa vcc, v104, v5 src0_sel:BYTE_0 src1_sel:DWORD
    v_cmp_eq_u32_sdwa s[46:47], v105, v5 src0_sel:BYTE_0 src1_sel:DWORD
    v_mad_u32_u16 v100, v100, s21, v1 op_sel:[1,0,0,0]
    v_mad_u32_u16 v101, v101, s21, v1 op_sel:[1,0,0,0]
    v_cndmask_b32_e64 v106, v4, v7, vcc
    v_cndmask_b32 v107, v4, v7, s[46:47]
    v_mad_u32_u16 v102, v102, s21, v1 op_sel:[1,0,0,0]
    v_mad_u32_u16 v103, v103, s21, v1 op_sel:[1,0,0,0]
    v_add_u32_sdwa v12, s45, v3 dst_sel:DWORD dst_unused:UNUSED_PAD src0_sel:WORD_1 src1_sel:DWORD
    v_lshl_add_u32 v7, v12, 1, s100
    s_add_u32 s26, s26, 1
    s_waitcnt lgkmcnt(0)
    buffer_load_dwordx4 v100, s[4:7], s22 offen lds
    v_readlane_b32 s45, v6, s26
    buffer_load_dwordx4 v101, s[4:7], s23 offen offset:1024 lds
    buffer_load_dwordx4 v102, s[4:7], s24 offen offset:2048 lds
    buffer_load_dwordx4 v103, s[4:7], s25 offen offset:3072 lds
    s_waitcnt vmcnt(12)
    v_mfma_f32_16x16x32_bf16 v[176:179], v[80:83], v[96:99], v[176:179]
    v_add_u32_sdwa v13, s45, v2 dst_sel:DWORD dst_unused:UNUSED_PAD src0_sel:WORD_0 src1_sel:DWORD
    ds_read_b64_tr_b16 v[80:81], v108
    ds_read_b64_tr_b16 v[82:83], v108 offset:1024
    s_nop 0
    ds_read_b64 v[104:105], v12
    ds_read_b128 v[100:103], v13
    v_mfma_f32_16x16x32_bf16 v[180:183], v[84:87], v[96:99], v[180:183]
    ds_read_b64_tr_b16 v[84:85], v109
    ds_read_b64_tr_b16 v[86:87], v109 offset:1024
    v_mfma_f32_16x16x32_bf16 v[184:187], v[88:91], v[96:99], v[184:187]
    ds_read_b64_tr_b16 v[88:89], v108 offset:512
    ds_read_b64_tr_b16 v[90:91], v108 offset:1536
    v_mfma_f32_16x16x32_bf16 v[188:191], v[92:95], v[96:99], v[188:191]
    ds_read_b64_tr_b16 v[92:93], v109 offset:512
    ds_read_b64_tr_b16 v[94:95], v109 offset:1536
    ds_read_b64_tr_b16 v[96:97], v106
    ds_read_b64_tr_b16 v[98:99], v107 offset:8
    s_add_u32 m0, s19, s20
    s_add_u32 s20, s20, 4096
    s_and_b32 s20, s20, 16383
    s_cmp_lt_i32 s45, 0
    v_add_u32_e64 v108, s20, v8
    v_add_u32_e64 v109, s20, v9
    s_cbranch_scc1 K2_wrap_14
K2_wrap_14_ret:
    s_waitcnt lgkmcnt(8)
    v_cmp_eq_u32_sdwa vcc, v104, v5 src0_sel:BYTE_0 src1_sel:DWORD
    v_cmp_eq_u32_sdwa s[46:47], v105, v5 src0_sel:BYTE_0 src1_sel:DWORD
    v_mad_u32_u16 v100, v100, s21, v1 op_sel:[1,0,0,0]
    v_mad_u32_u16 v101, v101, s21, v1 op_sel:[1,0,0,0]
    v_cndmask_b32_e64 v106, v4, v7, vcc
    v_cndmask_b32 v107, v4, v7, s[46:47]
    v_mad_u32_u16 v102, v102, s21, v1 op_sel:[1,0,0,0]
    v_mad_u32_u16 v103, v103, s21, v1 op_sel:[1,0,0,0]
    v_add_u32_sdwa v12, s45, v3 dst_sel:DWORD dst_unused:UNUSED_PAD src0_sel:WORD_1 src1_sel:DWORD
    v_lshl_add_u32 v7, v12, 1, s100
    s_add_u32 s26, s26, 1
    s_waitcnt lgkmcnt(0)
    buffer_load_dwordx4 v100, s[4:7], s22 offen lds
    v_readlane_b32 s45, v6, s26
    buffer_load_dwordx4 v101, s[4:7], s23 offen offset:1024 lds
    buffer_load_dwordx4 v102, s[4:7], s24 offen offset:2048 lds
    buffer_load_dwordx4 v103, s[4:7], s25 offen offset:3072 lds
    s_waitcnt vmcnt(12)
    v_mfma_f32_16x16x32_bf16 v[192:195], v[80:83], v[96:99], v[192:195]
    v_add_u32_sdwa v13, s45, v2 dst_sel:DWORD dst_unused:UNUSED_PAD src0_sel:WORD_0 src1_sel:DWORD
    ds_read_b64_tr_b16 v[80:81], v108
    ds_read_b64_tr_b16 v[82:83], v108 offset:1024
    s_nop 0
    ds_read_b64 v[104:105], v12
    ds_read_b128 v[100:103], v13
    v_mfma_f32_16x16x32_bf16 v[196:199], v[84:87], v[96:99], v[196:199]
    ds_read_b64_tr_b16 v[84:85], v109
    ds_read_b64_tr_b16 v[86:87], v109 offset:1024
    v_mfma_f32_16x16x32_bf16 v[200:203], v[88:91], v[96:99], v[200:203]
    ds_read_b64_tr_b16 v[88:89], v108 offset:512
    ds_read_b64_tr_b16 v[90:91], v108 offset:1536
    v_mfma_f32_16x16x32_bf16 v[204:207], v[92:95], v[96:99], v[204:207]
    ds_read_b64_tr_b16 v[92:93], v109 offset:512
    ds_read_b64_tr_b16 v[94:95], v109 offset:1536
    ds_read_b64_tr_b16 v[96:97], v106
    ds_read_b64_tr_b16 v[98:99], v107 offset:8
    s_add_u32 m0, s19, s20
    s_add_u32 s20, s20, 4096
    s_and_b32 s20, s20, 16383
    s_cmp_lt_i32 s45, 0
    v_add_u32_e64 v108, s20, v8
    v_add_u32_e64 v109, s20, v9
    s_cbranch_scc1 K2_wrap_15
K2_wrap_15_ret:
    s_waitcnt lgkmcnt(8)
    v_cmp_eq_u32_sdwa vcc, v104, v5 src0_sel:BYTE_0 src1_sel:DWORD
    v_cmp_eq_u32_sdwa s[46:47], v105, v5 src0_sel:BYTE_0 src1_sel:DWORD
    v_mad_u32_u16 v100, v100, s21, v1 op_sel:[1,0,0,0]
    v_mad_u32_u16 v101, v101, s21, v1 op_sel:[1,0,0,0]
    v_cndmask_b32_e64 v106, v4, v7, vcc
    v_cndmask_b32 v107, v4, v7, s[46:47]
    v_mad_u32_u16 v102, v102, s21, v1 op_sel:[1,0,0,0]
    v_mad_u32_u16 v103, v103, s21, v1 op_sel:[1,0,0,0]
    v_add_u32_sdwa v12, s45, v3 dst_sel:DWORD dst_unused:UNUSED_PAD src0_sel:WORD_1 src1_sel:DWORD
    v_lshl_add_u32 v7, v12, 1, s100
    s_add_u32 s26, s26, 1
    s_waitcnt lgkmcnt(0)
    buffer_load_dwordx4 v100, s[4:7], s22 offen lds
    v_readlane_b32 s45, v6, s26
    buffer_load_dwordx4 v101, s[4:7], s23 offen offset:1024 lds
    buffer_load_dwordx4 v102, s[4:7], s24 offen offset:2048 lds
    buffer_load_dwordx4 v103, s[4:7], s25 offen offset:3072 lds
    s_waitcnt vmcnt(12)
    v_mfma_f32_16x16x32_bf16 v[208:211], v[80:83], v[96:99], v[208:211]
    v_add_u32_sdwa v13, s45, v2 dst_sel:DWORD dst_unused:UNUSED_PAD src0_sel:WORD_0 src1_sel:DWORD
    ds_read_b64_tr_b16 v[80:81], v108
    ds_read_b64_tr_b16 v[82:83], v108 offset:1024
    s_nop 0
    ds_read_b64 v[104:105], v12
    ds_read_b128 v[100:103], v13
    v_mfma_f32_16x16x32_bf16 v[212:215], v[84:87], v[96:99], v[212:215]
    ds_read_b64_tr_b16 v[84:85], v109
    ds_read_b64_tr_b16 v[86:87], v109 offset:1024
    v_mfma_f32_16x16x32_bf16 v[216:219], v[88:91], v[96:99], v[216:219]
    ds_read_b64_tr_b16 v[88:89], v108 offset:512
    ds_read_b64_tr_b16 v[90:91], v108 offset:1536
    v_mfma_f32_16x16x32_bf16 v[220:223], v[92:95], v[96:99], v[220:223]
    ds_read_b64_tr_b16 v[92:93], v109 offset:512
    ds_read_b64_tr_b16 v[94:95], v109 offset:1536
    ds_read_b64_tr_b16 v[96:97], v106
    ds_read_b64_tr_b16 v[98:99], v107 offset:8
    s_add_u32 m0, s19, s20
    s_add_u32 s20, s20, 4096
    s_and_b32 s20, s20, 16383
    s_cmp_lt_i32 s45, 0
    v_add_u32_e64 v108, s20, v8
    v_add_u32_e64 v109, s20, v9
    s_cbranch_scc1 K2_wrap_16
K2_wrap_16_ret:
    s_waitcnt lgkmcnt(8)
    v_cmp_eq_u32_sdwa vcc, v104, v5 src0_sel:BYTE_0 src1_sel:DWORD
    v_cmp_eq_u32_sdwa s[46:47], v105, v5 src0_sel:BYTE_0 src1_sel:DWORD
    v_mad_u32_u16 v100, v100, s21, v1 op_sel:[1,0,0,0]
    v_mad_u32_u16 v101, v101, s21, v1 op_sel:[1,0,0,0]
    v_cndmask_b32_e64 v106, v4, v7, vcc
    v_cndmask_b32 v107, v4, v7, s[46:47]
    v_mad_u32_u16 v102, v102, s21, v1 op_sel:[1,0,0,0]
    v_mad_u32_u16 v103, v103, s21, v1 op_sel:[1,0,0,0]
    v_add_u32_sdwa v12, s45, v3 dst_sel:DWORD dst_unused:UNUSED_PAD src0_sel:WORD_1 src1_sel:DWORD
    v_lshl_add_u32 v7, v12, 1, s100
    s_add_u32 s26, s26, 1
    s_waitcnt lgkmcnt(0)
    buffer_load_dwordx4 v100, s[4:7], s22 offen lds
    v_readlane_b32 s45, v6, s26
    buffer_load_dwordx4 v101, s[4:7], s23 offen offset:1024 lds
    buffer_load_dwordx4 v102, s[4:7], s24 offen offset:2048 lds
    buffer_load_dwordx4 v103, s[4:7], s25 offen offset:3072 lds
    s_waitcnt vmcnt(12)
    v_mfma_f32_16x16x32_bf16 v[224:227], v[80:83], v[96:99], v[224:227]
    v_add_u32_sdwa v13, s45, v2 dst_sel:DWORD dst_unused:UNUSED_PAD src0_sel:WORD_0 src1_sel:DWORD
    ds_read_b64_tr_b16 v[80:81], v108
    ds_read_b64_tr_b16 v[82:83], v108 offset:1024
    s_nop 0
    ds_read_b64 v[104:105], v12
    ds_read_b128 v[100:103], v13
    v_mfma_f32_16x16x32_bf16 v[228:231], v[84:87], v[96:99], v[228:231]
    ds_read_b64_tr_b16 v[84:85], v109
    ds_read_b64_tr_b16 v[86:87], v109 offset:1024
    v_mfma_f32_16x16x32_bf16 v[232:235], v[88:91], v[96:99], v[232:235]
    ds_read_b64_tr_b16 v[88:89], v108 offset:512
    ds_read_b64_tr_b16 v[90:91], v108 offset:1536
    v_mfma_f32_16x16x32_bf16 v[236:239], v[92:95], v[96:99], v[236:239]
    ds_read_b64_tr_b16 v[92:93], v109 offset:512
    ds_read_b64_tr_b16 v[94:95], v109 offset:1536
    ds_read_b64_tr_b16 v[96:97], v106
    ds_read_b64_tr_b16 v[98:99], v107 offset:8
    s_add_u32 m0, s19, s20
    s_add_u32 s20, s20, 4096
    s_and_b32 s20, s20, 16383
    s_cmp_lt_i32 s45, 0
    v_add_u32_e64 v108, s20, v8
    v_add_u32_e64 v109, s20, v9
    s_cbranch_scc1 K2_wrap_17
K2_wrap_17_ret:
    s_waitcnt lgkmcnt(8)
    v_cmp_eq_u32_sdwa vcc, v104, v5 src0_sel:BYTE_0 src1_sel:DWORD
    v_cmp_eq_u32_sdwa s[46:47], v105, v5 src0_sel:BYTE_0 src1_sel:DWORD
    v_mad_u32_u16 v100, v100, s21, v1 op_sel:[1,0,0,0]
    v_mad_u32_u16 v101, v101, s21, v1 op_sel:[1,0,0,0]
    v_cndmask_b32_e64 v106, v4, v7, vcc
    v_cndmask_b32 v107, v4, v7, s[46:47]
    v_mad_u32_u16 v102, v102, s21, v1 op_sel:[1,0,0,0]
    v_mad_u32_u16 v103, v103, s21, v1 op_sel:[1,0,0,0]
    v_add_u32_sdwa v12, s45, v3 dst_sel:DWORD dst_unused:UNUSED_PAD src0_sel:WORD_1 src1_sel:DWORD
    v_lshl_add_u32 v7, v12, 1, s100
    s_add_u32 s26, s26, 1
    s_waitcnt lgkmcnt(0)
    buffer_load_dwordx4 v100, s[4:7], s22 offen lds
    v_readlane_b32 s45, v6, s26
    buffer_load_dwordx4 v101, s[4:7], s23 offen offset:1024 lds
    buffer_load_dwordx4 v102, s[4:7], s24 offen offset:2048 lds
    buffer_load_dwordx4 v103, s[4:7], s25 offen offset:3072 lds
    s_cmp_gt_u32 s38, s29
    s_cbranch_scc1 K2_fast6
K2_fast6_ret:
    s_add_u32 s29, s29, 1
    s_cmp_lt_u32 s29, s60
    s_cbranch_scc1 K2_fast
K2_stepchk:
    s_cmp_lt_u32 s29, s30
    s_cbranch_scc0 K2_roundend
K2_step:
    s_cmp_gt_u32 s32, s29
    s_waitcnt vmcnt(12)
    s_cbranch_scc0 K2_skip_18
    v_mfma_f32_16x16x32_bf16 v[144:147], v[80:83], v[96:99], v[144:147]
    v_add_u32_sdwa v13, s45, v2 dst_sel:DWORD dst_unused:UNUSED_PAD src0_sel:WORD_0 src1_sel:DWORD
    ds_read_b64_tr_b16 v[80:81], v108
    ds_read_b64_tr_b16 v[82:83], v108 offset:1024
    ds_read_b64 v[104:105], v12
    ds_read_b128 v[100:103], v13
    v_mfma_f32_16x16x32_bf16 v[148:151], v[84:87], v[96:99], v[148:151]
    ds_read_b64_tr_b16 v[84:85], v109
    ds_read_b64_tr_b16 v[86:87], v109 offset:1024
    v_mfma_f32_16x16x32_bf16 v[152:155], v[88:91], v[96:99], v[152:155]
    ds_read_b64_tr_b16 v[88:89], v108 offset:512
    ds_read_b64_tr_b16 v[90:91], v108 offset:1536
    v_mfma_f32_16x16x32_bf16 v[156:159], v[92:95], v[96:99], v[156:159]
    ds_read_b64_tr_b16 v[92:93], v109 offset:512
    ds_read_b64_tr_b16 v[94:95], v109 offset:1536
    ds_read_b64_tr_b16 v[96:97], v106
    ds_read_b64_tr_b16 v[98:99], v107 offset:8
    s_add_u32 m0, s19, s20
    s_add_u32 s20, s20, 4096
    s_and_b32 s20, s20, 16383
    s_cmp_lt_i32 s45, 0
    v_add_u32_e64 v108, s20, v8
    v_add_u32_e64 v109, s20, v9
    s_cbranch_scc1 K2_wrap_19
K2_wrap_19_ret:
    s_waitcnt lgkmcnt(8)
    v_cmp_eq_u32_sdwa vcc, v104, v5 src0_sel:BYTE_0 src1_sel:DWORD
    v_cmp_eq_u32_sdwa s[46:47], v105, v5 src0_sel:BYTE_0 src1_sel:DWORD
    v_mad_u32_u16 v100, v100, s21, v1 op_sel:[1,0,0,0]
    v_mad_u32_u16 v101, v101, s21, v1 op_sel:[1,0,0,0]
    v_cndmask_b32 v106, v4, v7, vcc
    v_cndmask_b32 v107, v4, v7, s[46:47]
    v_mad_u32_u16 v102, v102, s21, v1 op_sel:[1,0,0,0]
    v_mad_u32_u16 v103, v103, s21, v1 op_sel:[1,0,0,0]
    v_add_u32_sdwa v12, s45, v3 dst_sel:DWORD dst_unused:UNUSED_PAD src0_sel:WORD_1 src1_sel:DWORD
    v_lshl_add_u32 v7, v12, 1, s100
    s_add_u32 s26, s26, 1
    s_waitcnt lgkmcnt(0)
    buffer_load_dwordx4 v100, s[4:7], s22 offen lds
    v_readlane_b32 s45, v6, s26
    buffer_load_dwordx4 v101, s[4:7], s23 offen offset:1024 lds
    buffer_load_dwordx4 v102, s[4:7], s24 offen offset:2048 lds
    buffer_load_dwordx4 v103, s[4:7], s25 offen offset:3072 lds
K2_skip_18:
    s_cmp_gt_u32 s33, s29
    s_waitcnt vmcnt(12)
    s_cbranch_scc0 K2_skip_20
    v_mfma_f32_16x16x32_bf16 v[160:163], v[80:83], v[96:99], v[160:163]
    v_add_u32_sdwa v13, s45, v2 dst_sel:DWORD dst_unused:UNUSED_PAD src0_sel:WORD_0 src1_sel:DWORD
    ds_read_b64_tr_b16 v[80:81], v108
    ds_read_b64_tr_b16 v[82:83], v108 offset:1024
    ds_read_b64 v[104:105], v12
    ds_read_b128 v[100:103], v13
    v_mfma_f32_16x16x32_bf16 v[164:167], v[84:87], v[96:99], v[164:167]
    ds_read_b64_tr_b16 v[84:85], v109
    ds_read_b64_tr_b16 v[86:87], v109 offset:1024
    v_mfma_f32_16x16x32_bf16 v[168:171], v[88:91], v[96:99], v[168:171]
    ds_read_b64_tr_b16 v[88:89], v108 offset:512
    ds_read_b64_tr_b16 v[90:91], v108 offset:1536
    v_mfma_f32_16x16x32_bf16 v[172:175], v[92:95], v[96:99], v[172:175]
    ds_read_b64_tr_b16 v[92:93], v109 offset:512
    ds_read_b64_tr_b16 v[94:95], v109 offset:1536
    ds_read_b64_tr_b16 v[96:97], v106
    ds_read_b64_tr_b16 v[98:99], v107 offset:8
    s_add_u32 m0, s19, s20
    s_add_u32 s20, s20, 4096
    s_and_b32 s20, s20, 16383
    s_cmp_lt_i32 s45, 0
    v_add_u32_e64 v108, s20, v8
    v_add_u32_e64 v109, s20, v9
    s_cbranch_scc1 K2_wrap_21
K2_wrap_21_ret:
    s_waitcnt lgkmcnt(8)
    v_cmp_eq_u32_sdwa vcc, v104, v5 src0_sel:BYTE_0 src1_sel:DWORD
    v_cmp_eq_u32_sdwa s[46:47], v105, v5 src0_sel:BYTE_0 src1_sel:DWORD
    v_mad_u32_u16 v100, v100, s21, v1 op_sel:[1,0,0,0]
    v_mad_u32_u16 v101, v101, s21, v1 op_sel:[1,0,0,0]
    v_cndmask_b32 v106, v4, v7, vcc
    v_cndmask_b32 v107, v4, v7, s[46:47]
    v_mad_u32_u16 v102, v102, s21, v1 op_sel:[1,0,0,0]
    v_mad_u32_u16 v103, v103, s21, v1 op_sel:[1,0,0,0]
    v_add_u32_sdwa v12, s45, v3 dst_sel:DWORD dst_unused:UNUSED_PAD src0_sel:WORD_1 src1_sel:DWORD
    v_lshl_add_u32 v7, v12, 1, s100
    s_add_u32 s26, s26, 1
    s_waitcnt lgkmcnt(0)
    buffer_load_dwordx4 v100, s[4:7], s22 offen lds
    v_readlane_b32 s45, v6, s26
    buffer_load_dwordx4 v101, s[4:7], s23 offen offset:1024 lds
    buffer_load_dwordx4 v102, s[4:7], s24 offen offset:2048 lds
    buffer_load_dwordx4 v103, s[4:7], s25 offen offset:3072 lds
K2_skip_20:
    s_cmp_gt_u32 s34, s29
    s_waitcnt vmcnt(12)
    s_cbranch_scc0 K2_skip_22
    v_mfma_f32_16x16x32_bf16 v[176:179], v[80:83], v[96:99], v[176:179]
    v_add_u32_sdwa v13, s45, v2 dst_sel:DWORD dst_unused:UNUSED_PAD src0_sel:WORD_0 src1_sel:DWORD
    ds_read_b64_tr_b16 v[80:81], v108
    ds_read_b64_tr_b16 v[82:83], v108 offset:1024
    ds_read_b64 v[104:105], v12
    ds_read_b128 v[100:103], v13
    v_mfma_f32_16x16x32_bf16 v[180:183], v[84:87], v[96:99], v[180:183]
    ds_read_b64_tr_b16 v[84:85], v109
    ds_read_b64_tr_b16 v[86:87], v109 offset:1024
    v_mfma_f32_16x16x32_bf16 v[184:187], v[88:91], v[96:99], v[184:187]
    ds_read_b64_tr_b16 v[88:89], v108 offset:512
    ds_read_b64_tr_b16 v[90:91], v108 offset:1536
    v_mfma_f32_16x16x32_bf16 v[188:191], v[92:95], v[96:99], v[188:191]
    ds_read_b64_tr_b16 v[92:93], v109 offset:512
    ds_read_b64_tr_b16 v[94:95], v109 offset:1536
    ds_read_b64_tr_b16 v[96:97], v106
    ds_read_b64_tr_b16 v[98:99], v107 offset:8
    s_add_u32 m0, s19, s20
    s_add_u32 s20, s20, 4096
    s_and_b32 s20, s20, 16383
    s_cmp_lt_i32 s45, 0
    v_add_u32_e64 v108, s20, v8
    v_add_u32_e64 v109, s20, v9
    s_cbranch_scc1 K2_wrap_23
K2_wrap_23_ret:
    s_waitcnt lgkmcnt(8)
    v_cmp_eq_u32_sdwa vcc, v104, v5 src0_sel:BYTE_0 src1_sel:DWORD
    v_cmp_eq_u32_sdwa s[46:47], v105, v5 src0_sel:BYTE_0 src1_sel:DWORD
    v_mad_u32_u16 v100, v100, s21, v1 op_sel:[1,0,0,0]
    v_mad_u32_u16 v101, v101, s21, v1 op_sel:[1,0,0,0]
    v_cndmask_b32 v106, v4, v7, vcc
    v_cndmask_b32 v107, v4, v7, s[46:47]
    v_mad_u32_u16 v102, v102, s21, v1 op_sel:[1,0,0,0]
    v_mad_u32_u16 v103, v103, s21, v1 op_sel:[1,0,0,0]
    v_add_u32_sdwa v12, s45, v3 dst_sel:DWORD dst_unused:UNUSED_PAD src0_sel:WORD_1 src1_sel:DWORD
    v_lshl_add_u32 v7, v12, 1, s100
    s_add_u32 s26, s26, 1
    s_waitcnt lgkmcnt(0)
    buffer_load_dwordx4 v100, s[4:7], s22 offen lds
    v_readlane_b32 s45, v6, s26
    buffer_load_dwordx4 v101, s[4:7], s23 offen offset:1024 lds
    buffer_load_dwordx4 v102, s[4:7], s24 offen offset:2048 lds
    buffer_load_dwordx4 v103, s[4:7], s25 offen offset:3072 lds
K2_skip_22:
    s_cmp_gt_u32 s35, s29
    s_waitcnt vmcnt(12)
    s_cbranch_scc0 K2_skip_24
    v_mfma_f32_16x16x32_bf16 v[192:195], v[80:83], v[96:99], v[192:195]
    v_add_u32_sdwa v13, s45, v2 dst_sel:DWORD dst_unused:UNUSED_PAD src0_sel:WORD_0 src1_sel:DWORD
    ds_read_b64_tr_b16 v[80:81], v108
    ds_read_b64_tr_b16 v[82:83], v108 offset:1024
    ds_read_b64 v[104:105], v12
    ds_read_b128 v[100:103], v13
    v_mfma_f32_16x16x32_bf16 v[196:199], v[84:87], v[96:99], v[196:199]
    ds_read_b64_tr_b16 v[84:85], v109
    ds_read_b64_tr_b16 v[86:87], v109 offset:1024
    v_mfma_f32_16x16x32_bf16 v[200:203], v[88:91], v[96:99], v[200:203]
    ds_read_b64_tr_b16 v[88:89], v108 offset:512
    ds_read_b64_tr_b16 v[90:91], v108 offset:1536
    v_mfma_f32_16x16x32_bf16 v[204:207], v[92:95], v[96:99], v[204:207]
    ds_read_b64_tr_b16 v[92:93], v109 offset:512
    ds_read_b64_tr_b16 v[94:95], v109 offset:1536
    ds_read_b64_tr_b16 v[96:97], v106
    ds_read_b64_tr_b16 v[98:99], v107 offset:8
    s_add_u32 m0, s19, s20
    s_add_u32 s20, s20, 4096
    s_and_b32 s20, s20, 16383
    s_cmp_lt_i32 s45, 0
    v_add_u32_e64 v108, s20, v8
    v_add_u32_e64 v109, s20, v9
    s_cbranch_scc1 K2_wrap_25
K2_wrap_25_ret:
    s_waitcnt lgkmcnt(8)
    v_cmp_eq_u32_sdwa vcc, v104, v5 src0_sel:BYTE_0 src1_sel:DWORD
    v_cmp_eq_u32_sdwa s[46:47], v105, v5 src0_sel:BYTE_0 src1_sel:DWORD
    v_mad_u32_u16 v100, v100, s21, v1 op_sel:[1,0,0,0]
    v_mad_u32_u16 v101, v101, s21, v1 op_sel:[1,0,0,0]
    v_cndmask_b32 v106, v4, v7, vcc
    v_cndmask_b32 v107, v4, v7, s[46:47]
    v_mad_u32_u16 v102, v102, s21, v1 op_sel:[1,0,0,0]
    v_mad_u32_u16 v103, v103, s21, v1 op_sel:[1,0,0,0]
    v_add_u32_sdwa v12, s45, v3 dst_sel:DWORD dst_unused:UNUSED_PAD src0_sel:WORD_1 src1_sel:DWORD
    v_lshl_add_u32 v7, v12, 1, s100
    s_add_u32 s26, s26, 1
    s_waitcnt lgkmcnt(0)
    buffer_load_dwordx4 v100, s[4:7], s22 offen lds
    v_readlane_b32 s45, v6, s26
    buffer_load_dwordx4 v101, s[4:7], s23 offen offset:1024 lds
    buffer_load_dwordx4 v102, s[4:7], s24 offen offset:2048 lds
    buffer_load_dwordx4 v103, s[4:7], s25 offen offset:3072 lds
K2_skip_24:
    s_cmp_gt_u32 s36, s29
    s_waitcnt vmcnt(12)
    s_cbranch_scc0 K2_skip_26
    v_mfma_f32_16x16x32_bf16 v[208:211], v[80:83], v[96:99], v[208:211]
    v_add_u32_sdwa v13, s45, v2 dst_sel:DWORD dst_unused:UNUSED_PAD src0_sel:WORD_0 src1_sel:DWORD
    ds_read_b64_tr_b16 v[80:81], v108
    ds_read_b64_tr_b16 v[82:83], v108 offset:1024
    ds_read_b64 v[104:105], v12
    ds_read_b128 v[100:103], v13
    v_mfma_f32_16x16x32_bf16 v[212:215], v[84:87], v[96:99], v[212:215]
    ds_read_b64_tr_b16 v[84:85], v109
    ds_read_b64_tr_b16 v[86:87], v109 offset:1024
    v_mfma_f32_16x16x32_bf16 v[216:219], v[88:91], v[96:99], v[216:219]
    ds_read_b64_tr_b16 v[88:89], v108 offset:512
    ds_read_b64_tr_b16 v[90:91], v108 offset:1536
    v_mfma_f32_16x16x32_bf16 v[220:223], v[92:95], v[96:99], v[220:223]
    ds_read_b64_tr_b16 v[92:93], v109 offset:512
    ds_read_b64_tr_b16 v[94:95], v109 offset:1536
    ds_read_b64_tr_b16 v[96:97], v106
    ds_read_b64_tr_b16 v[98:99], v107 offset:8
    s_add_u32 m0, s19, s20
    s_add_u32 s20, s20, 4096
    s_and_b32 s20, s20, 16383
    s_cmp_lt_i32 s45, 0
    v_add_u32_e64 v108, s20, v8
    v_add_u32_e64 v109, s20, v9
    s_cbranch_scc1 K2_wrap_27
K2_wrap_27_ret:
    s_waitcnt lgkmcnt(8)
    v_cmp_eq_u32_sdwa vcc, v104, v5 src0_sel:BYTE_0 src1_sel:DWORD
    v_cmp_eq_u32_sdwa s[46:47], v105, v5 src0_sel:BYTE_0 src1_sel:DWORD
    v_mad_u32_u16 v100, v100, s21, v1 op_sel:[1,0,0,0]
    v_mad_u32_u16 v101, v101, s21, v1 op_sel:[1,0,0,0]
    v_cndmask_b32 v106, v4, v7, vcc
    v_cndmask_b32 v107, v4, v7, s[46:47]
    v_mad_u32_u16 v102, v102, s21, v1 op_sel:[1,0,0,0]
    v_mad_u32_u16 v103, v103, s21, v1 op_sel:[1,0,0,0]
    v_add_u32_sdwa v12, s45, v3 dst_sel:DWORD dst_unused:UNUSED_PAD src0_sel:WORD_1 src1_sel:DWORD
    v_lshl_add_u32 v7, v12, 1, s100
    s_add_u32 s26, s26, 1
    s_waitcnt lgkmcnt(0)
    buffer_load_dwordx4 v100, s[4:7], s22 offen lds
    v_readlane_b32 s45, v6, s26
    buffer_load_dwordx4 v101, s[4:7], s23 offen offset:1024 lds
    buffer_load_dwordx4 v102, s[4:7], s24 offen offset:2048 lds
    buffer_load_dwordx4 v103, s[4:7], s25 offen offset:3072 lds
K2_skip_26:
    s_cmp_gt_u32 s37, s29
    s_waitcnt vmcnt(12)
    s_cbranch_scc0 K2_skip_28
    v_mfma_f32_16x16x32_bf16 v[224:227], v[80:83], v[96:99], v[224:227]
    v_add_u32_sdwa v13, s45, v2 dst_sel:DWORD dst_unused:UNUSED_PAD src0_sel:WORD_0 src1_sel:DWORD
    ds_read_b64_tr_b16 v[80:81], v108
    ds_read_b64_tr_b16 v[82:83], v108 offset:1024
    ds_read_b64 v[104:105], v12
    ds_read_b128 v[100:103], v13
    v_mfma_f32_16x16x32_bf16 v[228:231], v[84:87], v[96:99], v[228:231]
    ds_read_b64_tr_b16 v[84:85], v109
    ds_read_b64_tr_b16 v[86:87], v109 offset:1024
    v_mfma_f32_16x16x32_bf16 v[232:235], v[88:91], v[96:99], v[232:235]
    ds_read_b64_tr_b16 v[88:89], v108 offset:512
    ds_read_b64_tr_b16 v[90:91], v108 offset:1536
    v_mfma_f32_16x16x32_bf16 v[236:239], v[92:95], v[96:99], v[236:239]
    ds_read_b64_tr_b16 v[92:93], v109 offset:512
    ds_read_b64_tr_b16 v[94:95], v109 offset:1536
    ds_read_b64_tr_b16 v[96:97], v106
    ds_read_b64_tr_b16 v[98:99], v107 offset:8
    s_add_u32 m0, s19, s20
    s_add_u32 s20, s20, 4096
    s_and_b32 s20, s20, 16383
    s_cmp_lt_i32 s45, 0
    v_add_u32_e64 v108, s20, v8
    v_add_u32_e64 v109, s20, v9
    s_cbranch_scc1 K2_wrap_29
K2_wrap_29_ret:
    s_waitcnt lgkmcnt(8)
    v_cmp_eq_u32_sdwa vcc, v104, v5 src0_sel:BYTE_0 src1_sel:DWORD
    v_cmp_eq_u32_sdwa s[46:47], v105, v5 src0_sel:BYTE_0 src1_sel:DWORD
    v_mad_u32_u16 v100, v100, s21, v1 op_sel:[1,0,0,0]
    v_mad_u32_u16 v101, v101, s21, v1 op_sel:[1,0,0,0]
    v_cndmask_b32 v106, v4, v7, vcc
    v_cndmask_b32 v107, v4, v7, s[46:47]
    v_mad_u32_u16 v102, v102, s21, v1 op_sel:[1,0,0,0]
    v_mad_u32_u16 v103, v103, s21, v1 op_sel:[1,0,0,0]
    v_add_u32_sdwa v12, s45, v3 dst_sel:DWORD dst_unused:UNUSED_PAD src0_sel:WORD_1 src1_sel:DWORD
    v_lshl_add_u32 v7, v12, 1, s100
    s_add_u32 s26, s26, 1
    s_waitcnt lgkmcnt(0)
    buffer_load_dwordx4 v100, s[4:7], s22 offen lds
    v_readlane_b32 s45, v6, s26
    buffer_load_dwordx4 v101, s[4:7], s23 offen offset:1024 lds
    buffer_load_dwordx4 v102, s[4:7], s24 offen offset:2048 lds
    buffer_load_dwordx4 v103, s[4:7], s25 offen offset:3072 lds
K2_skip_28:
    s_cmp_gt_u32 s38, s29
    s_waitcnt vmcnt(12)
    s_cbranch_scc0 K2_skip_30
    v_mfma_f32_16x16x32_bf16 v[240:243], v[80:83], v[96:99], v[240:243]
    v_add_u32_sdwa v13, s45, v2 dst_sel:DWORD dst_unused:UNUSED_PAD src0_sel:WORD_0 src1_sel:DWORD
    ds_read_b64_tr_b16 v[80:81], v108
    ds_read_b64_tr_b16 v[82:83], v108 offset:1024
    ds_read_b64 v[104:105], v12
    ds_read_b128 v[100:103], v13
    v_mfma_f32_16x16x32_bf16 v[244:247], v[84:87], v[96:99], v[244:247]
    ds_read_b64_tr_b16 v[84:85], v109
    ds_read_b64_tr_b16 v[86:87], v109 offset:1024
    v_mfma_f32_16x16x32_bf16 v[248:251], v[88:91], v[96:99], v[248:251]
    ds_read_b64_tr_b16 v[88:89], v108 offset:512
    ds_read_b64_tr_b16 v[90:91], v108 offset:1536
    v_mfma_f32_16x16x32_bf16 v[252:255], v[92:95], v[96:99], v[252:255]
    ds_read_b64_tr_b16 v[92:93], v109 offset:512
    ds_read_b64_tr_b16 v[94:95], v109 offset:1536
    ds_read_b64_tr_b16 v[96:97], v106
    ds_read_b64_tr_b16 v[98:99], v107 offset:8
    s_add_u32 m0, s19, s20
    s_add_u32 s20, s20, 4096
    s_and_b32 s20, s20, 16383
    s_cmp_lt_i32 s45, 0
    v_add_u32 v108, s20, v8
    v_add_u32 v109, s20, v9
    s_cbranch_scc1 K2_wrap_31
K2_wrap_31_ret:
    s_waitcnt lgkmcnt(8)
    v_cmp_eq_u32_sdwa vcc, v104, v5 src0_sel:BYTE_0 src1_sel:DWORD
    v_cmp_eq_u32_sdwa s[46:47], v105, v5 src0_sel:BYTE_0 src1_sel:DWORD
    v_mad_u32_u16 v100, v100, s21, v1 op_sel:[1,0,0,0]
    v_mad_u32_u16 v101, v101, s21, v1 op_sel:[1,0,0,0]
    v_cndmask_b32_e64 v106, v4, v7, vcc
    v_cndmask_b32 v107, v4, v7, s[46:47]
    v_mad_u32_u16 v102, v102, s21, v1 op_sel:[1,0,0,0]
    v_mad_u32_u16 v103, v103, s21, v1 op_sel:[1,0,0,0]
    v_add_u32_sdwa v12, s45, v3 dst_sel:DWORD dst_unused:UNUSED_PAD src0_sel:WORD_1 src1_sel:DWORD
    v_lshl_add_u32 v7, v12, 1, s100
    s_add_u32 s26, s26, 1
    s_waitcnt lgkmcnt(0)
    buffer_load_dwordx4 v100, s[4:7], s22 offen lds
    v_readlane_b32 s45, v6, s26
    buffer_load_dwordx4 v101, s[4:7], s23 offen offset:1024 lds
    buffer_load_dwordx4 v102, s[4:7], s24 offen offset:2048 lds
    buffer_load_dwordx4 v103, s[4:7], s25 offen offset:3072 lds
K2_skip_30:
    s_add_u32 s29, s29, 1
    s_cmp_lt_u32 s29, s30
    s_cbranch_scc1 K2_step
K2_roundend:
    s_cmp_eq_u32 s52, 1
    s_cbranch_scc1 K2_bound1
    s_cmp_eq_u32 s52, 2
    s_cbranch_scc1 K2_bound2
    s_cmp_eq_u32 s52, 3
    s_cbranch_scc1 K2_bound3
    v_and_b32 v114, 3, v15
    v_lshlrev_b32 v115, 2, v114
    ds_bpermute_b32 v112, v115, v110
    v_add_u32 v115, 16, v115
    ds_bpermute_b32 v113, v115, v110
    v_cmp_gt_u32 vcc, 3, v114
    v_bfe_u32 v114, v15, 2, 2
    v_lshrrev_b32 v115, 4, v15
    v_lshlrev_b32_e64 v115, 4, v115
    s_mul_i32 s43, s27, 98
    s_movk_i32 s53, 98
    v_mov_b32 v116, 0x80000000
    s_waitcnt lgkmcnt(0)
    v_cndmask_b32 v113, 0, v113, vcc
    v_and_b32 v117, 31, v112
    v_and_b32 v118, 31, v113
    v_lshl_add_u32 v117, v117, 2, v114
    v_lshl_add_u32 v118, v118, 2, v114
    v_cmp_gt_u32 vcc, s53, v117
    v_cmp_gt_u32 s[58:59], s53, v118
    v_add_u32 v117, s43, v117
    v_add_u32 v118, s43, v118
    v_lshl_add_u32 v117, v117, 9, v115
    v_lshl_add_u32 v118, v118, 9, v115
    v_and_b32 v112, 0x80, v112
    v_and_b32 v113, 0x80, v113
    v_cndmask_b32 v117, v116, v117, vcc
    v_cndmask_b32 v118, v116, v118, s[58:59]
    v_cmp_ne_u32 vcc, 0, v112
    v_cmp_ne_u32 s[58:59], 0, v113
    s_nop 1
    v_cndmask_b32_e64 v10, v116, v117, vcc
    v_cndmask_b32 v11, v116, v118, s[58:59]
    s_mov_b32 s26, 0
    v_readlane_b32 s45, v6, 0
    v_and_b32_e64 v14, 63, v15
    v_min_u32_e64 v14, 24, v14
    v_lshlrev_b32_e64 v14, 9, v14
    s_add_u32 s43, s101, 256
    buffer_load_dword v14, v14, s[4:7], s43 offen
    v_cvt_pk_bf16_f32 v144, v144, v145
    v_cvt_pk_bf16_f32 v145, v146, v147
    v_cvt_pk_bf16_f32 v148, v148, v149
    v_cvt_pk_bf16_f32 v149, v150, v151
    v_cvt_pk_bf16_f32 v152, v152, v153
    v_cvt_pk_bf16_f32 v153, v154, v155
    v_cvt_pk_bf16_f32 v156, v156, v157
    v_cvt_pk_bf16_f32 v157, v158, v159
    v_cvt_pk_bf16_f32 v160, v160, v161
    v_cvt_pk_bf16_f32 v161, v162, v163
    v_cvt_pk_bf16_f32 v164, v164, v165
    v_cvt_pk_bf16_f32 v165, v166, v167
    v_cvt_pk_bf16_f32 v168, v168, v169
    v_cvt_pk_bf16_f32 v169, v170, v171
    v_cvt_pk_bf16_f32 v172, v172, v173
    v_cvt_pk_bf16_f32 v173, v174, v175
    v_cvt_pk_bf16_f32 v176, v176, v177
    v_cvt_pk_bf16_f32 v177, v178, v179
    v_cvt_pk_bf16_f32 v180, v180, v181
    v_cvt_pk_bf16_f32 v181, v182, v183
    v_cvt_pk_bf16_f32 v184, v184, v185
    v_cvt_pk_bf16_f32 v185, v186, v187
    v_cvt_pk_bf16_f32 v188, v188, v189
    v_cvt_pk_bf16_f32 v189, v190, v191
    v_cvt_pk_bf16_f32 v192, v192, v193
    v_cvt_pk_bf16_f32 v193, v194, v195
    v_cvt_pk_bf16_f32 v196, v196, v197
    v_cvt_pk_bf16_f32 v197, v198, v199
    v_cvt_pk_bf16_f32 v200, v200, v201
    v_cvt_pk_bf16_f32 v201, v202, v203
    v_cvt_pk_bf16_f32 v204, v204, v205
    v_cvt_pk_bf16_f32 v205, v206, v207
    s_mov_b64 vcc, s[94:95]
    v_cndmask_b32_dpp v146, v160, v144, vcc quad_perm:[1,0,3,2] row_mask:0xf bank_mask:0xf
    v_cndmask_b32_dpp v147, v161, v145, vcc quad_perm:[1,0,3,2] row_mask:0xf bank_mask:0xf
    v_cndmask_b32_dpp v150, v164, v148, vcc quad_perm:[1,0,3,2] row_mask:0xf bank_mask:0xf
    v_cndmask_b32_dpp v151, v165, v149, vcc quad_perm:[1,0,3,2] row_mask:0xf bank_mask:0xf
    v_cndmask_b32_dpp v154, v168, v152, vcc quad_perm:[1,0,3,2] row_mask:0xf bank_mask:0xf
    s_nop 0
    v_cndmask_b32_dpp v155, v169, v153, vcc quad_perm:[1,0,3,2] row_mask:0xf bank_mask:0xf
    v_cndmask_b32_dpp v158, v172, v156, vcc quad_perm:[1,0,3,2] row_mask:0xf bank_mask:0xf
    v_cndmask_b32_dpp v159, v173, v157, vcc quad_perm:[1,0,3,2] row_mask:0xf bank_mask:0xf
    v_cndmask_b32_dpp v178, v192, v176, vcc quad_perm:[1,0,3,2] row_mask:0xf bank_mask:0xf
    v_cndmask_b32_dpp v179, v193, v177, vcc quad_perm:[1,0,3,2] row_mask:0xf bank_mask:0xf
    v_cndmask_b32_dpp v182, v196, v180, vcc quad_perm:[1,0,3,2] row_mask:0xf bank_mask:0xf
    v_cndmask_b32_dpp v183, v197, v181, vcc quad_perm:[1,0,3,2] row_mask:0xf bank_mask:0xf
    v_cndmask_b32_dpp v186, v200, v184, vcc quad_perm:[1,0,3,2] row_mask:0xf bank_mask:0xf
    v_cndmask_b32_dpp v187, v201, v185, vcc quad_perm:[1,0,3,2] row_mask:0xf bank_mask:0xf
    v_cndmask_b32_dpp v190, v204, v188, vcc quad_perm:[1,0,3,2] row_mask:0xf bank_mask:0xf
    v_cndmask_b32_dpp v191, v205, v189, vcc quad_perm:[1,0,3,2] row_mask:0xf bank_mask:0xf
    s_not_b64 vcc, vcc
    v_cndmask_b32_dpp v162, v144, v160, vcc quad_perm:[1,0,3,2] row_mask:0xf bank_mask:0xf
    v_cndmask_b32_dpp v163, v145, v161, vcc quad_perm:[1,0,3,2] row_mask:0xf bank_mask:0xf
    v_cndmask_b32_dpp v166, v148, v164, vcc quad_perm:[1,0,3,2] row_mask:0xf bank_mask:0xf
    v_cndmask_b32_dpp v167, v149, v165, vcc quad_perm:[1,0,3,2] row_mask:0xf bank_mask:0xf
    s_nop 0
    v_cndmask_b32_dpp v170, v152, v168, vcc quad_perm:[1,0,3,2] row_mask:0xf bank_mask:0xf
    v_cndmask_b32_dpp v171, v153, v169, vcc quad_perm:[1,0,3,2] row_mask:0xf bank_mask:0xf
    v_cndmask_b32_dpp v174, v156, v172, vcc quad_perm:[1,0,3,2] row_mask:0xf bank_mask:0xf
    v_cndmask_b32_dpp v175, v157, v173, vcc quad_perm:[1,0,3,2] row_mask:0xf bank_mask:0xf
    v_cndmask_b32_dpp v194, v176, v192, vcc quad_perm:[1,0,3,2] row_mask:0xf bank_mask:0xf
    v_cndmask_b32_dpp v195, v177, v193, vcc quad_perm:[1,0,3,2] row_mask:0xf bank_mask:0xf
    v_cndmask_b32_dpp v198, v180, v196, vcc quad_perm:[1,0,3,2] row_mask:0xf bank_mask:0xf
    v_cndmask_b32_dpp v199, v181, v197, vcc quad_perm:[1,0,3,2] row_mask:0xf bank_mask:0xf
    v_cndmask_b32_dpp v202, v184, v200, vcc quad_perm:[1,0,3,2] row_mask:0xf bank_mask:0xf
    v_cndmask_b32_dpp v203, v185, v201, vcc quad_perm:[1,0,3,2] row_mask:0xf bank_mask:0xf
    v_cndmask_b32_dpp v206, v188, v204, vcc quad_perm:[1,0,3,2] row_mask:0xf bank_mask:0xf
    v_cndmask_b32_dpp v207, v189, v205, vcc quad_perm:[1,0,3,2] row_mask:0xf bank_mask:0xf
    s_mov_b64 vcc, s[96:97]
    v_cndmask_b32_dpp v112, v178, v146, vcc quad_perm:[2,3,0,1] row_mask:0xf bank_mask:0xf
    v_cndmask_b32_dpp v113, v179, v147, vcc quad_perm:[2,3,0,1] row_mask:0xf bank_mask:0xf
    v_cndmask_b32_dpp v114, v182, v150, vcc quad_perm:[2,3,0,1] row_mask:0xf bank_mask:0xf
    s_nop 0
    v_cndmask_b32_dpp v115, v183, v151, vcc quad_perm:[2,3,0,1] row_mask:0xf bank_mask:0xf
    v_cndmask_b32_dpp v116, v186, v154, vcc quad_perm:[2,3,0,1] row_mask:0xf bank_mask:0xf
    v_cndmask_b32_dpp v117, v187, v155, vcc quad_perm:[2,3,0,1] row_mask:0xf bank_mask:0xf
    v_cndmask_b32_dpp v118, v190, v158, vcc quad_perm:[2,3,0,1] row_mask:0xf bank_mask:0xf
    v_cndmask_b32_dpp v119, v191, v159, vcc quad_perm:[2,3,0,1] row_mask:0xf bank_mask:0xf
    v_cndmask_b32_dpp v120, v194, v162, vcc quad_perm:[2,3,0,1] row_mask:0xf bank_mask:0xf
    v_cndmask_b32_dpp v121, v195, v163, vcc quad_perm:[2,3,0,1] row_mask:0xf bank_mask:0xf
    v_cndmask_b32_dpp v122, v198, v166, vcc quad_perm:[2,3,0,1] row_mask:0xf bank_mask:0xf
    v_cndmask_b32_dpp v123, v199, v167, vcc quad_perm:[2,3,0,1] row_mask:0xf bank_mask:0xf
    v_cndmask_b32_dpp v124, v202, v170, vcc quad_perm:[2,3,0,1] row_mask:0xf bank_mask:0xf
    v_cndmask_b32_dpp v125, v203, v171, vcc quad_perm:[2,3,0,1] row_mask:0xf bank_mask:0xf
    v_cndmask_b32_dpp v126, v206, v174, vcc quad_perm:[2,3,0,1] row_mask:0xf bank_mask:0xf
    v_cndmask_b32_dpp v127, v207, v175, vcc quad_perm:[2,3,0,1] row_mask:0xf bank_mask:0xf
    s_not_b64 vcc, vcc
    v_cndmask_b32_dpp v128, v146, v178, vcc quad_perm:[2,3,0,1] row_mask:0xf bank_mask:0xf
    v_cndmask_b32_dpp v129, v147, v179, vcc quad_perm:[2,3,0,1] row_mask:0xf bank_mask:0xf
    s_nop 0
    v_cndmask_b32_dpp v130, v150, v182, vcc quad_perm:[2,3,0,1] row_mask:0xf bank_mask:0xf
    v_cndmask_b32_dpp v131, v151, v183, vcc quad_perm:[2,3,0,1] row_mask:0xf bank_mask:0xf
    v_cndmask_b32_dpp v132, v154, v186, vcc quad_perm:[2,3,0,1] row_mask:0xf bank_mask:0xf
    v_cndmask_b32_dpp v133, v155, v187, vcc quad_perm:[2,3,0,1] row_mask:0xf bank_mask:0xf
    v_cndmask_b32_dpp v134, v158, v190, vcc quad_perm:[2,3,0,1] row_mask:0xf bank_mask:0xf
    v_cndmask_b32_dpp v135, v159, v191, vcc quad_perm:[2,3,0,1] row_mask:0xf bank_mask:0xf
    v_cndmask_b32_dpp v136, v162, v194, vcc quad_perm:[2,3,0,1] row_mask:0xf bank_mask:0xf
    v_cndmask_b32_dpp v137, v163, v195, vcc quad_perm:[2,3,0,1] row_mask:0xf bank_mask:0xf
    v_cndmask_b32_dpp v138, v166, v198, vcc quad_perm:[2,3,0,1] row_mask:0xf bank_mask:0xf
    v_cndmask_b32_dpp v139, v167, v199, vcc quad_perm:[2,3,0,1] row_mask:0xf bank_mask:0xf
    v_cndmask_b32_dpp v140, v170, v202, vcc quad_perm:[2,3,0,1] row_mask:0xf bank_mask:0xf
    v_cndmask_b32_dpp v141, v171, v203, vcc quad_perm:[2,3,0,1] row_mask:0xf bank_mask:0xf
    v_cndmask_b32_dpp v142, v174, v206, vcc quad_perm:[2,3,0,1] row_mask:0xf bank_mask:0xf
    v_cndmask_b32_dpp v143, v175, v207, vcc quad_perm:[2,3,0,1] row_mask:0xf bank_mask:0xf
    s_cmp_eq_u32 s32, 0
    s_waitcnt vmcnt(12)
    s_cbranch_scc1 K2_z_33
    s_nop 0
    v_mfma_f32_16x16x32_bf16 v[144:147], v[80:83], v[96:99], 0
    v_add_u32_sdwa v13, s45, v2 dst_sel:DWORD dst_unused:UNUSED_PAD src0_sel:WORD_0 src1_sel:DWORD
    ds_read_b64_tr_b16 v[80:81], v108
    ds_read_b64_tr_b16 v[82:83], v108 offset:1024
    ds_read_b64 v[104:105], v12
    ds_read_b128 v[100:103], v13
    v_mfma_f32_16x16x32_bf16 v[148:151], v[84:87], v[96:99], 0
    ds_read_b64_tr_b16 v[84:85], v109
    ds_read_b64_tr_b16 v[86:87], v109 offset:1024
    v_mfma_f32_16x16x32_bf16 v[152:155], v[88:91], v[96:99], 0
    ds_read_b64_tr_b16 v[88:89], v108 offset:512
    ds_read_b64_tr_b16 v[90:91], v108 offset:1536
    v_mfma_f32_16x16x32_bf16 v[156:159], v[92:95], v[96:99], 0
    ds_read_b64_tr_b16 v[92:93], v109 offset:512
    ds_read_b64_tr_b16 v[94:95], v109 offset:1536
    ds_read_b64_tr_b16 v[96:97], v106
    ds_read_b64_tr_b16 v[98:99], v107 offset:8
    s_add_u32 m0, s19, s20
    s_add_u32 s20, s20, 4096
    s_and_b32 s20, s20, 16383
    s_cmp_lt_i32 s45, 0
    v_add_u32 v108, s20, v8
    v_add_u32 v109, s20, v9
    s_cbranch_scc1 K2_wrap_34
K2_wrap_34_ret:
    s_waitcnt lgkmcnt(8)
    v_cmp_eq_u32_sdwa vcc, v104, v5 src0_sel:BYTE_0 src1_sel:DWORD
    v_mfma_f32_16x16x32_bf16 v[16:19], a[0:3], v[112:115], v[16:19]
    v_cmp_eq_u32_sdwa s[46:47], v105, v5 src0_sel:BYTE_0 src1_sel:DWORD
    v_mad_u32_u16 v100, v100, s21, v1 op_sel:[1,0,0,0]
    v_mfma_f32_16x16x32_bf16 v[20:23], a[4:7], v[112:115], v[20:23]
    v_mad_u32_u16 v101, v101, s21, v1 op_sel:[1,0,0,0]
    v_cndmask_b32_e64 v106, v4, v7, vcc
    v_mfma_f32_16x16x32_bf16 v[24:27], a[8:11], v[112:115], v[24:27]
    v_cndmask_b32 v107, v4, v7, s[46:47]
    v_mad_u32_u16 v102, v102, s21, v1 op_sel:[1,0,0,0]
    v_mfma_f32_16x16x32_bf16 v[28:31], a[12:15], v[112:115], v[28:31]
    v_mad_u32_u16 v103, v103, s21, v1 op_sel:[1,0,0,0]
    v_add_u32_sdwa v12, s45, v3 dst_sel:DWORD dst_unused:UNUSED_PAD src0_sel:WORD_1 src1_sel:DWORD
    v_mfma_f32_16x16x32_bf16 v[16:19], a[16:19], v[116:119], v[16:19]
    v_lshl_add_u32 v7, v12, 1, s100
    s_add_u32 s26, s26, 1
    v_mfma_f32_16x16x32_bf16 v[20:23], a[20:23], v[116:119], v[20:23]
    s_waitcnt lgkmcnt(0)
    buffer_load_dwordx4 v100, s[4:7], s22 offen lds
    v_mfma_f32_16x16x32_bf16 v[24:27], a[24:27], v[116:119], v[24:27]
    v_readlane_b32 s45, v6, s26
    buffer_load_dwordx4 v101, s[4:7], s23 offen offset:1024 lds
    v_mfma_f32_16x16x32_bf16 v[28:31], a[28:31], v[116:119], v[28:31]
    buffer_load_dwordx4 v102, s[4:7], s24 offen offset:2048 lds
    buffer_load_dwordx4 v103, s[4:7], s25 offen offset:3072 lds
K2_z_33_ret:
    s_cmp_eq_u32 s33, 0
    s_waitcnt vmcnt(12)
    s_cbranch_scc1 K2_z_35
    s_nop 0
    v_mfma_f32_16x16x32_bf16 v[160:163], v[80:83], v[96:99], 0
    v_add_u32_sdwa v13, s45, v2 dst_sel:DWORD dst_unused:UNUSED_PAD src0_sel:WORD_0 src1_sel:DWORD
    ds_read_b64_tr_b16 v[80:81], v108
    ds_read_b64_tr_b16 v[82:83], v108 offset:1024
    ds_read_b64 v[104:105], v12
    ds_read_b128 v[100:103], v13
    v_mfma_f32_16x16x32_bf16 v[164:167], v[84:87], v[96:99], 0
    ds_read_b64_tr_b16 v[84:85], v109
    ds_read_b64_tr_b16 v[86:87], v109 offset:1024
    v_mfma_f32_16x16x32_bf16 v[168:171], v[88:91], v[96:99], 0
    ds_read_b64_tr_b16 v[88:89], v108 offset:512
    ds_read_b64_tr_b16 v[90:91], v108 offset:1536
    v_mfma_f32_16x16x32_bf16 v[172:175], v[92:95], v[96:99], 0
    ds_read_b64_tr_b16 v[92:93], v109 offset:512
    ds_read_b64_tr_b16 v[94:95], v109 offset:1536
    ds_read_b64_tr_b16 v[96:97], v106
    ds_read_b64_tr_b16 v[98:99], v107 offset:8
    s_add_u32 m0, s19, s20
    s_add_u32 s20, s20, 4096
    s_and_b32 s20, s20, 16383
    s_cmp_lt_i32 s45, 0
    v_add_u32 v108, s20, v8
    v_add_u32 v109, s20, v9
    s_cbranch_scc1 K2_wrap_36
K2_wrap_36_ret:
    s_waitcnt lgkmcnt(8)
    v_cmp_eq_u32_sdwa vcc, v104, v5 src0_sel:BYTE_0 src1_sel:DWORD
    v_mfma_f32_16x16x32_bf16 v[32:35], a[64:67], v[120:123], v[32:35]
    v_cmp_eq_u32_sdwa s[46:47], v105, v5 src0_sel:BYTE_0 src1_sel:DWORD
    v_mad_u32_u16 v100, v100, s21, v1 op_sel:[1,0,0,0]
    v_mfma_f32_16x16x32_bf16 v[36:39], a[68:71], v[120:123], v[36:39]
    v_mad_u32_u16 v101, v101, s21, v1 op_sel:[1,0,0,0]
    v_cndmask_b32_e64 v106, v4, v7, vcc
    v_mfma_f32_16x16x32_bf16 v[40:43], a[72:75], v[120:123], v[40:43]
    v_cndmask_b32 v107, v4, v7, s[46:47]
    v_mad_u32_u16 v102, v102, s21, v1 op_sel:[1,0,0,0]
    v_mfma_f32_16x16x32_bf16 v[44:47], a[76:79], v[120:123], v[44:47]
    v_mad_u32_u16 v103, v103, s21, v1 op_sel:[1,0,0,0]
    v_add_u32_sdwa v12, s45, v3 dst_sel:DWORD dst_unused:UNUSED_PAD src0_sel:WORD_1 src1_sel:DWORD
    v_mfma_f32_16x16x32_bf16 v[32:35], a[80:83], v[124:127], v[32:35]
    v_lshl_add_u32 v7, v12, 1, s100
    s_add_u32 s26, s26, 1
    v_mfma_f32_16x16x32_bf16 v[36:39], a[84:87], v[124:127], v[36:39]
    s_waitcnt lgkmcnt(0)
    buffer_load_dwordx4 v100, s[4:7], s22 offen lds
    v_mfma_f32_16x16x32_bf16 v[40:43], a[88:91], v[124:127], v[40:43]
    v_readlane_b32 s45, v6, s26
    buffer_load_dwordx4 v101, s[4:7], s23 offen offset:1024 lds
    v_mfma_f32_16x16x32_bf16 v[44:47], a[92:95], v[124:127], v[44:47]
    buffer_load_dwordx4 v102, s[4:7], s24 offen offset:2048 lds
    buffer_load_dwordx4 v103, s[4:7], s25 offen offset:3072 lds
K2_z_35_ret:
    s_cmp_eq_u32 s34, 0
    s_waitcnt vmcnt(12)
    s_cbranch_scc1 K2_z_37
    s_nop 0
    v_mfma_f32_16x16x32_bf16 v[176:179], v[80:83], v[96:99], 0
    v_add_u32_sdwa v13, s45, v2 dst_sel:DWORD dst_unused:UNUSED_PAD src0_sel:WORD_0 src1_sel:DWORD
    ds_read_b64_tr_b16 v[80:81], v108
    ds_read_b64_tr_b16 v[82:83], v108 offset:1024
    ds_read_b64 v[104:105], v12
    ds_read_b128 v[100:103], v13
    v_mfma_f32_16x16x32_bf16 v[180:183], v[84:87], v[96:99], 0
    ds_read_b64_tr_b16 v[84:85], v109
    ds_read_b64_tr_b16 v[86:87], v109 offset:1024
    v_mfma_f32_16x16x32_bf16 v[184:187], v[88:91], v[96:99], 0
    ds_read_b64_tr_b16 v[88:89], v108 offset:512
    ds_read_b64_tr_b16 v[90:91], v108 offset:1536
    v_mfma_f32_16x16x32_bf16 v[188:191], v[92:95], v[96:99], 0
    ds_read_b64_tr_b16 v[92:93], v109 offset:512
    ds_read_b64_tr_b16 v[94:95], v109 offset:1536
    ds_read_b64_tr_b16 v[96:97], v106
    ds_read_b64_tr_b16 v[98:99], v107 offset:8
    s_add_u32 m0, s19, s20
    s_add_u32 s20, s20, 4096
    s_and_b32 s20, s20, 16383
    s_cmp_lt_i32 s45, 0
    v_add_u32 v108, s20, v8
    v_add_u32 v109, s20, v9
    s_cbranch_scc1 K2_wrap_38
K2_wrap_38_ret:
    s_waitcnt lgkmcnt(8)
    v_cmp_eq_u32_sdwa vcc, v104, v5 src0_sel:BYTE_0 src1_sel:DWORD
    v_mfma_f32_16x16x32_bf16 v[48:51], a[64:67], v[128:131], v[48:51]
    v_cmp_eq_u32_sdwa s[46:47], v105, v5 src0_sel:BYTE_0 src1_sel:DWORD
    v_mad_u32_u16 v100, v100, s21, v1 op_sel:[1,0,0,0]
    v_mfma_f32_16x16x32_bf16 v[52:55], a[68:71], v[128:131], v[52:55]
    v_mad_u32_u16 v101, v101, s21, v1 op_sel:[1,0,0,0]
    v_cndmask_b32_e64 v106, v4, v7, vcc
    v_mfma_f32_16x16x32_bf16 v[56:59], a[72:75], v[128:131], v[56:59]
    v_cndmask_b32 v107, v4, v7, s[46:47]
    v_mad_u32_u16 v102, v102, s21, v1 op_sel:[1,0,0,0]
    v_mfma_f32_16x16x32_bf16 v[60:63], a[76:79], v[128:131], v[60:63]
    v_mad_u32_u16 v103, v103, s21, v1 op_sel:[1,0,0,0]
    v_add_u32_sdwa v12, s45, v3 dst_sel:DWORD dst_unused:UNUSED_PAD src0_sel:WORD_1 src1_sel:DWORD
    v_mfma_f32_16x16x32_bf16 v[48:51], a[80:83], v[132:135], v[48:51]
    v_lshl_add_u32 v7, v12, 1, s100
    s_add_u32 s26, s26, 1
    v_mfma_f32_16x16x32_bf16 v[52:55], a[84:87], v[132:135], v[52:55]
    s_waitcnt lgkmcnt(0)
    buffer_load_dwordx4 v100, s[4:7], s22 offen lds
    v_mfma_f32_16x16x32_bf16 v[56:59], a[88:91], v[132:135], v[56:59]
    v_readlane_b32 s45, v6, s26
    buffer_load_dwordx4 v101, s[4:7], s23 offen offset:1024 lds
    v_mfma_f32_16x16x32_bf16 v[60:63], a[92:95], v[132:135], v[60:63]
    buffer_load_dwordx4 v102, s[4:7], s24 offen offset:2048 lds
    buffer_load_dwordx4 v103, s[4:7], s25 offen offset:3072 lds
K2_z_37_ret:
    s_cmp_eq_u32 s35, 0
    s_waitcnt vmcnt(12)
    s_cbranch_scc1 K2_z_39
    s_nop 0
    v_mfma_f32_16x16x32_bf16 v[192:195], v[80:83], v[96:99], 0
    v_add_u32_sdwa v13, s45, v2 dst_sel:DWORD dst_unused:UNUSED_PAD src0_sel:WORD_0 src1_sel:DWORD
    ds_read_b64_tr_b16 v[80:81], v108
    ds_read_b64_tr_b16 v[82:83], v108 offset:1024
    ds_read_b64 v[104:105], v12
    ds_read_b128 v[100:103], v13
    v_mfma_f32_16x16x32_bf16 v[196:199], v[84:87], v[96:99], 0
    ds_read_b64_tr_b16 v[84:85], v109
    ds_read_b64_tr_b16 v[86:87], v109 offset:1024
    v_mfma_f32_16x16x32_bf16 v[200:203], v[88:91], v[96:99], 0
    ds_read_b64_tr_b16 v[88:89], v108 offset:512
    ds_read_b64_tr_b16 v[90:91], v108 offset:1536
    v_mfma_f32_16x16x32_bf16 v[204:207], v[92:95], v[96:99], 0
    ds_read_b64_tr_b16 v[92:93], v109 offset:512
    ds_read_b64_tr_b16 v[94:95], v109 offset:1536
    ds_read_b64_tr_b16 v[96:97], v106
    ds_read_b64_tr_b16 v[98:99], v107 offset:8
    s_add_u32 m0, s19, s20
    s_add_u32 s20, s20, 4096
    s_and_b32 s20, s20, 16383
    s_cmp_lt_i32 s45, 0
    v_add_u32 v108, s20, v8
    v_add_u32 v109, s20, v9
    s_cbranch_scc1 K2_wrap_40
K2_wrap_40_ret:
    s_waitcnt lgkmcnt(8)
    v_cmp_eq_u32_sdwa vcc, v104, v5 src0_sel:BYTE_0 src1_sel:DWORD
    v_mfma_f32_16x16x32_bf16 v[64:67], a[64:67], v[136:139], v[64:67]
    v_cmp_eq_u32_sdwa s[46:47], v105, v5 src0_sel:BYTE_0 src1_sel:DWORD
    v_mad_u32_u16 v100, v100, s21, v1 op_sel:[1,0,0,0]
    v_mfma_f32_16x16x32_bf16 v[68:71], a[68:71], v[136:139], v[68:71]
    v_mad_u32_u16 v101, v101, s21, v1 op_sel:[1,0,0,0]
    v_cndmask_b32_e64 v106, v4, v7, vcc
    v_mfma_f32_16x16x32_bf16 v[72:75], a[72:75], v[136:139], v[72:75]
    v_cndmask_b32 v107, v4, v7, s[46:47]
    v_mad_u32_u16 v102, v102, s21, v1 op_sel:[1,0,0,0]
    v_mfma_f32_16x16x32_bf16 v[76:79], a[76:79], v[136:139], v[76:79]
    v_mad_u32_u16 v103, v103, s21, v1 op_sel:[1,0,0,0]
    v_add_u32_sdwa v12, s45, v3 dst_sel:DWORD dst_unused:UNUSED_PAD src0_sel:WORD_1 src1_sel:DWORD
    v_mfma_f32_16x16x32_bf16 v[64:67], a[80:83], v[140:143], v[64:67]
    v_lshl_add_u32 v7, v12, 1, s100
    s_add_u32 s26, s26, 1
    v_mfma_f32_16x16x32_bf16 v[68:71], a[84:87], v[140:143], v[68:71]
    s_waitcnt lgkmcnt(0)
    buffer_load_dwordx4 v100, s[4:7], s22 offen lds
    v_mfma_f32_16x16x32_bf16 v[72:75], a[88:91], v[140:143], v[72:75]
    v_readlane_b32 s45, v6, s26
    buffer_load_dwordx4 v101, s[4:7], s23 offen offset:1024 lds
    v_mfma_f32_16x16x32_bf16 v[76:79], a[92:95], v[140:143], v[76:79]
    buffer_load_dwordx4 v102, s[4:7], s24 offen offset:2048 lds
    buffer_load_dwordx4 v103, s[4:7], s25 offen offset:3072 lds
K2_z_39_ret:
    v_cvt_pk_bf16_f32 v208, v208, v209
    v_cvt_pk_bf16_f32 v209, v210, v211
    v_cvt_pk_bf16_f32 v212, v212, v213
    v_cvt_pk_bf16_f32 v213, v214, v215
    v_cvt_pk_bf16_f32 v216, v216, v217
    v_cvt_pk_bf16_f32 v217, v218, v219
    v_cvt_pk_bf16_f32 v220, v220, v221
    v_cvt_pk_bf16_f32 v221, v222, v223
    v_cvt_pk_bf16_f32 v224, v224, v225
    v_cvt_pk_bf16_f32 v225, v226, v227
    v_cvt_pk_bf16_f32 v228, v228, v229
    v_cvt_pk_bf16_f32 v229, v230, v231
    v_cvt_pk_bf16_f32 v232, v232, v233
    v_cvt_pk_bf16_f32 v233, v234, v235
    v_cvt_pk_bf16_f32 v236, v236, v237
    v_cvt_pk_bf16_f32 v237, v238, v239
    v_cvt_pk_bf16_f32 v240, v240, v241
    v_cvt_pk_bf16_f32 v241, v242, v243
    v_cvt_pk_bf16_f32 v244, v244, v245
    v_cvt_pk_bf16_f32 v245, v246, v247
    v_cvt_pk_bf16_f32 v248, v248, v249
    v_cvt_pk_bf16_f32 v249, v250, v251
    v_cvt_pk_bf16_f32 v252, v252, v253
    v_cvt_pk_bf16_f32 v253, v254, v255
    s_mov_b64 vcc, s[94:95]
    v_cndmask_b32_dpp v210, v224, v208, vcc quad_perm:[1,0,3,2] row_mask:0xf bank_mask:0xf
    s_nop 0
    v_cndmask_b32_dpp v211, v225, v209, vcc quad_perm:[1,0,3,2] row_mask:0xf bank_mask:0xf
    v_cndmask_b32_dpp v214, v228, v212, vcc quad_perm:[1,0,3,2] row_mask:0xf bank_mask:0xf
    v_cndmask_b32_dpp v215, v229, v213, vcc quad_perm:[1,0,3,2] row_mask:0xf bank_mask:0xf
    v_cndmask_b32_dpp v218, v232, v216, vcc quad_perm:[1,0,3,2] row_mask:0xf bank_mask:0xf
    v_cndmask_b32_dpp v219, v233, v217, vcc quad_perm:[1,0,3,2] row_mask:0xf bank_mask:0xf
    v_cndmask_b32_dpp v222, v236, v220, vcc quad_perm:[1,0,3,2] row_mask:0xf bank_mask:0xf
    v_cndmask_b32_dpp v223, v237, v221, vcc quad_perm:[1,0,3,2] row_mask:0xf bank_mask:0xf
    s_not_b64 vcc, vcc
    s_nop 0
    v_cndmask_b32_dpp v226, v208, v224, vcc quad_perm:[1,0,3,2] row_mask:0xf bank_mask:0xf
    v_cndmask_b32_dpp v227, v209, v225, vcc quad_perm:[1,0,3,2] row_mask:0xf bank_mask:0xf
    v_cndmask_b32_dpp v230, v212, v228, vcc quad_perm:[1,0,3,2] row_mask:0xf bank_mask:0xf
    v_cndmask_b32_dpp v231, v213, v229, vcc quad_perm:[1,0,3,2] row_mask:0xf bank_mask:0xf
    v_cndmask_b32_dpp v234, v216, v232, vcc quad_perm:[1,0,3,2] row_mask:0xf bank_mask:0xf
    v_cndmask_b32_dpp v235, v217, v233, vcc quad_perm:[1,0,3,2] row_mask:0xf bank_mask:0xf
    v_cndmask_b32_dpp v238, v220, v236, vcc quad_perm:[1,0,3,2] row_mask:0xf bank_mask:0xf
    v_cndmask_b32_dpp v239, v221, v237, vcc quad_perm:[1,0,3,2] row_mask:0xf bank_mask:0xf
    v_mov_b32_dpp v242, v240 quad_perm:[1,0,3,2] row_mask:0xf bank_mask:0xf
    v_mov_b32_dpp v243, v241 quad_perm:[1,0,3,2] row_mask:0xf bank_mask:0xf
    v_mov_b32_dpp v246, v244 quad_perm:[1,0,3,2] row_mask:0xf bank_mask:0xf
    v_mov_b32_dpp v247, v245 quad_perm:[1,0,3,2] row_mask:0xf bank_mask:0xf
    v_mov_b32_dpp v250, v248 quad_perm:[1,0,3,2] row_mask:0xf bank_mask:0xf
    v_mov_b32_dpp v251, v249 quad_perm:[1,0,3,2] row_mask:0xf bank_mask:0xf
    v_mov_b32_dpp v254, v252 quad_perm:[1,0,3,2] row_mask:0xf bank_mask:0xf
    v_mov_b32_dpp v255, v253 quad_perm:[1,0,3,2] row_mask:0xf bank_mask:0xf
    s_nop 0
    s_mov_b64 vcc, s[96:97]
    v_cndmask_b32_dpp v112, v240, v210, vcc quad_perm:[2,3,0,1] row_mask:0xf bank_mask:0xf
    v_cndmask_b32_dpp v113, v241, v211, vcc quad_perm:[2,3,0,1] row_mask:0xf bank_mask:0xf
    v_cndmask_b32_dpp v114, v244, v214, vcc quad_perm:[2,3,0,1] row_mask:0xf bank_mask:0xf
    v_cndmask_b32_dpp v115, v245, v215, vcc quad_perm:[2,3,0,1] row_mask:0xf bank_mask:0xf
    v_cndmask_b32_dpp v116, v248, v218, vcc quad_perm:[2,3,0,1] row_mask:0xf bank_mask:0xf
    v_cndmask_b32_dpp v117, v249, v219, vcc quad_perm:[2,3,0,1] row_mask:0xf bank_mask:0xf
    v_cndmask_b32_dpp v118, v252, v222, vcc quad_perm:[2,3,0,1] row_mask:0xf bank_mask:0xf
    v_cndmask_b32_dpp v119, v253, v223, vcc quad_perm:[2,3,0,1] row_mask:0xf bank_mask:0xf
    v_cndmask_b32_dpp v120, v242, v226, vcc quad_perm:[2,3,0,1] row_mask:0xf bank_mask:0xf
    v_cndmask_b32_dpp v121, v243, v227, vcc quad_perm:[2,3,0,1] row_mask:0xf bank_mask:0xf
    v_cndmask_b32_dpp v122, v246, v230, vcc quad_perm:[2,3,0,1] row_mask:0xf bank_mask:0xf
    v_cndmask_b32_dpp v123, v247, v231, vcc quad_perm:[2,3,0,1] row_mask:0xf bank_mask:0xf
    v_cndmask_b32_dpp v124, v250, v234, vcc quad_perm:[2,3,0,1] row_mask:0xf bank_mask:0xf
    v_cndmask_b32_dpp v125, v251, v235, vcc quad_perm:[2,3,0,1] row_mask:0xf bank_mask:0xf
    v_cndmask_b32_dpp v126, v254, v238, vcc quad_perm:[2,3,0,1] row_mask:0xf bank_mask:0xf
    v_cndmask_b32_dpp v127, v255, v239, vcc quad_perm:[2,3,0,1] row_mask:0xf bank_mask:0xf
    s_not_b64 vcc, vcc
    v_cndmask_b32_dpp v128, v210, v240, vcc quad_perm:[2,3,0,1] row_mask:0xf bank_mask:0xf
    v_cndmask_b32_dpp v129, v211, v241, vcc quad_perm:[2,3,0,1] row_mask:0xf bank_mask:0xf
    v_cndmask_b32_dpp v130, v214, v244, vcc quad_perm:[2,3,0,1] row_mask:0xf bank_mask:0xf
    v_cndmask_b32_dpp v131, v215, v245, vcc quad_perm:[2,3,0,1] row_mask:0xf bank_mask:0xf
    v_cndmask_b32_dpp v132, v218, v248, vcc quad_perm:[2,3,0,1] row_mask:0xf bank_mask:0xf
    v_cndmask_b32_dpp v133, v219, v249, vcc quad_perm:[2,3,0,1] row_mask:0xf bank_mask:0xf
    s_nop 0
    v_cndmask_b32_dpp v134, v222, v252, vcc quad_perm:[2,3,0,1] row_mask:0xf bank_mask:0xf
    v_cndmask_b32_dpp v135, v223, v253, vcc quad_perm:[2,3,0,1] row_mask:0xf bank_mask:0xf
    v_cndmask_b32_dpp v136, v226, v242, vcc quad_perm:[2,3,0,1] row_mask:0xf bank_mask:0xf
    v_cndmask_b32_dpp v137, v227, v243, vcc quad_perm:[2,3,0,1] row_mask:0xf bank_mask:0xf
    v_cndmask_b32_dpp v138, v230, v246, vcc quad_perm:[2,3,0,1] row_mask:0xf bank_mask:0xf
    v_cndmask_b32_dpp v139, v231, v247, vcc quad_perm:[2,3,0,1] row_mask:0xf bank_mask:0xf
    v_cndmask_b32_dpp v140, v234, v250, vcc quad_perm:[2,3,0,1] row_mask:0xf bank_mask:0xf
    v_cndmask_b32_dpp v141, v235, v251, vcc quad_perm:[2,3,0,1] row_mask:0xf bank_mask:0xf
    v_cndmask_b32_dpp v142, v238, v254, vcc quad_perm:[2,3,0,1] row_mask:0xf bank_mask:0xf
    v_cndmask_b32_dpp v143, v239, v255, vcc quad_perm:[2,3,0,1] row_mask:0xf bank_mask:0xf
    s_cmp_eq_u32 s36, 0
    s_waitcnt vmcnt(12)
    s_cbranch_scc1 K2_z_41
    v_mfma_f32_16x16x32_bf16 v[208:211], v[80:83], v[96:99], 0
    v_add_u32_sdwa v13, s45, v2 dst_sel:DWORD dst_unused:UNUSED_PAD src0_sel:WORD_0 src1_sel:DWORD
    ds_read_b64_tr_b16 v[80:81], v108
    ds_read_b64_tr_b16 v[82:83], v108 offset:1024
    s_nop 0
    ds_read_b64 v[104:105], v12
    ds_read_b128 v[100:103], v13
    v_mfma_f32_16x16x32_bf16 v[212:215], v[84:87], v[96:99], 0
    ds_read_b64_tr_b16 v[84:85], v109
    ds_read_b64_tr_b16 v[86:87], v109 offset:1024
    v_mfma_f32_16x16x32_bf16 v[216:219], v[88:91], v[96:99], 0
    ds_read_b64_tr_b16 v[88:89], v108 offset:512
    ds_read_b64_tr_b16 v[90:91], v108 offset:1536
    v_mfma_f32_16x16x32_bf16 v[220:223], v[92:95], v[96:99], 0
    ds_read_b64_tr_b16 v[92:93], v109 offset:512
    ds_read_b64_tr_b16 v[94:95], v109 offset:1536
    ds_read_b64_tr_b16 v[96:97], v106
    ds_read_b64_tr_b16 v[98:99], v107 offset:8
    s_add_u32 m0, s19, s20
    s_add_u32 s20, s20, 4096
    s_and_b32 s20, s20, 16383
    s_cmp_lt_i32 s45, 0
    v_add_u32 v108, s20, v8
    v_add_u32 v109, s20, v9
    s_cbranch_scc1 K2_wrap_42
K2_wrap_42_ret:
    s_waitcnt lgkmcnt(8)
    v_cmp_eq_u32_sdwa vcc, v104, v5 src0_sel:BYTE_0 src1_sel:DWORD
    v_mfma_f32_16x16x32_bf16 a[160:163], a[0:3], v[112:115], a[160:163]
    v_cmp_eq_u32_sdwa s[46:47], v105, v5 src0_sel:BYTE_0 src1_sel:DWORD
    v_mad_u32_u16 v100, v100, s21, v1 op_sel:[1,0,0,0]
    v_mfma_f32_16x16x32_bf16 a[164:167], a[4:7], v[112:115], a[164:167]
    v_mad_u32_u16 v101, v101, s21, v1 op_sel:[1,0,0,0]
    v_cndmask_b32_e64 v106, v4, v7, vcc
    v_mfma_f32_16x16x32_bf16 a[168:171], a[8:11], v[112:115], a[168:171]
    v_cndmask_b32 v107, v4, v7, s[46:47]
    v_mad_u32_u16 v102, v102, s21, v1 op_sel:[1,0,0,0]
    v_mfma_f32_16x16x32_bf16 a[172:175], a[12:15], v[112:115], a[172:175]
    v_mad_u32_u16 v103, v103, s21, v1 op_sel:[1,0,0,0]
    v_add_u32_sdwa v12, s45, v3 dst_sel:DWORD dst_unused:UNUSED_PAD src0_sel:WORD_1 src1_sel:DWORD
    v_mfma_f32_16x16x32_bf16 a[160:163], a[16:19], v[116:119], a[160:163]
    v_lshl_add_u32 v7, v12, 1, s100
    s_add_u32 s26, s26, 1
    v_mfma_f32_16x16x32_bf16 a[164:167], a[20:23], v[116:119], a[164:167]
    s_waitcnt lgkmcnt(0)
    buffer_load_dwordx4 v100, s[4:7], s22 offen lds
    v_mfma_f32_16x16x32_bf16 a[168:171], a[24:27], v[116:119], a[168:171]
    v_readlane_b32 s45, v6, s26
    buffer_load_dwordx4 v101, s[4:7], s23 offen offset:1024 lds
    v_mfma_f32_16x16x32_bf16 a[172:175], a[28:31], v[116:119], a[172:175]
    buffer_load_dwordx4 v102, s[4:7], s24 offen offset:2048 lds
    buffer_load_dwordx4 v103, s[4:7], s25 offen offset:3072 lds
K2_z_41_ret:
    s_cmp_eq_u32 s37, 0
    s_waitcnt vmcnt(12)
    s_cbranch_scc1 K2_z_43
    v_mfma_f32_16x16x32_bf16 v[224:227], v[80:83], v[96:99], 0
    v_add_u32_sdwa v13, s45, v2 dst_sel:DWORD dst_unused:UNUSED_PAD src0_sel:WORD_0 src1_sel:DWORD
    ds_read_b64_tr_b16 v[80:81], v108
    ds_read_b64_tr_b16 v[82:83], v108 offset:1024
    s_nop 0
    ds_read_b64 v[104:105], v12
    ds_read_b128 v[100:103], v13
    v_mfma_f32_16x16x32_bf16 v[228:231], v[84:87], v[96:99], 0
    ds_read_b64_tr_b16 v[84:85], v109
    ds_read_b64_tr_b16 v[86:87], v109 offset:1024
    v_mfma_f32_16x16x32_bf16 v[232:235], v[88:91], v[96:99], 0
    ds_read_b64_tr_b16 v[88:89], v108 offset:512
    ds_read_b64_tr_b16 v[90:91], v108 offset:1536
    v_mfma_f32_16x16x32_bf16 v[236:239], v[92:95], v[96:99], 0
    ds_read_b64_tr_b16 v[92:93], v109 offset:512
    ds_read_b64_tr_b16 v[94:95], v109 offset:1536
    ds_read_b64_tr_b16 v[96:97], v106
    ds_read_b64_tr_b16 v[98:99], v107 offset:8
    s_add_u32 m0, s19, s20
    s_add_u32 s20, s20, 4096
    s_and_b32 s20, s20, 16383
    s_cmp_lt_i32 s45, 0
    v_add_u32 v108, s20, v8
    v_add_u32 v109, s20, v9
    s_cbranch_scc1 K2_wrap_44
K2_wrap_44_ret:
    s_waitcnt lgkmcnt(8)
    v_cmp_eq_u32_sdwa vcc, v104, v5 src0_sel:BYTE_0 src1_sel:DWORD
    v_mfma_f32_16x16x32_bf16 a[176:179], a[64:67], v[120:123], a[176:179]
    v_cmp_eq_u32_sdwa s[46:47], v105, v5 src0_sel:BYTE_0 src1_sel:DWORD
    v_mad_u32_u16 v100, v100, s21, v1 op_sel:[1,0,0,0]
    v_mfma_f32_16x16x32_bf16 a[180:183], a[68:71], v[120:123], a[180:183]
    v_mad_u32_u16 v101, v101, s21, v1 op_sel:[1,0,0,0]
    v_cndmask_b32_e64 v106, v4, v7, vcc
    v_mfma_f32_16x16x32_bf16 a[184:187], a[72:75], v[120:123], a[184:187]
    v_cndmask_b32 v107, v4, v7, s[46:47]
    v_mad_u32_u16 v102, v102, s21, v1 op_sel:[1,0,0,0]
    v_mfma_f32_16x16x32_bf16 a[188:191], a[76:79], v[120:123], a[188:191]
    v_mad_u32_u16 v103, v103, s21, v1 op_sel:[1,0,0,0]
    v_add_u32_sdwa v12, s45, v3 dst_sel:DWORD dst_unused:UNUSED_PAD src0_sel:WORD_1 src1_sel:DWORD
    v_mfma_f32_16x16x32_bf16 a[176:179], a[80:83], v[124:127], a[176:179]
    v_lshl_add_u32 v7, v12, 1, s100
    s_add_u32 s26, s26, 1
    v_mfma_f32_16x16x32_bf16 a[180:183], a[84:87], v[124:127], a[180:183]
    s_waitcnt lgkmcnt(0)
    buffer_load_dwordx4 v100, s[4:7], s22 offen lds
    v_mfma_f32_16x16x32_bf16 a[184:187], a[88:91], v[124:127], a[184:187]
    v_readlane_b32 s45, v6, s26
    buffer_load_dwordx4 v101, s[4:7], s23 offen offset:1024 lds
    v_mfma_f32_16x16x32_bf16 a[188:191], a[92:95], v[124:127], a[188:191]
    buffer_load_dwordx4 v102, s[4:7], s24 offen offset:2048 lds
    buffer_load_dwordx4 v103, s[4:7], s25 offen offset:3072 lds
K2_z_43_ret:
    s_cmp_eq_u32 s38, 0
    s_waitcnt vmcnt(12)
    s_cbranch_scc1 K2_z_45
    v_mfma_f32_16x16x32_bf16 v[240:243], v[80:83], v[96:99], 0
    v_add_u32_sdwa v13, s45, v2 dst_sel:DWORD dst_unused:UNUSED_PAD src0_sel:WORD_0 src1_sel:DWORD
    ds_read_b64_tr_b16 v[80:81], v108
    ds_read_b64_tr_b16 v[82:83], v108 offset:1024
    s_nop 0
    ds_read_b64 v[104:105], v12
    ds_read_b128 v[100:103], v13
    v_mfma_f32_16x16x32_bf16 v[244:247], v[84:87], v[96:99], 0
    ds_read_b64_tr_b16 v[84:85], v109
    ds_read_b64_tr_b16 v[86:87], v109 offset:1024
    v_mfma_f32_16x16x32_bf16 v[248:251], v[88:91], v[96:99], 0
    ds_read_b64_tr_b16 v[88:89], v108 offset:512
    ds_read_b64_tr_b16 v[90:91], v108 offset:1536
    v_mfma_f32_16x16x32_bf16 v[252:255], v[92:95], v[96:99], 0
    ds_read_b64_tr_b16 v[92:93], v109 offset:512
    ds_read_b64_tr_b16 v[94:95], v109 offset:1536
    ds_read_b64_tr_b16 v[96:97], v106
    ds_read_b64_tr_b16 v[98:99], v107 offset:8
    s_add_u32 m0, s19, s20
    s_add_u32 s20, s20, 4096
    s_and_b32 s20, s20, 16383
    s_cmp_lt_i32 s45, 0
    v_add_u32 v108, s20, v8
    v_add_u32 v109, s20, v9
    s_cbranch_scc1 K2_wrap_46
K2_wrap_46_ret:
    s_waitcnt lgkmcnt(8)
    v_cmp_eq_u32_sdwa vcc, v104, v5 src0_sel:BYTE_0 src1_sel:DWORD
    v_mfma_f32_16x16x32_bf16 a[192:195], a[64:67], v[128:131], a[192:195]
    v_cmp_eq_u32_sdwa s[46:47], v105, v5 src0_sel:BYTE_0 src1_sel:DWORD
    v_mad_u32_u16 v100, v100, s21, v1 op_sel:[1,0,0,0]
    v_mfma_f32_16x16x32_bf16 a[196:199], a[68:71], v[128:131], a[196:199]
    v_mad_u32_u16 v101, v101, s21, v1 op_sel:[1,0,0,0]
    v_cndmask_b32_e64 v106, v4, v7, vcc
    v_mfma_f32_16x16x32_bf16 a[200:203], a[72:75], v[128:131], a[200:203]
    v_cndmask_b32 v107, v4, v7, s[46:47]
    v_mad_u32_u16 v102, v102, s21, v1 op_sel:[1,0,0,0]
    v_mfma_f32_16x16x32_bf16 a[204:207], a[76:79], v[128:131], a[204:207]
    v_mad_u32_u16 v103, v103, s21, v1 op_sel:[1,0,0,0]
    v_add_u32_sdwa v12, s45, v3 dst_sel:DWORD dst_unused:UNUSED_PAD src0_sel:WORD_1 src1_sel:DWORD
    v_mfma_f32_16x16x32_bf16 a[192:195], a[80:83], v[132:135], a[192:195]
    v_lshl_add_u32 v7, v12, 1, s100
    s_add_u32 s26, s26, 1
    v_mfma_f32_16x16x32_bf16 a[196:199], a[84:87], v[132:135], a[196:199]
    s_waitcnt lgkmcnt(0)
    buffer_load_dwordx4 v100, s[4:7], s22 offen lds
    v_mfma_f32_16x16x32_bf16 a[200:203], a[88:91], v[132:135], a[200:203]
    v_readlane_b32 s45, v6, s26
    buffer_load_dwordx4 v101, s[4:7], s23 offen offset:1024 lds
    v_mfma_f32_16x16x32_bf16 a[204:207], a[92:95], v[132:135], a[204:207]
    buffer_load_dwordx4 v102, s[4:7], s24 offen offset:2048 lds
    buffer_load_dwordx4 v103, s[4:7], s25 offen offset:3072 lds
K2_z_45_ret:
    v_mfma_f32_16x16x32_bf16 a[208:211], a[64:67], v[136:139], a[208:211]
    v_mfma_f32_16x16x32_bf16 a[212:215], a[68:71], v[136:139], a[212:215]
    v_mfma_f32_16x16x32_bf16 a[216:219], a[72:75], v[136:139], a[216:219]
    v_mfma_f32_16x16x32_bf16 a[220:223], a[76:79], v[136:139], a[220:223]
    v_mfma_f32_16x16x32_bf16 a[208:211], a[80:83], v[140:143], a[208:211]
    v_mfma_f32_16x16x32_bf16 a[212:215], a[84:87], v[140:143], a[212:215]
    v_mfma_f32_16x16x32_bf16 a[216:219], a[88:91], v[140:143], a[216:219]
    v_mfma_f32_16x16x32_bf16 a[220:223], a[92:95], v[140:143], a[220:223]
    s_mov_b32 s52, 1
    s_mov_b32 s29, 1
    s_branch K2_fastchk
    s_nop 0
    s_nop 0
    s_nop 0
K2_bound1:
    s_mov_b32 s26, 0
    v_readlane_b32 s45, v6, 0
    v_and_b32 v14, 63, v15
    v_min_u32 v14, 24, v14
    v_lshlrev_b32 v14, 9, v14
    s_add_u32 s43, s101, 384
    buffer_load_dword v14, v14, s[4:7], s43 offen
    v_cvt_pk_bf16_f32 v144, v144, v145
    v_cvt_pk_bf16_f32 v145, v146, v147
    v_cvt_pk_bf16_f32 v148, v148, v149
    v_cvt_pk_bf16_f32 v149, v150, v151
    v_cvt_pk_bf16_f32 v152, v152, v153
    v_cvt_pk_bf16_f32 v153, v154, v155
    v_cvt_pk_bf16_f32 v156, v156, v157
    v_cvt_pk_bf16_f32 v157, v158, v159
    v_cvt_pk_bf16_f32 v160, v160, v161
    v_cvt_pk_bf16_f32 v161, v162, v163
    v_cvt_pk_bf16_f32 v164, v164, v165
    v_cvt_pk_bf16_f32 v165, v166, v167
    v_cvt_pk_bf16_f32 v168, v168, v169
    v_cvt_pk_bf16_f32 v169, v170, v171
    v_cvt_pk_bf16_f32 v172, v172, v173
    v_cvt_pk_bf16_f32 v173, v174, v175
    v_cvt_pk_bf16_f32 v176, v176, v177
    v_cvt_pk_bf16_f32 v177, v178, v179
    v_cvt_pk_bf16_f32 v180, v180, v181
    v_cvt_pk_bf16_f32 v181, v182, v183
    v_cvt_pk_bf16_f32 v184, v184, v185
    v_cvt_pk_bf16_f32 v185, v186, v187
    v_cvt_pk_bf16_f32 v188, v188, v189
    v_cvt_pk_bf16_f32 v189, v190, v191
    v_cvt_pk_bf16_f32 v192, v192, v193
    v_cvt_pk_bf16_f32 v193, v194, v195
    v_cvt_pk_bf16_f32 v196, v196, v197
    v_cvt_pk_bf16_f32 v197, v198, v199
    v_cvt_pk_bf16_f32 v200, v200, v201
    v_cvt_pk_bf16_f32 v201, v202, v203
    v_cvt_pk_bf16_f32 v204, v204, v205
    v_cvt_pk_bf16_f32 v205, v206, v207
    s_mov_b64 vcc, s[94:95]
    v_cndmask_b32_dpp v146, v160, v144, vcc quad_perm:[1,0,3,2] row_mask:0xf bank_mask:0xf
    v_cndmask_b32_dpp v147, v161, v145, vcc quad_perm:[1,0,3,2] row_mask:0xf bank_mask:0xf
    v_cndmask_b32_dpp v150, v164, v148, vcc quad_perm:[1,0,3,2] row_mask:0xf bank_mask:0xf
    v_cndmask_b32_dpp v151, v165, v149, vcc quad_perm:[1,0,3,2] row_mask:0xf bank_mask:0xf
    v_cndmask_b32_dpp v154, v168, v152, vcc quad_perm:[1,0,3,2] row_mask:0xf bank_mask:0xf
    s_nop 0
    v_cndmask_b32_dpp v155, v169, v153, vcc quad_perm:[1,0,3,2] row_mask:0xf bank_mask:0xf
    v_cndmask_b32_dpp v158, v172, v156, vcc quad_perm:[1,0,3,2] row_mask:0xf bank_mask:0xf
    v_cndmask_b32_dpp v159, v173, v157, vcc quad_perm:[1,0,3,2] row_mask:0xf bank_mask:0xf
    v_cndmask_b32_dpp v178, v192, v176, vcc quad_perm:[1,0,3,2] row_mask:0xf bank_mask:0xf
    v_cndmask_b32_dpp v179, v193, v177, vcc quad_perm:[1,0,3,2] row_mask:0xf bank_mask:0xf
    v_cndmask_b32_dpp v182, v196, v180, vcc quad_perm:[1,0,3,2] row_mask:0xf bank_mask:0xf
    v_cndmask_b32_dpp v183, v197, v181, vcc quad_perm:[1,0,3,2] row_mask:0xf bank_mask:0xf
    v_cndmask_b32_dpp v186, v200, v184, vcc quad_perm:[1,0,3,2] row_mask:0xf bank_mask:0xf
    v_cndmask_b32_dpp v187, v201, v185, vcc quad_perm:[1,0,3,2] row_mask:0xf bank_mask:0xf
    v_cndmask_b32_dpp v190, v204, v188, vcc quad_perm:[1,0,3,2] row_mask:0xf bank_mask:0xf
    v_cndmask_b32_dpp v191, v205, v189, vcc quad_perm:[1,0,3,2] row_mask:0xf bank_mask:0xf
    s_not_b64 vcc, vcc
    v_cndmask_b32_dpp v162, v144, v160, vcc quad_perm:[1,0,3,2] row_mask:0xf bank_mask:0xf
    v_cndmask_b32_dpp v163, v145, v161, vcc quad_perm:[1,0,3,2] row_mask:0xf bank_mask:0xf
    v_cndmask_b32_dpp v166, v148, v164, vcc quad_perm:[1,0,3,2] row_mask:0xf bank_mask:0xf
    v_cndmask_b32_dpp v167, v149, v165, vcc quad_perm:[1,0,3,2] row_mask:0xf bank_mask:0xf
    s_nop 0
    v_cndmask_b32_dpp v170, v152, v168, vcc quad_perm:[1,0,3,2] row_mask:0xf bank_mask:0xf
    v_cndmask_b32_dpp v171, v153, v169, vcc quad_perm:[1,0,3,2] row_mask:0xf bank_mask:0xf
    v_cndmask_b32_dpp v174, v156, v172, vcc quad_perm:[1,0,3,2] row_mask:0xf bank_mask:0xf
    v_cndmask_b32_dpp v175, v157, v173, vcc quad_perm:[1,0,3,2] row_mask:0xf bank_mask:0xf
    v_cndmask_b32_dpp v194, v176, v192, vcc quad_perm:[1,0,3,2] row_mask:0xf bank_mask:0xf
    v_cndmask_b32_dpp v195, v177, v193, vcc quad_perm:[1,0,3,2] row_mask:0xf bank_mask:0xf
    v_cndmask_b32_dpp v198, v180, v196, vcc quad_perm:[1,0,3,2] row_mask:0xf bank_mask:0xf
    v_cndmask_b32_dpp v199, v181, v197, vcc quad_perm:[1,0,3,2] row_mask:0xf bank_mask:0xf
    v_cndmask_b32_dpp v202, v184, v200, vcc quad_perm:[1,0,3,2] row_mask:0xf bank_mask:0xf
    v_cndmask_b32_dpp v203, v185, v201, vcc quad_perm:[1,0,3,2] row_mask:0xf bank_mask:0xf
    v_cndmask_b32_dpp v206, v188, v204, vcc quad_perm:[1,0,3,2] row_mask:0xf bank_mask:0xf
    v_cndmask_b32_dpp v207, v189, v205, vcc quad_perm:[1,0,3,2] row_mask:0xf bank_mask:0xf
    s_mov_b64 vcc, s[96:97]
    v_cndmask_b32_dpp v112, v178, v146, vcc quad_perm:[2,3,0,1] row_mask:0xf bank_mask:0xf
    v_cndmask_b32_dpp v113, v179, v147, vcc quad_perm:[2,3,0,1] row_mask:0xf bank_mask:0xf
    v_cndmask_b32_dpp v114, v182, v150, vcc quad_perm:[2,3,0,1] row_mask:0xf bank_mask:0xf
    s_nop 0
    v_cndmask_b32_dpp v115, v183, v151, vcc quad_perm:[2,3,0,1] row_mask:0xf bank_mask:0xf
    v_cndmask_b32_dpp v116, v186, v154, vcc quad_perm:[2,3,0,1] row_mask:0xf bank_mask:0xf
    v_cndmask_b32_dpp v117, v187, v155, vcc quad_perm:[2,3,0,1] row_mask:0xf bank_mask:0xf
    v_cndmask_b32_dpp v118, v190, v158, vcc quad_perm:[2,3,0,1] row_mask:0xf bank_mask:0xf
    v_cndmask_b32_dpp v119, v191, v159, vcc quad_perm:[2,3,0,1] row_mask:0xf bank_mask:0xf
    v_cndmask_b32_dpp v120, v194, v162, vcc quad_perm:[2,3,0,1] row_mask:0xf bank_mask:0xf
    v_cndmask_b32_dpp v121, v195, v163, vcc quad_perm:[2,3,0,1] row_mask:0xf bank_mask:0xf
    v_cndmask_b32_dpp v122, v198, v166, vcc quad_perm:[2,3,0,1] row_mask:0xf bank_mask:0xf
    v_cndmask_b32_dpp v123, v199, v167, vcc quad_perm:[2,3,0,1] row_mask:0xf bank_mask:0xf
    v_cndmask_b32_dpp v124, v202, v170, vcc quad_perm:[2,3,0,1] row_mask:0xf bank_mask:0xf
    v_cndmask_b32_dpp v125, v203, v171, vcc quad_perm:[2,3,0,1] row_mask:0xf bank_mask:0xf
    v_cndmask_b32_dpp v126, v206, v174, vcc quad_perm:[2,3,0,1] row_mask:0xf bank_mask:0xf
    v_cndmask_b32_dpp v127, v207, v175, vcc quad_perm:[2,3,0,1] row_mask:0xf bank_mask:0xf
    s_not_b64 vcc, vcc
    v_cndmask_b32_dpp v128, v146, v178, vcc quad_perm:[2,3,0,1] row_mask:0xf bank_mask:0xf
    v_cndmask_b32_dpp v129, v147, v179, vcc quad_perm:[2,3,0,1] row_mask:0xf bank_mask:0xf
    s_nop 0
    v_cndmask_b32_dpp v130, v150, v182, vcc quad_perm:[2,3,0,1] row_mask:0xf bank_mask:0xf
    v_cndmask_b32_dpp v131, v151, v183, vcc quad_perm:[2,3,0,1] row_mask:0xf bank_mask:0xf
    v_cndmask_b32_dpp v132, v154, v186, vcc quad_perm:[2,3,0,1] row_mask:0xf bank_mask:0xf
    v_cndmask_b32_dpp v133, v155, v187, vcc quad_perm:[2,3,0,1] row_mask:0xf bank_mask:0xf
    v_cndmask_b32_dpp v134, v158, v190, vcc quad_perm:[2,3,0,1] row_mask:0xf bank_mask:0xf
    v_cndmask_b32_dpp v135, v159, v191, vcc quad_perm:[2,3,0,1] row_mask:0xf bank_mask:0xf
    v_cndmask_b32_dpp v136, v162, v194, vcc quad_perm:[2,3,0,1] row_mask:0xf bank_mask:0xf
    v_cndmask_b32_dpp v137, v163, v195, vcc quad_perm:[2,3,0,1] row_mask:0xf bank_mask:0xf
    v_cndmask_b32_dpp v138, v166, v198, vcc quad_perm:[2,3,0,1] row_mask:0xf bank_mask:0xf
    v_cndmask_b32_dpp v139, v167, v199, vcc quad_perm:[2,3,0,1] row_mask:0xf bank_mask:0xf
    v_cndmask_b32_dpp v140, v170, v202, vcc quad_perm:[2,3,0,1] row_mask:0xf bank_mask:0xf
    v_cndmask_b32_dpp v141, v171, v203, vcc quad_perm:[2,3,0,1] row_mask:0xf bank_mask:0xf
    v_cndmask_b32_dpp v142, v174, v206, vcc quad_perm:[2,3,0,1] row_mask:0xf bank_mask:0xf
    v_cndmask_b32_dpp v143, v175, v207, vcc quad_perm:[2,3,0,1] row_mask:0xf bank_mask:0xf
    v_xor_b32 v128, s55, v128
    v_xor_b32 v129, s55, v129
    v_xor_b32 v130, s55, v130
    v_xor_b32 v131, s55, v131
    v_xor_b32 v132, s55, v132
    v_xor_b32 v133, s55, v133
    v_xor_b32 v134, s55, v134
    v_xor_b32_e64 v135, s55, v135
    s_cmp_eq_u32 s32, 0
    s_waitcnt vmcnt(12)
    s_cbranch_scc1 K2_z_47
    v_mfma_f32_16x16x32_bf16 v[144:147], v[80:83], v[96:99], 0
    v_add_u32_sdwa v13, s45, v2 dst_sel:DWORD dst_unused:UNUSED_PAD src0_sel:WORD_0 src1_sel:DWORD
    ds_read_b64_tr_b16 v[80:81], v108
    ds_read_b64_tr_b16 v[82:83], v108 offset:1024
    ds_read_b64 v[104:105], v12
    ds_read_b128 v[100:103], v13
    v_mfma_f32_16x16x32_bf16 v[148:151], v[84:87], v[96:99], 0
    ds_read_b64_tr_b16 v[84:85], v109
    ds_read_b64_tr_b16 v[86:87], v109 offset:1024
    v_mfma_f32_16x16x32_bf16 v[152:155], v[88:91], v[96:99], 0
    ds_read_b64_tr_b16 v[88:89], v108 offset:512
    ds_read_b64_tr_b16 v[90:91], v108 offset:1536
    v_mfma_f32_16x16x32_bf16 v[156:159], v[92:95], v[96:99], 0
    ds_read_b64_tr_b16 v[92:93], v109 offset:512
    ds_read_b64_tr_b16 v[94:95], v109 offset:1536
    ds_read_b64_tr_b16 v[96:97], v106
    ds_read_b64_tr_b16 v[98:99], v107 offset:8
    s_add_u32 m0, s19, s20
    s_add_u32 s20, s20, 4096
    s_and_b32 s20, s20, 16383
    s_cmp_lt_i32 s45, 0
    v_add_u32 v108, s20, v8
    v_add_u32 v109, s20, v9
    s_cbranch_scc1 K2_wrap_48
K2_wrap_48_ret:
    s_waitcnt lgkmcnt(8)
    v_cmp_eq_u32_sdwa vcc, v104, v5 src0_sel:BYTE_0 src1_sel:DWORD
    v_mfma_f32_16x16x32_bf16 v[32:35], a[96:99], v[112:115], v[32:35]
    v_cmp_eq_u32_sdwa s[46:47], v105, v5 src0_sel:BYTE_0 src1_sel:DWORD
    v_mad_u32_u16 v100, v100, s21, v1 op_sel:[1,0,0,0]
    v_mfma_f32_16x16x32_bf16 v[36:39], a[100:103], v[112:115], v[36:39]
    v_mad_u32_u16 v101, v101, s21, v1 op_sel:[1,0,0,0]
    v_cndmask_b32_e64 v106, v4, v7, vcc
    v_mfma_f32_16x16x32_bf16 v[40:43], a[104:107], v[112:115], v[40:43]
    v_cndmask_b32 v107, v4, v7, s[46:47]
    v_mad_u32_u16 v102, v102, s21, v1 op_sel:[1,0,0,0]
    v_mfma_f32_16x16x32_bf16 v[44:47], a[108:111], v[112:115], v[44:47]
    v_mad_u32_u16 v103, v103, s21, v1 op_sel:[1,0,0,0]
    v_add_u32_sdwa v12, s45, v3 dst_sel:DWORD dst_unused:UNUSED_PAD src0_sel:WORD_1 src1_sel:DWORD
    v_mfma_f32_16x16x32_bf16 v[32:35], a[112:115], v[116:119], v[32:35]
    v_lshl_add_u32 v7, v12, 1, s100
    s_add_u32 s26, s26, 1
    v_mfma_f32_16x16x32_bf16 v[36:39], a[116:119], v[116:119], v[36:39]
    s_waitcnt lgkmcnt(0)
    buffer_load_dwordx4 v100, s[4:7], s22 offen lds
    v_mfma_f32_16x16x32_bf16 v[40:43], a[120:123], v[116:119], v[40:43]
    v_readlane_b32 s45, v6, s26
    buffer_load_dwordx4 v101, s[4:7], s23 offen offset:1024 lds
    v_mfma_f32_16x16x32_bf16 v[44:47], a[124:127], v[116:119], v[44:47]
    buffer_load_dwordx4 v102, s[4:7], s24 offen offset:2048 lds
    buffer_load_dwordx4 v103, s[4:7], s25 offen offset:3072 lds
K2_z_47_ret:
    s_cmp_eq_u32 s33, 0
    s_waitcnt vmcnt(12)
    s_cbranch_scc1 K2_z_49
    v_mfma_f32_16x16x32_bf16 v[160:163], v[80:83], v[96:99], 0
    v_add_u32_sdwa v13, s45, v2 dst_sel:DWORD dst_unused:UNUSED_PAD src0_sel:WORD_0 src1_sel:DWORD
    ds_read_b64_tr_b16 v[80:81], v108
    ds_read_b64_tr_b16 v[82:83], v108 offset:1024
    s_nop 0
    ds_read_b64 v[104:105], v12
    ds_read_b128 v[100:103], v13
    v_mfma_f32_16x16x32_bf16 v[164:167], v[84:87], v[96:99], 0
    ds_read_b64_tr_b16 v[84:85], v109
    ds_read_b64_tr_b16 v[86:87], v109 offset:1024
    v_mfma_f32_16x16x32_bf16 v[168:171], v[88:91], v[96:99], 0
    ds_read_b64_tr_b16 v[88:89], v108 offset:512
    ds_read_b64_tr_b16 v[90:91], v108 offset:1536
    v_mfma_f32_16x16x32_bf16 v[172:175], v[92:95], v[96:99], 0
    ds_read_b64_tr_b16 v[92:93], v109 offset:512
    ds_read_b64_tr_b16 v[94:95], v109 offset:1536
    ds_read_b64_tr_b16 v[96:97], v106
    ds_read_b64_tr_b16 v[98:99], v107 offset:8
    s_add_u32 m0, s19, s20
    s_add_u32 s20, s20, 4096
    s_and_b32 s20, s20, 16383
    s_cmp_lt_i32 s45, 0
    v_add_u32 v108, s20, v8
    v_add_u32 v109, s20, v9
    s_cbranch_scc1 K2_wrap_50
K2_wrap_50_ret:
    s_waitcnt lgkmcnt(8)
    v_cmp_eq_u32_sdwa vcc, v104, v5 src0_sel:BYTE_0 src1_sel:DWORD
    v_mfma_f32_16x16x32_bf16 v[16:19], a[32:35], v[120:123], v[16:19]
    v_cmp_eq_u32_sdwa s[46:47], v105, v5 src0_sel:BYTE_0 src1_sel:DWORD
    v_mad_u32_u16 v100, v100, s21, v1 op_sel:[1,0,0,0]
    v_mfma_f32_16x16x32_bf16 v[20:23], a[36:39], v[120:123], v[20:23]
    v_mad_u32_u16 v101, v101, s21, v1 op_sel:[1,0,0,0]
    v_cndmask_b32_e64 v106, v4, v7, vcc
    v_mfma_f32_16x16x32_bf16 v[24:27], a[40:43], v[120:123], v[24:27]
    v_cndmask_b32 v107, v4, v7, s[46:47]
    v_mad_u32_u16 v102, v102, s21, v1 op_sel:[1,0,0,0]
    v_mfma_f32_16x16x32_bf16 v[28:31], a[44:47], v[120:123], v[28:31]
    v_mad_u32_u16 v103, v103, s21, v1 op_sel:[1,0,0,0]
    v_add_u32_sdwa v12, s45, v3 dst_sel:DWORD dst_unused:UNUSED_PAD src0_sel:WORD_1 src1_sel:DWORD
    v_mfma_f32_16x16x32_bf16 v[16:19], a[48:51], v[124:127], v[16:19]
    v_lshl_add_u32 v7, v12, 1, s100
    s_add_u32 s26, s26, 1
    v_mfma_f32_16x16x32_bf16 v[20:23], a[52:55], v[124:127], v[20:23]
    s_waitcnt lgkmcnt(0)
    buffer_load_dwordx4 v100, s[4:7], s22 offen lds
    v_mfma_f32_16x16x32_bf16 v[24:27], a[56:59], v[124:127], v[24:27]
    v_readlane_b32 s45, v6, s26
    buffer_load_dwordx4 v101, s[4:7], s23 offen offset:1024 lds
    v_mfma_f32_16x16x32_bf16 v[28:31], a[60:63], v[124:127], v[28:31]
    buffer_load_dwordx4 v102, s[4:7], s24 offen offset:2048 lds
    buffer_load_dwordx4 v103, s[4:7], s25 offen offset:3072 lds
K2_z_49_ret:
    s_cmp_eq_u32 s34, 0
    s_waitcnt vmcnt(12)
    s_cbranch_scc1 K2_z_51
    v_mfma_f32_16x16x32_bf16 v[176:179], v[80:83], v[96:99], 0
    v_add_u32_sdwa v13, s45, v2 dst_sel:DWORD dst_unused:UNUSED_PAD src0_sel:WORD_0 src1_sel:DWORD
    ds_read_b64_tr_b16 v[80:81], v108
    ds_read_b64_tr_b16 v[82:83], v108 offset:1024
    s_nop 0
    ds_read_b64 v[104:105], v12
    ds_read_b128 v[100:103], v13
    v_mfma_f32_16x16x32_bf16 v[180:183], v[84:87], v[96:99], 0
    ds_read_b64_tr_b16 v[84:85], v109
    ds_read_b64_tr_b16 v[86:87], v109 offset:1024
    v_mfma_f32_16x16x32_bf16 v[184:187], v[88:91], v[96:99], 0
    ds_read_b64_tr_b16 v[88:89], v108 offset:512
    ds_read_b64_tr_b16 v[90:91], v108 offset:1536
    v_mfma_f32_16x16x32_bf16 v[188:191], v[92:95], v[96:99], 0
    ds_read_b64_tr_b16 v[92:93], v109 offset:512
    ds_read_b64_tr_b16 v[94:95], v109 offset:1536
    ds_read_b64_tr_b16 v[96:97], v106
    ds_read_b64_tr_b16 v[98:99], v107 offset:8
    s_add_u32 m0, s19, s20
    s_add_u32 s20, s20, 4096
    s_and_b32 s20, s20, 16383
    s_cmp_lt_i32 s45, 0
    v_add_u32 v108, s20, v8
    v_add_u32 v109, s20, v9
    s_cbranch_scc1 K2_wrap_52
K2_wrap_52_ret:
    s_waitcnt lgkmcnt(8)
    v_cmp_eq_u32_sdwa vcc, v104, v5 src0_sel:BYTE_0 src1_sel:DWORD
    v_mfma_f32_16x16x32_bf16 v[64:67], a[128:131], v[128:131], v[64:67]
    v_cmp_eq_u32_sdwa s[46:47], v105, v5 src0_sel:BYTE_0 src1_sel:DWORD
    v_mad_u32_u16 v100, v100, s21, v1 op_sel:[1,0,0,0]
    v_mfma_f32_16x16x32_bf16 v[68:71], a[132:135], v[128:131], v[68:71]
    v_mad_u32_u16 v101, v101, s21, v1 op_sel:[1,0,0,0]
    v_cndmask_b32_e64 v106, v4, v7, vcc
    v_mfma_f32_16x16x32_bf16 v[72:75], a[136:139], v[128:131], v[72:75]
    v_cndmask_b32 v107, v4, v7, s[46:47]
    v_mad_u32_u16 v102, v102, s21, v1 op_sel:[1,0,0,0]
    v_mfma_f32_16x16x32_bf16 v[76:79], a[140:143], v[128:131], v[76:79]
    v_mad_u32_u16 v103, v103, s21, v1 op_sel:[1,0,0,0]
    v_add_u32_sdwa v12, s45, v3 dst_sel:DWORD dst_unused:UNUSED_PAD src0_sel:WORD_1 src1_sel:DWORD
    v_mfma_f32_16x16x32_bf16 v[64:67], a[144:147], v[132:135], v[64:67]
    v_lshl_add_u32 v7, v12, 1, s100
    s_add_u32 s26, s26, 1
    v_mfma_f32_16x16x32_bf16 v[68:71], a[148:151], v[132:135], v[68:71]
    s_waitcnt lgkmcnt(0)
    buffer_load_dwordx4 v100, s[4:7], s22 offen lds
    v_mfma_f32_16x16x32_bf16 v[72:75], a[152:155], v[132:135], v[72:75]
    v_readlane_b32 s45, v6, s26
    buffer_load_dwordx4 v101, s[4:7], s23 offen offset:1024 lds
    v_mfma_f32_16x16x32_bf16 v[76:79], a[156:159], v[132:135], v[76:79]
    buffer_load_dwordx4 v102, s[4:7], s24 offen offset:2048 lds
    buffer_load_dwordx4 v103, s[4:7], s25 offen offset:3072 lds
K2_z_51_ret:
    s_cmp_eq_u32 s35, 0
    s_waitcnt vmcnt(12)
    s_cbranch_scc1 K2_z_53
    v_mfma_f32_16x16x32_bf16 v[192:195], v[80:83], v[96:99], 0
    v_add_u32_sdwa v13, s45, v2 dst_sel:DWORD dst_unused:UNUSED_PAD src0_sel:WORD_0 src1_sel:DWORD
    ds_read_b64_tr_b16 v[80:81], v108
    ds_read_b64_tr_b16 v[82:83], v108 offset:1024
    s_nop 0
    ds_read_b64 v[104:105], v12
    ds_read_b128 v[100:103], v13
    v_mfma_f32_16x16x32_bf16 v[196:199], v[84:87], v[96:99], 0
    ds_read_b64_tr_b16 v[84:85], v109
    ds_read_b64_tr_b16 v[86:87], v109 offset:1024
    v_mfma_f32_16x16x32_bf16 v[200:203], v[88:91], v[96:99], 0
    ds_read_b64_tr_b16 v[88:89], v108 offset:512
    ds_read_b64_tr_b16 v[90:91], v108 offset:1536
    v_mfma_f32_16x16x32_bf16 v[204:207], v[92:95], v[96:99], 0
    ds_read_b64_tr_b16 v[92:93], v109 offset:512
    ds_read_b64_tr_b16 v[94:95], v109 offset:1536
    ds_read_b64_tr_b16 v[96:97], v106
    ds_read_b64_tr_b16 v[98:99], v107 offset:8
    s_add_u32 m0, s19, s20
    s_add_u32 s20, s20, 4096
    s_and_b32 s20, s20, 16383
    s_cmp_lt_i32 s45, 0
    v_add_u32 v108, s20, v8
    v_add_u32 v109, s20, v9
    s_cbranch_scc1 K2_wrap_54
K2_wrap_54_ret:
    s_waitcnt lgkmcnt(8)
    v_cmp_eq_u32_sdwa vcc, v104, v5 src0_sel:BYTE_0 src1_sel:DWORD
    v_mfma_f32_16x16x32_bf16 v[48:51], a[128:131], v[136:139], v[48:51]
    v_cmp_eq_u32_sdwa s[46:47], v105, v5 src0_sel:BYTE_0 src1_sel:DWORD
    v_mad_u32_u16 v100, v100, s21, v1 op_sel:[1,0,0,0]
    v_mfma_f32_16x16x32_bf16 v[52:55], a[132:135], v[136:139], v[52:55]
    v_mad_u32_u16 v101, v101, s21, v1 op_sel:[1,0,0,0]
    v_cndmask_b32_e64 v106, v4, v7, vcc
    v_mfma_f32_16x16x32_bf16 v[56:59], a[136:139], v[136:139], v[56:59]
    v_cndmask_b32 v107, v4, v7, s[46:47]
    v_mad_u32_u16 v102, v102, s21, v1 op_sel:[1,0,0,0]
    v_mfma_f32_16x16x32_bf16 v[60:63], a[140:143], v[136:139], v[60:63]
    v_mad_u32_u16 v103, v103, s21, v1 op_sel:[1,0,0,0]
    v_add_u32_sdwa v12, s45, v3 dst_sel:DWORD dst_unused:UNUSED_PAD src0_sel:WORD_1 src1_sel:DWORD
    v_mfma_f32_16x16x32_bf16 v[48:51], a[144:147], v[140:143], v[48:51]
    v_lshl_add_u32 v7, v12, 1, s100
    s_add_u32 s26, s26, 1
    v_mfma_f32_16x16x32_bf16 v[52:55], a[148:151], v[140:143], v[52:55]
    s_waitcnt lgkmcnt(0)
    buffer_load_dwordx4 v100, s[4:7], s22 offen lds
    v_mfma_f32_16x16x32_bf16 v[56:59], a[152:155], v[140:143], v[56:59]
    v_readlane_b32 s45, v6, s26
    buffer_load_dwordx4 v101, s[4:7], s23 offen offset:1024 lds
    v_mfma_f32_16x16x32_bf16 v[60:63], a[156:159], v[140:143], v[60:63]
    buffer_load_dwordx4 v102, s[4:7], s24 offen offset:2048 lds
    buffer_load_dwordx4 v103, s[4:7], s25 offen offset:3072 lds
K2_z_53_ret:
    v_cvt_pk_bf16_f32 v208, v208, v209
    v_cvt_pk_bf16_f32 v209, v210, v211
    v_cvt_pk_bf16_f32 v212, v212, v213
    v_cvt_pk_bf16_f32 v213, v214, v215
    v_cvt_pk_bf16_f32 v216, v216, v217
    v_cvt_pk_bf16_f32 v217, v218, v219
    v_cvt_pk_bf16_f32 v220, v220, v221
    v_cvt_pk_bf16_f32 v221, v222, v223
    v_cvt_pk_bf16_f32 v224, v224, v225
    v_cvt_pk_bf16_f32 v225, v226, v227
    v_cvt_pk_bf16_f32 v228, v228, v229
    v_cvt_pk_bf16_f32 v229, v230, v231
    v_cvt_pk_bf16_f32 v232, v232, v233
    v_cvt_pk_bf16_f32 v233, v234, v235
    v_cvt_pk_bf16_f32 v236, v236, v237
    v_cvt_pk_bf16_f32 v237, v238, v239
    v_cvt_pk_bf16_f32 v240, v240, v241
    v_cvt_pk_bf16_f32 v241, v242, v243
    v_cvt_pk_bf16_f32 v244, v244, v245
    v_cvt_pk_bf16_f32 v245, v246, v247
    v_cvt_pk_bf16_f32 v248, v248, v249
    v_cvt_pk_bf16_f32 v249, v250, v251
    v_cvt_pk_bf16_f32 v252, v252, v253
    v_cvt_pk_bf16_f32 v253, v254, v255
    s_mov_b64 vcc, s[94:95]
    v_cndmask_b32_dpp v210, v224, v208, vcc quad_perm:[1,0,3,2] row_mask:0xf bank_mask:0xf
    v_cndmask_b32_dpp v211, v225, v209, vcc quad_perm:[1,0,3,2] row_mask:0xf bank_mask:0xf
    v_cndmask_b32_dpp v214, v228, v212, vcc quad_perm:[1,0,3,2] row_mask:0xf bank_mask:0xf
    v_cndmask_b32_dpp v215, v229, v213, vcc quad_perm:[1,0,3,2] row_mask:0xf bank_mask:0xf
    v_cndmask_b32_dpp v218, v232, v216, vcc quad_perm:[1,0,3,2] row_mask:0xf bank_mask:0xf
    s_nop 0
    v_cndmask_b32_dpp v219, v233, v217, vcc quad_perm:[1,0,3,2] row_mask:0xf bank_mask:0xf
    v_cndmask_b32_dpp v222, v236, v220, vcc quad_perm:[1,0,3,2] row_mask:0xf bank_mask:0xf
    v_cndmask_b32_dpp v223, v237, v221, vcc quad_perm:[1,0,3,2] row_mask:0xf bank_mask:0xf
    s_not_b64 vcc, vcc
    v_cndmask_b32_dpp v226, v208, v224, vcc quad_perm:[1,0,3,2] row_mask:0xf bank_mask:0xf
    v_cndmask_b32_dpp v227, v209, v225, vcc quad_perm:[1,0,3,2] row_mask:0xf bank_mask:0xf
    v_cndmask_b32_dpp v230, v212, v228, vcc quad_perm:[1,0,3,2] row_mask:0xf bank_mask:0xf
    v_cndmask_b32_dpp v231, v213, v229, vcc quad_perm:[1,0,3,2] row_mask:0xf bank_mask:0xf
    s_nop 0
    v_cndmask_b32_dpp v234, v216, v232, vcc quad_perm:[1,0,3,2] row_mask:0xf bank_mask:0xf
    v_cndmask_b32_dpp v235, v217, v233, vcc quad_perm:[1,0,3,2] row_mask:0xf bank_mask:0xf
    v_cndmask_b32_dpp v238, v220, v236, vcc quad_perm:[1,0,3,2] row_mask:0xf bank_mask:0xf
    v_cndmask_b32_dpp v239, v221, v237, vcc quad_perm:[1,0,3,2] row_mask:0xf bank_mask:0xf
    v_mov_b32_dpp v242, v240 quad_perm:[1,0,3,2] row_mask:0xf bank_mask:0xf
    v_mov_b32_dpp v243, v241 quad_perm:[1,0,3,2] row_mask:0xf bank_mask:0xf
    v_mov_b32_dpp v246, v244 quad_perm:[1,0,3,2] row_mask:0xf bank_mask:0xf
    v_mov_b32_dpp v247, v245 quad_perm:[1,0,3,2] row_mask:0xf bank_mask:0xf
    v_mov_b32_dpp v250, v248 quad_perm:[1,0,3,2] row_mask:0xf bank_mask:0xf
    v_mov_b32_dpp v251, v249 quad_perm:[1,0,3,2] row_mask:0xf bank_mask:0xf
    v_mov_b32_dpp v254, v252 quad_perm:[1,0,3,2] row_mask:0xf bank_mask:0xf
    v_mov_b32_dpp v255, v253 quad_perm:[1,0,3,2] row_mask:0xf bank_mask:0xf
    s_mov_b64 vcc, s[96:97]
    v_cndmask_b32_dpp v112, v240, v210, vcc quad_perm:[2,3,0,1] row_mask:0xf bank_mask:0xf
    v_cndmask_b32_dpp v113, v241, v211, vcc quad_perm:[2,3,0,1] row_mask:0xf bank_mask:0xf
    v_cndmask_b32_dpp v114, v244, v214, vcc quad_perm:[2,3,0,1] row_mask:0xf bank_mask:0xf
    s_nop 0
    v_cndmask_b32_dpp v115, v245, v215, vcc quad_perm:[2,3,0,1] row_mask:0xf bank_mask:0xf
    v_cndmask_b32_dpp v116, v248, v218, vcc quad_perm:[2,3,0,1] row_mask:0xf bank_mask:0xf
    v_cndmask_b32_dpp v117, v249, v219, vcc quad_perm:[2,3,0,1] row_mask:0xf bank_mask:0xf
    v_cndmask_b32_dpp v118, v252, v222, vcc quad_perm:[2,3,0,1] row_mask:0xf bank_mask:0xf
    v_cndmask_b32_dpp v119, v253, v223, vcc quad_perm:[2,3,0,1] row_mask:0xf bank_mask:0xf
    v_cndmask_b32_dpp v120, v242, v226, vcc quad_perm:[2,3,0,1] row_mask:0xf bank_mask:0xf
    v_cndmask_b32_dpp v121, v243, v227, vcc quad_perm:[2,3,0,1] row_mask:0xf bank_mask:0xf
    v_cndmask_b32_dpp v122, v246, v230, vcc quad_perm:[2,3,0,1] row_mask:0xf bank_mask:0xf
    v_cndmask_b32_dpp v123, v247, v231, vcc quad_perm:[2,3,0,1] row_mask:0xf bank_mask:0xf
    v_cndmask_b32_dpp v124, v250, v234, vcc quad_perm:[2,3,0,1] row_mask:0xf bank_mask:0xf
    v_cndmask_b32_dpp v125, v251, v235, vcc quad_perm:[2,3,0,1] row_mask:0xf bank_mask:0xf
    v_cndmask_b32_dpp v126, v254, v238, vcc quad_perm:[2,3,0,1] row_mask:0xf bank_mask:0xf
    v_cndmask_b32_dpp v127, v255, v239, vcc quad_perm:[2,3,0,1] row_mask:0xf bank_mask:0xf
    s_not_b64 vcc, vcc
    v_cndmask_b32_dpp v128, v210, v240, vcc quad_perm:[2,3,0,1] row_mask:0xf bank_mask:0xf
    v_cndmask_b32_dpp v129, v211, v241, vcc quad_perm:[2,3,0,1] row_mask:0xf bank_mask:0xf
    s_nop 0
    v_cndmask_b32_dpp v130, v214, v244, vcc quad_perm:[2,3,0,1] row_mask:0xf bank_mask:0xf
    v_cndmask_b32_dpp v131, v215, v245, vcc quad_perm:[2,3,0,1] row_mask:0xf bank_mask:0xf
    v_cndmask_b32_dpp v132, v218, v248, vcc quad_perm:[2,3,0,1] row_mask:0xf bank_mask:0xf
    v_cndmask_b32_dpp v133, v219, v249, vcc quad_perm:[2,3,0,1] row_mask:0xf bank_mask:0xf
    v_cndmask_b32_dpp v134, v222, v252, vcc quad_perm:[2,3,0,1] row_mask:0xf bank_mask:0xf
    v_cndmask_b32_dpp v135, v223, v253, vcc quad_perm:[2,3,0,1] row_mask:0xf bank_mask:0xf
    v_cndmask_b32_dpp v136, v226, v242, vcc quad_perm:[2,3,0,1] row_mask:0xf bank_mask:0xf
    v_cndmask_b32_dpp v137, v227, v243, vcc quad_perm:[2,3,0,1] row_mask:0xf bank_mask:0xf
    v_cndmask_b32_dpp v138, v230, v246, vcc quad_perm:[2,3,0,1] row_mask:0xf bank_mask:0xf
    v_cndmask_b32_dpp v139, v231, v247, vcc quad_perm:[2,3,0,1] row_mask:0xf bank_mask:0xf
    v_cndmask_b32_dpp v140, v234, v250, vcc quad_perm:[2,3,0,1] row_mask:0xf bank_mask:0xf
    v_cndmask_b32_dpp v141, v235, v251, vcc quad_perm:[2,3,0,1] row_mask:0xf bank_mask:0xf
    v_cndmask_b32_dpp v142, v238, v254, vcc quad_perm:[2,3,0,1] row_mask:0xf bank_mask:0xf
    v_cndmask_b32_dpp v143, v239, v255, vcc quad_perm:[2,3,0,1] row_mask:0xf bank_mask:0xf
    v_xor_b32 v128, s55, v128
    v_xor_b32 v129, s55, v129
    v_xor_b32 v130, s55, v130
    v_xor_b32 v131, s55, v131
    v_xor_b32 v132, s55, v132
    v_xor_b32 v133, s55, v133
    v_xor_b32 v134, s55, v134
    v_xor_b32_e64 v135, s55, v135
    s_cmp_eq_u32 s36, 0
    s_waitcnt vmcnt(12)
    s_cbranch_scc1 K2_z_55
    v_mfma_f32_16x16x32_bf16 v[208:211], v[80:83], v[96:99], 0
    v_add_u32_sdwa v13, s45, v2 dst_sel:DWORD dst_unused:UNUSED_PAD src0_sel:WORD_0 src1_sel:DWORD
    ds_read_b64_tr_b16 v[80:81], v108
    ds_read_b64_tr_b16 v[82:83], v108 offset:1024
    ds_read_b64 v[104:105], v12
    ds_read_b128 v[100:103], v13
    v_mfma_f32_16x16x32_bf16 v[212:215], v[84:87], v[96:99], 0
    ds_read_b64_tr_b16 v[84:85], v109
    ds_read_b64_tr_b16 v[86:87], v109 offset:1024
    v_mfma_f32_16x16x32_bf16 v[216:219], v[88:91], v[96:99], 0
    ds_read_b64_tr_b16 v[88:89], v108 offset:512
    ds_read_b64_tr_b16 v[90:91], v108 offset:1536
    v_mfma_f32_16x16x32_bf16 v[220:223], v[92:95], v[96:99], 0
    ds_read_b64_tr_b16 v[92:93], v109 offset:512
    ds_read_b64_tr_b16 v[94:95], v109 offset:1536
    ds_read_b64_tr_b16 v[96:97], v106
    ds_read_b64_tr_b16 v[98:99], v107 offset:8
    s_add_u32 m0, s19, s20
    s_add_u32 s20, s20, 4096
    s_and_b32 s20, s20, 16383
    s_cmp_lt_i32 s45, 0
    v_add_u32 v108, s20, v8
    v_add_u32 v109, s20, v9
    s_cbranch_scc1 K2_wrap_56
K2_wrap_56_ret:
    s_waitcnt lgkmcnt(8)
    v_cmp_eq_u32_sdwa vcc, v104, v5 src0_sel:BYTE_0 src1_sel:DWORD
    v_mfma_f32_16x16x32_bf16 a[176:179], a[96:99], v[112:115], a[176:179]
    v_cmp_eq_u32_sdwa s[46:47], v105, v5 src0_sel:BYTE_0 src1_sel:DWORD
    v_mad_u32_u16 v100, v100, s21, v1 op_sel:[1,0,0,0]
    v_mfma_f32_16x16x32_bf16 a[180:183], a[100:103], v[112:115], a[180:183]
    v_mad_u32_u16 v101, v101, s21, v1 op_sel:[1,0,0,0]
    v_cndmask_b32_e64 v106, v4, v7, vcc
    v_mfma_f32_16x16x32_bf16 a[184:187], a[104:107], v[112:115], a[184:187]
    v_cndmask_b32 v107, v4, v7, s[46:47]
    v_mad_u32_u16 v102, v102, s21, v1 op_sel:[1,0,0,0]
    v_mfma_f32_16x16x32_bf16 a[188:191], a[108:111], v[112:115], a[188:191]
    v_mad_u32_u16 v103, v103, s21, v1 op_sel:[1,0,0,0]
    v_add_u32_sdwa v12, s45, v3 dst_sel:DWORD dst_unused:UNUSED_PAD src0_sel:WORD_1 src1_sel:DWORD
    v_mfma_f32_16x16x32_bf16 a[176:179], a[112:115], v[116:119], a[176:179]
    v_lshl_add_u32 v7, v12, 1, s100
    s_add_u32 s26, s26, 1
    v_mfma_f32_16x16x32_bf16 a[180:183], a[116:119], v[116:119], a[180:183]
    s_waitcnt lgkmcnt(0)
    buffer_load_dwordx4 v100, s[4:7], s22 offen lds
    v_mfma_f32_16x16x32_bf16 a[184:187], a[120:123], v[116:119], a[184:187]
    v_readlane_b32 s45, v6, s26
    buffer_load_dwordx4 v101, s[4:7], s23 offen offset:1024 lds
    v_mfma_f32_16x16x32_bf16 a[188:191], a[124:127], v[116:119], a[188:191]
    buffer_load_dwordx4 v102, s[4:7], s24 offen offset:2048 lds
    buffer_load_dwordx4 v103, s[4:7], s25 offen offset:3072 lds
K2_z_55_ret:
    s_cmp_eq_u32 s37, 0
    s_waitcnt vmcnt(12)
    s_cbranch_scc1 K2_z_57
    v_mfma_f32_16x16x32_bf16 v[224:227], v[80:83], v[96:99], 0
    v_add_u32_sdwa v13, s45, v2 dst_sel:DWORD dst_unused:UNUSED_PAD src0_sel:WORD_0 src1_sel:DWORD
    ds_read_b64_tr_b16 v[80:81], v108
    ds_read_b64_tr_b16 v[82:83], v108 offset:1024
    s_nop 0
    ds_read_b64 v[104:105], v12
    ds_read_b128 v[100:103], v13
    v_mfma_f32_16x16x32_bf16 v[228:231], v[84:87], v[96:99], 0
    ds_read_b64_tr_b16 v[84:85], v109
    ds_read_b64_tr_b16 v[86:87], v109 offset:1024
    v_mfma_f32_16x16x32_bf16 v[232:235], v[88:91], v[96:99], 0
    ds_read_b64_tr_b16 v[88:89], v108 offset:512
    ds_read_b64_tr_b16 v[90:91], v108 offset:1536
    v_mfma_f32_16x16x32_bf16 v[236:239], v[92:95], v[96:99], 0
    ds_read_b64_tr_b16 v[92:93], v109 offset:512
    ds_read_b64_tr_b16 v[94:95], v109 offset:1536
    ds_read_b64_tr_b16 v[96:97], v106
    ds_read_b64_tr_b16 v[98:99], v107 offset:8
    s_add_u32 m0, s19, s20
    s_add_u32 s20, s20, 4096
    s_and_b32 s20, s20, 16383
    s_cmp_lt_i32 s45, 0
    v_add_u32 v108, s20, v8
    v_add_u32 v109, s20, v9
    s_cbranch_scc1 K2_wrap_58
K2_wrap_58_ret:
    s_waitcnt lgkmcnt(8)
    v_cmp_eq_u32_sdwa vcc, v104, v5 src0_sel:BYTE_0 src1_sel:DWORD
    v_mfma_f32_16x16x32_bf16 a[160:163], a[32:35], v[120:123], a[160:163]
    v_cmp_eq_u32_sdwa s[46:47], v105, v5 src0_sel:BYTE_0 src1_sel:DWORD
    v_mad_u32_u16 v100, v100, s21, v1 op_sel:[1,0,0,0]
    v_mfma_f32_16x16x32_bf16 a[164:167], a[36:39], v[120:123], a[164:167]
    v_mad_u32_u16 v101, v101, s21, v1 op_sel:[1,0,0,0]
    v_cndmask_b32_e64 v106, v4, v7, vcc
    v_mfma_f32_16x16x32_bf16 a[168:171], a[40:43], v[120:123], a[168:171]
    v_cndmask_b32 v107, v4, v7, s[46:47]
    v_mad_u32_u16 v102, v102, s21, v1 op_sel:[1,0,0,0]
    v_mfma_f32_16x16x32_bf16 a[172:175], a[44:47], v[120:123], a[172:175]
    v_mad_u32_u16 v103, v103, s21, v1 op_sel:[1,0,0,0]
    v_add_u32_sdwa v12, s45, v3 dst_sel:DWORD dst_unused:UNUSED_PAD src0_sel:WORD_1 src1_sel:DWORD
    v_mfma_f32_16x16x32_bf16 a[160:163], a[48:51], v[124:127], a[160:163]
    v_lshl_add_u32 v7, v12, 1, s100
    s_add_u32 s26, s26, 1
    v_mfma_f32_16x16x32_bf16 a[164:167], a[52:55], v[124:127], a[164:167]
    s_waitcnt lgkmcnt(0)
    buffer_load_dwordx4 v100, s[4:7], s22 offen lds
    v_mfma_f32_16x16x32_bf16 a[168:171], a[56:59], v[124:127], a[168:171]
    v_readlane_b32 s45, v6, s26
    buffer_load_dwordx4 v101, s[4:7], s23 offen offset:1024 lds
    v_mfma_f32_16x16x32_bf16 a[172:175], a[60:63], v[124:127], a[172:175]
    buffer_load_dwordx4 v102, s[4:7], s24 offen offset:2048 lds
    buffer_load_dwordx4 v103, s[4:7], s25 offen offset:3072 lds
K2_z_57_ret:
    s_cmp_eq_u32 s38, 0
    s_waitcnt vmcnt(12)
    s_cbranch_scc1 K2_z_59
    v_mfma_f32_16x16x32_bf16 v[240:243], v[80:83], v[96:99], 0
    v_add_u32_sdwa v13, s45, v2 dst_sel:DWORD dst_unused:UNUSED_PAD src0_sel:WORD_0 src1_sel:DWORD
    ds_read_b64_tr_b16 v[80:81], v108
    ds_read_b64_tr_b16 v[82:83], v108 offset:1024
    s_nop 0
    ds_read_b64 v[104:105], v12
    ds_read_b128 v[100:103], v13
    v_mfma_f32_16x16x32_bf16 v[244:247], v[84:87], v[96:99], 0
    ds_read_b64_tr_b16 v[84:85], v109
    ds_read_b64_tr_b16 v[86:87], v109 offset:1024
    v_mfma_f32_16x16x32_bf16 v[248:251], v[88:91], v[96:99], 0
    ds_read_b64_tr_b16 v[88:89], v108 offset:512
    ds_read_b64_tr_b16 v[90:91], v108 offset:1536
    v_mfma_f32_16x16x32_bf16 v[252:255], v[92:95], v[96:99], 0
    ds_read_b64_tr_b16 v[92:93], v109 offset:512
    ds_read_b64_tr_b16 v[94:95], v109 offset:1536
    ds_read_b64_tr_b16 v[96:97], v106
    ds_read_b64_tr_b16 v[98:99], v107 offset:8
    s_add_u32 m0, s19, s20
    s_add_u32 s20, s20, 4096
    s_and_b32 s20, s20, 16383
    s_cmp_lt_i32 s45, 0
    v_add_u32 v108, s20, v8
    v_add_u32 v109, s20, v9
    s_cbranch_scc1 K2_wrap_60
K2_wrap_60_ret:
    s_waitcnt lgkmcnt(8)
    v_cmp_eq_u32_sdwa vcc, v104, v5 src0_sel:BYTE_0 src1_sel:DWORD
    v_mfma_f32_16x16x32_bf16 a[208:211], a[128:131], v[128:131], a[208:211]
    v_cmp_eq_u32_sdwa s[46:47], v105, v5 src0_sel:BYTE_0 src1_sel:DWORD
    v_mad_u32_u16 v100, v100, s21, v1 op_sel:[1,0,0,0]
    v_mfma_f32_16x16x32_bf16 a[212:215], a[132:135], v[128:131], a[212:215]
    v_mad_u32_u16 v101, v101, s21, v1 op_sel:[1,0,0,0]
    v_cndmask_b32_e64 v106, v4, v7, vcc
    v_mfma_f32_16x16x32_bf16 a[216:219], a[136:139], v[128:131], a[216:219]
    v_cndmask_b32 v107, v4, v7, s[46:47]
    v_mad_u32_u16 v102, v102, s21, v1 op_sel:[1,0,0,0]
    v_mfma_f32_16x16x32_bf16 a[220:223], a[140:143], v[128:131], a[220:223]
    v_mad_u32_u16 v103, v103, s21, v1 op_sel:[1,0,0,0]
    v_add_u32_sdwa v12, s45, v3 dst_sel:DWORD dst_unused:UNUSED_PAD src0_sel:WORD_1 src1_sel:DWORD
    v_mfma_f32_16x16x32_bf16 a[208:211], a[144:147], v[132:135], a[208:211]
    v_lshl_add_u32 v7, v12, 1, s100
    s_add_u32 s26, s26, 1
    v_mfma_f32_16x16x32_bf16 a[212:215], a[148:151], v[132:135], a[212:215]
    s_waitcnt lgkmcnt(0)
    buffer_load_dwordx4 v100, s[4:7], s22 offen lds
    v_mfma_f32_16x16x32_bf16 a[216:219], a[152:155], v[132:135], a[216:219]
    v_readlane_b32 s45, v6, s26
    buffer_load_dwordx4 v101, s[4:7], s23 offen offset:1024 lds
    v_mfma_f32_16x16x32_bf16 a[220:223], a[156:159], v[132:135], a[220:223]
    buffer_load_dwordx4 v102, s[4:7], s24 offen offset:2048 lds
    buffer_load_dwordx4 v103, s[4:7], s25 offen offset:3072 lds
K2_z_59_ret:
    v_mfma_f32_16x16x32_bf16 a[192:195], a[128:131], v[136:139], a[192:195]
    v_mfma_f32_16x16x32_bf16 a[196:199], a[132:135], v[136:139], a[196:199]
    v_mfma_f32_16x16x32_bf16 a[200:203], a[136:139], v[136:139], a[200:203]
    v_mfma_f32_16x16x32_bf16 a[204:207], a[140:143], v[136:139], a[204:207]
    v_mfma_f32_16x16x32_bf16 a[192:195], a[144:147], v[140:143], a[192:195]
    v_mfma_f32_16x16x32_bf16 a[196:199], a[148:151], v[140:143], a[196:199]
    v_mfma_f32_16x16x32_bf16 a[200:203], a[152:155], v[140:143], a[200:203]
    v_mfma_f32_16x16x32_bf16 a[204:207], a[156:159], v[140:143], a[204:207]
    s_mov_b32 s52, 2
    s_mov_b32 s29, 1
    s_branch K2_fastchk
    s_nop 0
    s_nop 0
    s_nop 0
    s_nop 0
    s_nop 0
    s_nop 0
K2_bound2:
    s_mov_b32 s26, 0
    v_readlane_b32 s45, v6, 0
    v_cvt_pk_bf16_f32 v144, v144, v145
    v_cvt_pk_bf16_f32 v145, v146, v147
    v_cvt_pk_bf16_f32 v148, v148, v149
    v_cvt_pk_bf16_f32 v149, v150, v151
    v_cvt_pk_bf16_f32 v152, v152, v153
    v_cvt_pk_bf16_f32 v153, v154, v155
    v_cvt_pk_bf16_f32 v156, v156, v157
    v_cvt_pk_bf16_f32 v157, v158, v159
    v_cvt_pk_bf16_f32 v160, v160, v161
    v_cvt_pk_bf16_f32 v161, v162, v163
    v_cvt_pk_bf16_f32 v164, v164, v165
    v_cvt_pk_bf16_f32 v165, v166, v167
    v_cvt_pk_bf16_f32 v168, v168, v169
    v_cvt_pk_bf16_f32 v169, v170, v171
    v_cvt_pk_bf16_f32 v172, v172, v173
    v_cvt_pk_bf16_f32 v173, v174, v175
    v_cvt_pk_bf16_f32 v176, v176, v177
    v_cvt_pk_bf16_f32 v177, v178, v179
    v_cvt_pk_bf16_f32 v180, v180, v181
    v_cvt_pk_bf16_f32 v181, v182, v183
    v_cvt_pk_bf16_f32 v184, v184, v185
    v_cvt_pk_bf16_f32 v185, v186, v187
    v_cvt_pk_bf16_f32 v188, v188, v189
    v_cvt_pk_bf16_f32 v189, v190, v191
    v_cvt_pk_bf16_f32 v192, v192, v193
    v_cvt_pk_bf16_f32 v193, v194, v195
    v_cvt_pk_bf16_f32 v196, v196, v197
    v_cvt_pk_bf16_f32 v197, v198, v199
    v_cvt_pk_bf16_f32 v200, v200, v201
    v_cvt_pk_bf16_f32 v201, v202, v203
    v_cvt_pk_bf16_f32 v204, v204, v205
    v_cvt_pk_bf16_f32 v205, v206, v207
    s_nop 0
    s_mov_b64 vcc, s[94:95]
    v_cndmask_b32_dpp v146, v160, v144, vcc quad_perm:[1,0,3,2] row_mask:0xf bank_mask:0xf
    v_cndmask_b32_dpp v147, v161, v145, vcc quad_perm:[1,0,3,2] row_mask:0xf bank_mask:0xf
    v_cndmask_b32_dpp v150, v164, v148, vcc quad_perm:[1,0,3,2] row_mask:0xf bank_mask:0xf
    v_cndmask_b32_dpp v151, v165, v149, vcc quad_perm:[1,0,3,2] row_mask:0xf bank_mask:0xf
    v_cndmask_b32_dpp v154, v168, v152, vcc quad_perm:[1,0,3,2] row_mask:0xf bank_mask:0xf
    v_cndmask_b32_dpp v155, v169, v153, vcc quad_perm:[1,0,3,2] row_mask:0xf bank_mask:0xf
    v_cndmask_b32_dpp v158, v172, v156, vcc quad_perm:[1,0,3,2] row_mask:0xf bank_mask:0xf
    v_cndmask_b32_dpp v159, v173, v157, vcc quad_perm:[1,0,3,2] row_mask:0xf bank_mask:0xf
    v_cndmask_b32_dpp v178, v192, v176, vcc quad_perm:[1,0,3,2] row_mask:0xf bank_mask:0xf
    v_cndmask_b32_dpp v179, v193, v177, vcc quad_perm:[1,0,3,2] row_mask:0xf bank_mask:0xf
    v_cndmask_b32_dpp v182, v196, v180, vcc quad_perm:[1,0,3,2] row_mask:0xf bank_mask:0xf
    v_cndmask_b32_dpp v183, v197, v181, vcc quad_perm:[1,0,3,2] row_mask:0xf bank_mask:0xf
    v_cndmask_b32_dpp v186, v200, v184, vcc quad_perm:[1,0,3,2] row_mask:0xf bank_mask:0xf
    v_cndmask_b32_dpp v187, v201, v185, vcc quad_perm:[1,0,3,2] row_mask:0xf bank_mask:0xf
    v_cndmask_b32_dpp v190, v204, v188, vcc quad_perm:[1,0,3,2] row_mask:0xf bank_mask:0xf
    v_cndmask_b32_dpp v191, v205, v189, vcc quad_perm:[1,0,3,2] row_mask:0xf bank_mask:0xf
    s_not_b64 vcc, vcc
    v_cndmask_b32_dpp v162, v144, v160, vcc quad_perm:[1,0,3,2] row_mask:0xf bank_mask:0xf
    v_cndmask_b32_dpp v163, v145, v161, vcc quad_perm:[1,0,3,2] row_mask:0xf bank_mask:0xf
    v_cndmask_b32_dpp v166, v148, v164, vcc quad_perm:[1,0,3,2] row_mask:0xf bank_mask:0xf
    v_cndmask_b32_dpp v167, v149, v165, vcc quad_perm:[1,0,3,2] row_mask:0xf bank_mask:0xf
    v_cndmask_b32_dpp v170, v152, v168, vcc quad_perm:[1,0,3,2] row_mask:0xf bank_mask:0xf
    v_cndmask_b32_dpp v171, v153, v169, vcc quad_perm:[1,0,3,2] row_mask:0xf bank_mask:0xf
    s_nop 0
    v_cndmask_b32_dpp v174, v156, v172, vcc quad_perm:[1,0,3,2] row_mask:0xf bank_mask:0xf
    v_cndmask_b32_dpp v175, v157, v173, vcc quad_perm:[1,0,3,2] row_mask:0xf bank_mask:0xf
    v_cndmask_b32_dpp v194, v176, v192, vcc quad_perm:[1,0,3,2] row_mask:0xf bank_mask:0xf
    v_cndmask_b32_dpp v195, v177, v193, vcc quad_perm:[1,0,3,2] row_mask:0xf bank_mask:0xf
    v_cndmask_b32_dpp v198, v180, v196, vcc quad_perm:[1,0,3,2] row_mask:0xf bank_mask:0xf
    v_cndmask_b32_dpp v199, v181, v197, vcc quad_perm:[1,0,3,2] row_mask:0xf bank_mask:0xf
    v_cndmask_b32_dpp v202, v184, v200, vcc quad_perm:[1,0,3,2] row_mask:0xf bank_mask:0xf
    v_cndmask_b32_dpp v203, v185, v201, vcc quad_perm:[1,0,3,2] row_mask:0xf bank_mask:0xf
    v_cndmask_b32_dpp v206, v188, v204, vcc quad_perm:[1,0,3,2] row_mask:0xf bank_mask:0xf
    v_cndmask_b32_dpp v207, v189, v205, vcc quad_perm:[1,0,3,2] row_mask:0xf bank_mask:0xf
    s_mov_b64 vcc, s[96:97]
    v_cndmask_b32_dpp v112, v178, v146, vcc quad_perm:[2,3,0,1] row_mask:0xf bank_mask:0xf
    v_cndmask_b32_dpp v113, v179, v147, vcc quad_perm:[2,3,0,1] row_mask:0xf bank_mask:0xf
    v_cndmask_b32_dpp v114, v182, v150, vcc quad_perm:[2,3,0,1] row_mask:0xf bank_mask:0xf
    v_cndmask_b32_dpp v115, v183, v151, vcc quad_perm:[2,3,0,1] row_mask:0xf bank_mask:0xf
    v_cndmask_b32_dpp v116, v186, v154, vcc quad_perm:[2,3,0,1] row_mask:0xf bank_mask:0xf
    s_nop 0
    v_cndmask_b32_dpp v117, v187, v155, vcc quad_perm:[2,3,0,1] row_mask:0xf bank_mask:0xf
    v_cndmask_b32_dpp v118, v190, v158, vcc quad_perm:[2,3,0,1] row_mask:0xf bank_mask:0xf
    v_cndmask_b32_dpp v119, v191, v159, vcc quad_perm:[2,3,0,1] row_mask:0xf bank_mask:0xf
    v_cndmask_b32_dpp v120, v194, v162, vcc quad_perm:[2,3,0,1] row_mask:0xf bank_mask:0xf
    v_cndmask_b32_dpp v121, v195, v163, vcc quad_perm:[2,3,0,1] row_mask:0xf bank_mask:0xf
    v_cndmask_b32_dpp v122, v198, v166, vcc quad_perm:[2,3,0,1] row_mask:0xf bank_mask:0xf
    v_cndmask_b32_dpp v123, v199, v167, vcc quad_perm:[2,3,0,1] row_mask:0xf bank_mask:0xf
    v_cndmask_b32_dpp v124, v202, v170, vcc quad_perm:[2,3,0,1] row_mask:0xf bank_mask:0xf
    v_cndmask_b32_dpp v125, v203, v171, vcc quad_perm:[2,3,0,1] row_mask:0xf bank_mask:0xf
    v_cndmask_b32_dpp v126, v206, v174, vcc quad_perm:[2,3,0,1] row_mask:0xf bank_mask:0xf
    v_cndmask_b32_dpp v127, v207, v175, vcc quad_perm:[2,3,0,1] row_mask:0xf bank_mask:0xf
    s_not_b64 vcc, vcc
    v_cndmask_b32_dpp v128, v146, v178, vcc quad_perm:[2,3,0,1] row_mask:0xf bank_mask:0xf
    v_cndmask_b32_dpp v129, v147, v179, vcc quad_perm:[2,3,0,1] row_mask:0xf bank_mask:0xf
    v_cndmask_b32_dpp v130, v150, v182, vcc quad_perm:[2,3,0,1] row_mask:0xf bank_mask:0xf
    v_cndmask_b32_dpp v131, v151, v183, vcc quad_perm:[2,3,0,1] row_mask:0xf bank_mask:0xf
    s_nop 0
    v_cndmask_b32_dpp v132, v154, v186, vcc quad_perm:[2,3,0,1] row_mask:0xf bank_mask:0xf
    v_cndmask_b32_dpp v133, v155, v187, vcc quad_perm:[2,3,0,1] row_mask:0xf bank_mask:0xf
    v_cndmask_b32_dpp v134, v158, v190, vcc quad_perm:[2,3,0,1] row_mask:0xf bank_mask:0xf
    v_cndmask_b32_dpp v135, v159, v191, vcc quad_perm:[2,3,0,1] row_mask:0xf bank_mask:0xf
    v_cndmask_b32_dpp v136, v162, v194, vcc quad_perm:[2,3,0,1] row_mask:0xf bank_mask:0xf
    v_cndmask_b32_dpp v137, v163, v195, vcc quad_perm:[2,3,0,1] row_mask:0xf bank_mask:0xf
    v_cndmask_b32_dpp v138, v166, v198, vcc quad_perm:[2,3,0,1] row_mask:0xf bank_mask:0xf
    v_cndmask_b32_dpp v139, v167, v199, vcc quad_perm:[2,3,0,1] row_mask:0xf bank_mask:0xf
    v_cndmask_b32_dpp v140, v170, v202, vcc quad_perm:[2,3,0,1] row_mask:0xf bank_mask:0xf
    v_cndmask_b32_dpp v141, v171, v203, vcc quad_perm:[2,3,0,1] row_mask:0xf bank_mask:0xf
    v_cndmask_b32_dpp v142, v174, v206, vcc quad_perm:[2,3,0,1] row_mask:0xf bank_mask:0xf
    v_cndmask_b32_dpp v143, v175, v207, vcc quad_perm:[2,3,0,1] row_mask:0xf bank_mask:0xf
    v_xor_b32 v136, s55, v136
    v_xor_b32 v137, s55, v137
    v_xor_b32 v138, s55, v138
    v_xor_b32 v139, s55, v139
    v_xor_b32 v140, s55, v140
    v_xor_b32 v141, s55, v141
    v_xor_b32 v142, s55, v142
    v_xor_b32_e64 v143, s55, v143
    s_cmp_eq_u32 s32, 0
    s_waitcnt vmcnt(12)
    s_cbranch_scc1 K2_z_61
    v_mfma_f32_16x16x32_bf16 v[144:147], v[80:83], v[96:99], 0
    v_add_u32_sdwa v13, s45, v2 dst_sel:DWORD dst_unused:UNUSED_PAD src0_sel:WORD_0 src1_sel:DWORD
    ds_read_b64_tr_b16 v[80:81], v108
    ds_read_b64_tr_b16 v[82:83], v108 offset:1024
    ds_read_b64 v[104:105], v12
    ds_read_b128 v[100:103], v13
    v_mfma_f32_16x16x32_bf16 v[148:151], v[84:87], v[96:99], 0
    ds_read_b64_tr_b16 v[84:85], v109
    ds_read_b64_tr_b16 v[86:87], v109 offset:1024
    v_mfma_f32_16x16x32_bf16 v[152:155], v[88:91], v[96:99], 0
    ds_read_b64_tr_b16 v[88:89], v108 offset:512
    ds_read_b64_tr_b16 v[90:91], v108 offset:1536
    v_mfma_f32_16x16x32_bf16 v[156:159], v[92:95], v[96:99], 0
    ds_read_b64_tr_b16 v[92:93], v109 offset:512
    ds_read_b64_tr_b16 v[94:95], v109 offset:1536
    ds_read_b64_tr_b16 v[96:97], v106
    ds_read_b64_tr_b16 v[98:99], v107 offset:8
    s_add_u32 m0, s19, s20
    s_add_u32 s20, s20, 4096
    s_and_b32 s20, s20, 16383
    s_cmp_lt_i32 s45, 0
    v_add_u32 v108, s20, v8
    v_add_u32 v109, s20, v9
    s_cbranch_scc1 K2_wrap_62
K2_wrap_62_ret:
    s_waitcnt lgkmcnt(8)
    v_cmp_eq_u32_sdwa vcc, v104, v5 src0_sel:BYTE_0 src1_sel:DWORD
    v_mfma_f32_16x16x32_bf16 v[48:51], a[96:99], v[112:115], v[48:51]
    v_cmp_eq_u32_sdwa s[46:47], v105, v5 src0_sel:BYTE_0 src1_sel:DWORD
    v_mad_u32_u16 v100, v100, s21, v1 op_sel:[1,0,0,0]
    v_mfma_f32_16x16x32_bf16 v[52:55], a[100:103], v[112:115], v[52:55]
    v_mad_u32_u16 v101, v101, s21, v1 op_sel:[1,0,0,0]
    v_cndmask_b32_e64 v106, v4, v7, vcc
    v_mfma_f32_16x16x32_bf16 v[56:59], a[104:107], v[112:115], v[56:59]
    v_cndmask_b32 v107, v4, v7, s[46:47]
    v_mad_u32_u16 v102, v102, s21, v1 op_sel:[1,0,0,0]
    v_mfma_f32_16x16x32_bf16 v[60:63], a[108:111], v[112:115], v[60:63]
    v_mad_u32_u16 v103, v103, s21, v1 op_sel:[1,0,0,0]
    v_add_u32_sdwa v12, s45, v3 dst_sel:DWORD dst_unused:UNUSED_PAD src0_sel:WORD_1 src1_sel:DWORD
    v_mfma_f32_16x16x32_bf16 v[48:51], a[112:115], v[116:119], v[48:51]
    v_lshl_add_u32 v7, v12, 1, s100
    s_add_u32 s26, s26, 1
    v_mfma_f32_16x16x32_bf16 v[52:55], a[116:119], v[116:119], v[52:55]
    s_waitcnt lgkmcnt(0)
    buffer_load_dwordx4 v100, s[4:7], s22 offen lds
    v_mfma_f32_16x16x32_bf16 v[56:59], a[120:123], v[116:119], v[56:59]
    v_readlane_b32 s45, v6, s26
    buffer_load_dwordx4 v101, s[4:7], s23 offen offset:1024 lds
    v_mfma_f32_16x16x32_bf16 v[60:63], a[124:127], v[116:119], v[60:63]
    buffer_load_dwordx4 v102, s[4:7], s24 offen offset:2048 lds
    buffer_load_dwordx4 v103, s[4:7], s25 offen offset:3072 lds
K2_z_61_ret:
    s_cmp_eq_u32 s33, 0
    s_waitcnt vmcnt(12)
    s_cbranch_scc1 K2_z_63
    v_mfma_f32_16x16x32_bf16 v[160:163], v[80:83], v[96:99], 0
    v_add_u32_sdwa v13, s45, v2 dst_sel:DWORD dst_unused:UNUSED_PAD src0_sel:WORD_0 src1_sel:DWORD
    ds_read_b64_tr_b16 v[80:81], v108
    ds_read_b64_tr_b16 v[82:83], v108 offset:1024
    ds_read_b64 v[104:105], v12
    ds_read_b128 v[100:103], v13
    s_nop 0
    v_mfma_f32_16x16x32_bf16 v[164:167], v[84:87], v[96:99], 0
    ds_read_b64_tr_b16 v[84:85], v109
    ds_read_b64_tr_b16 v[86:87], v109 offset:1024
    v_mfma_f32_16x16x32_bf16 v[168:171], v[88:91], v[96:99], 0
    ds_read_b64_tr_b16 v[88:89], v108 offset:512
    ds_read_b64_tr_b16 v[90:91], v108 offset:1536
    v_mfma_f32_16x16x32_bf16 v[172:175], v[92:95], v[96:99], 0
    ds_read_b64_tr_b16 v[92:93], v109 offset:512
    ds_read_b64_tr_b16 v[94:95], v109 offset:1536
    ds_read_b64_tr_b16 v[96:97], v106
    ds_read_b64_tr_b16 v[98:99], v107 offset:8
    s_add_u32 m0, s19, s20
    s_add_u32 s20, s20, 4096
    s_and_b32 s20, s20, 16383
    s_cmp_lt_i32 s45, 0
    v_add_u32 v108, s20, v8
    v_add_u32 v109, s20, v9
    s_cbranch_scc1 K2_wrap_64
K2_wrap_64_ret:
    s_waitcnt lgkmcnt(8)
    v_cmp_eq_u32_sdwa vcc, v104, v5 src0_sel:BYTE_0 src1_sel:DWORD
    v_mfma_f32_16x16x32_bf16 v[64:67], a[128:131], v[120:123], v[64:67]
    v_cmp_eq_u32_sdwa s[46:47], v105, v5 src0_sel:BYTE_0 src1_sel:DWORD
    v_mad_u32_u16 v100, v100, s21, v1 op_sel:[1,0,0,0]
    v_mfma_f32_16x16x32_bf16 v[68:71], a[132:135], v[120:123], v[68:71]
    v_mad_u32_u16 v101, v101, s21, v1 op_sel:[1,0,0,0]
    v_cndmask_b32_e64 v106, v4, v7, vcc
    v_mfma_f32_16x16x32_bf16 v[72:75], a[136:139], v[120:123], v[72:75]
    v_cndmask_b32 v107, v4, v7, s[46:47]
    v_mad_u32_u16 v102, v102, s21, v1 op_sel:[1,0,0,0]
    v_mfma_f32_16x16x32_bf16 v[76:79], a[140:143], v[120:123], v[76:79]
    v_mad_u32_u16 v103, v103, s21, v1 op_sel:[1,0,0,0]
    v_add_u32_sdwa v12, s45, v3 dst_sel:DWORD dst_unused:UNUSED_PAD src0_sel:WORD_1 src1_sel:DWORD
    v_mfma_f32_16x16x32_bf16 v[64:67], a[144:147], v[124:127], v[64:67]
    v_lshl_add_u32 v7, v12, 1, s100
    s_add_u32 s26, s26, 1
    v_mfma_f32_16x16x32_bf16 v[68:71], a[148:151], v[124:127], v[68:71]
    s_waitcnt lgkmcnt(0)
    buffer_load_dwordx4 v100, s[4:7], s22 offen lds
    v_mfma_f32_16x16x32_bf16 v[72:75], a[152:155], v[124:127], v[72:75]
    v_readlane_b32 s45, v6, s26
    buffer_load_dwordx4 v101, s[4:7], s23 offen offset:1024 lds
    v_mfma_f32_16x16x32_bf16 v[76:79], a[156:159], v[124:127], v[76:79]
    buffer_load_dwordx4 v102, s[4:7], s24 offen offset:2048 lds
    buffer_load_dwordx4 v103, s[4:7], s25 offen offset:3072 lds
K2_z_63_ret:
    s_cmp_eq_u32 s34, 0
    s_waitcnt vmcnt(12)
    s_cbranch_scc1 K2_z_65
    v_mfma_f32_16x16x32_bf16 v[176:179], v[80:83], v[96:99], 0
    v_add_u32_sdwa v13, s45, v2 dst_sel:DWORD dst_unused:UNUSED_PAD src0_sel:WORD_0 src1_sel:DWORD
    ds_read_b64_tr_b16 v[80:81], v108
    ds_read_b64_tr_b16 v[82:83], v108 offset:1024
    ds_read_b64 v[104:105], v12
    ds_read_b128 v[100:103], v13
    s_nop 0
    v_mfma_f32_16x16x32_bf16 v[180:183], v[84:87], v[96:99], 0
    ds_read_b64_tr_b16 v[84:85], v109
    ds_read_b64_tr_b16 v[86:87], v109 offset:1024
    v_mfma_f32_16x16x32_bf16 v[184:187], v[88:91], v[96:99], 0
    ds_read_b64_tr_b16 v[88:89], v108 offset:512
    ds_read_b64_tr_b16 v[90:91], v108 offset:1536
    v_mfma_f32_16x16x32_bf16 v[188:191], v[92:95], v[96:99], 0
    ds_read_b64_tr_b16 v[92:93], v109 offset:512
    ds_read_b64_tr_b16 v[94:95], v109 offset:1536
    ds_read_b64_tr_b16 v[96:97], v106
    ds_read_b64_tr_b16 v[98:99], v107 offset:8
    s_add_u32 m0, s19, s20
    s_add_u32 s20, s20, 4096
    s_and_b32 s20, s20, 16383
    s_cmp_lt_i32 s45, 0
    v_add_u32 v108, s20, v8
    v_add_u32 v109, s20, v9
    s_cbranch_scc1 K2_wrap_66
K2_wrap_66_ret:
    s_waitcnt lgkmcnt(8)
    v_cmp_eq_u32_sdwa vcc, v104, v5 src0_sel:BYTE_0 src1_sel:DWORD
    v_mfma_f32_16x16x32_bf16 v[16:19], a[32:35], v[128:131], v[16:19]
    v_cmp_eq_u32_sdwa s[46:47], v105, v5 src0_sel:BYTE_0 src1_sel:DWORD
    v_mad_u32_u16 v100, v100, s21, v1 op_sel:[1,0,0,0]
    v_mfma_f32_16x16x32_bf16 v[20:23], a[36:39], v[128:131], v[20:23]
    v_mad_u32_u16 v101, v101, s21, v1 op_sel:[1,0,0,0]
    v_cndmask_b32_e64 v106, v4, v7, vcc
    v_mfma_f32_16x16x32_bf16 v[24:27], a[40:43], v[128:131], v[24:27]
    v_cndmask_b32 v107, v4, v7, s[46:47]
    v_mad_u32_u16 v102, v102, s21, v1 op_sel:[1,0,0,0]
    v_mfma_f32_16x16x32_bf16 v[28:31], a[44:47], v[128:131], v[28:31]
    v_mad_u32_u16 v103, v103, s21, v1 op_sel:[1,0,0,0]
    v_add_u32_sdwa v12, s45, v3 dst_sel:DWORD dst_unused:UNUSED_PAD src0_sel:WORD_1 src1_sel:DWORD
    v_mfma_f32_16x16x32_bf16 v[16:19], a[48:51], v[132:135], v[16:19]
    v_lshl_add_u32 v7, v12, 1, s100
    s_add_u32 s26, s26, 1
    v_mfma_f32_16x16x32_bf16 v[20:23], a[52:55], v[132:135], v[20:23]
    s_waitcnt lgkmcnt(0)
    buffer_load_dwordx4 v100, s[4:7], s22 offen lds
    v_mfma_f32_16x16x32_bf16 v[24:27], a[56:59], v[132:135], v[24:27]
    v_readlane_b32 s45, v6, s26
    buffer_load_dwordx4 v101, s[4:7], s23 offen offset:1024 lds
    v_mfma_f32_16x16x32_bf16 v[28:31], a[60:63], v[132:135], v[28:31]
    buffer_load_dwordx4 v102, s[4:7], s24 offen offset:2048 lds
    buffer_load_dwordx4 v103, s[4:7], s25 offen offset:3072 lds
K2_z_65_ret:
    s_cmp_eq_u32 s35, 0
    s_waitcnt vmcnt(12)
    s_cbranch_scc1 K2_z_67
    v_mfma_f32_16x16x32_bf16 v[192:195], v[80:83], v[96:99], 0
    v_add_u32_sdwa v13, s45, v2 dst_sel:DWORD dst_unused:UNUSED_PAD src0_sel:WORD_0 src1_sel:DWORD
    ds_read_b64_tr_b16 v[80:81], v108
    ds_read_b64_tr_b16 v[82:83], v108 offset:1024
    ds_read_b64 v[104:105], v12
    ds_read_b128 v[100:103], v13
    s_nop 0
    v_mfma_f32_16x16x32_bf16 v[196:199], v[84:87], v[96:99], 0
    ds_read_b64_tr_b16 v[84:85], v109
    ds_read_b64_tr_b16 v[86:87], v109 offset:1024
    v_mfma_f32_16x16x32_bf16 v[200:203], v[88:91], v[96:99], 0
    ds_read_b64_tr_b16 v[88:89], v108 offset:512
    ds_read_b64_tr_b16 v[90:91], v108 offset:1536
    v_mfma_f32_16x16x32_bf16 v[204:207], v[92:95], v[96:99], 0
    ds_read_b64_tr_b16 v[92:93], v109 offset:512
    ds_read_b64_tr_b16 v[94:95], v109 offset:1536
    ds_read_b64_tr_b16 v[96:97], v106
    ds_read_b64_tr_b16 v[98:99], v107 offset:8
    s_add_u32 m0, s19, s20
    s_add_u32 s20, s20, 4096
    s_and_b32 s20, s20, 16383
    s_cmp_lt_i32 s45, 0
    v_add_u32 v108, s20, v8
    v_add_u32 v109, s20, v9
    s_cbranch_scc1 K2_wrap_68
K2_wrap_68_ret:
    s_waitcnt lgkmcnt(8)
    v_cmp_eq_u32_sdwa vcc, v104, v5 src0_sel:BYTE_0 src1_sel:DWORD
    v_mfma_f32_16x16x32_bf16 v[32:35], a[128:131], v[136:139], v[32:35]
    v_cmp_eq_u32_sdwa s[46:47], v105, v5 src0_sel:BYTE_0 src1_sel:DWORD
    v_mad_u32_u16 v100, v100, s21, v1 op_sel:[1,0,0,0]
    v_mfma_f32_16x16x32_bf16 v[36:39], a[132:135], v[136:139], v[36:39]
    v_mad_u32_u16 v101, v101, s21, v1 op_sel:[1,0,0,0]
    v_cndmask_b32_e64 v106, v4, v7, vcc
    v_mfma_f32_16x16x32_bf16 v[40:43], a[136:139], v[136:139], v[40:43]
    v_cndmask_b32 v107, v4, v7, s[46:47]
    v_mad_u32_u16 v102, v102, s21, v1 op_sel:[1,0,0,0]
    v_mfma_f32_16x16x32_bf16 v[44:47], a[140:143], v[136:139], v[44:47]
    v_mad_u32_u16 v103, v103, s21, v1 op_sel:[1,0,0,0]
    v_add_u32_sdwa v12, s45, v3 dst_sel:DWORD dst_unused:UNUSED_PAD src0_sel:WORD_1 src1_sel:DWORD
    v_mfma_f32_16x16x32_bf16 v[32:35], a[144:147], v[140:143], v[32:35]
    v_lshl_add_u32 v7, v12, 1, s100
    s_add_u32 s26, s26, 1
    v_mfma_f32_16x16x32_bf16 v[36:39], a[148:151], v[140:143], v[36:39]
    s_waitcnt lgkmcnt(0)
    buffer_load_dwordx4 v100, s[4:7], s22 offen lds
    v_mfma_f32_16x16x32_bf16 v[40:43], a[152:155], v[140:143], v[40:43]
    v_readlane_b32 s45, v6, s26
    buffer_load_dwordx4 v101, s[4:7], s23 offen offset:1024 lds
    v_mfma_f32_16x16x32_bf16 v[44:47], a[156:159], v[140:143], v[44:47]
    buffer_load_dwordx4 v102, s[4:7], s24 offen offset:2048 lds
    buffer_load_dwordx4 v103, s[4:7], s25 offen offset:3072 lds
K2_z_67_ret:
    v_cvt_pk_bf16_f32 v208, v208, v209
    v_cvt_pk_bf16_f32 v209, v210, v211
    v_cvt_pk_bf16_f32 v212, v212, v213
    v_cvt_pk_bf16_f32 v213, v214, v215
    v_cvt_pk_bf16_f32 v216, v216, v217
    v_cvt_pk_bf16_f32 v217, v218, v219
    v_cvt_pk_bf16_f32 v220, v220, v221
    v_cvt_pk_bf16_f32 v221, v222, v223
    v_cvt_pk_bf16_f32 v224, v224, v225
    v_cvt_pk_bf16_f32 v225, v226, v227
    v_cvt_pk_bf16_f32 v228, v228, v229
    v_cvt_pk_bf16_f32 v229, v230, v231
    v_cvt_pk_bf16_f32 v232, v232, v233
    v_cvt_pk_bf16_f32 v233, v234, v235
    v_cvt_pk_bf16_f32 v236, v236, v237
    v_cvt_pk_bf16_f32 v237, v238, v239
    v_cvt_pk_bf16_f32 v240, v240, v241
    v_cvt_pk_bf16_f32 v241, v242, v243
    v_cvt_pk_bf16_f32 v244, v244, v245
    v_cvt_pk_bf16_f32 v245, v246, v247
    v_cvt_pk_bf16_f32 v248, v248, v249
    v_cvt_pk_bf16_f32 v249, v250, v251
    v_cvt_pk_bf16_f32 v252, v252, v253
    v_cvt_pk_bf16_f32 v253, v254, v255
    s_nop 0
    s_mov_b64 vcc, s[94:95]
    v_cndmask_b32_dpp v210, v224, v208, vcc quad_perm:[1,0,3,2] row_mask:0xf bank_mask:0xf
    v_cndmask_b32_dpp v211, v225, v209, vcc quad_perm:[1,0,3,2] row_mask:0xf bank_mask:0xf
    v_cndmask_b32_dpp v214, v228, v212, vcc quad_perm:[1,0,3,2] row_mask:0xf bank_mask:0xf
    v_cndmask_b32_dpp v215, v229, v213, vcc quad_perm:[1,0,3,2] row_mask:0xf bank_mask:0xf
    v_cndmask_b32_dpp v218, v232, v216, vcc quad_perm:[1,0,3,2] row_mask:0xf bank_mask:0xf
    v_cndmask_b32_dpp v219, v233, v217, vcc quad_perm:[1,0,3,2] row_mask:0xf bank_mask:0xf
    v_cndmask_b32_dpp v222, v236, v220, vcc quad_perm:[1,0,3,2] row_mask:0xf bank_mask:0xf
    v_cndmask_b32_dpp v223, v237, v221, vcc quad_perm:[1,0,3,2] row_mask:0xf bank_mask:0xf
    s_not_b64 vcc, vcc
    v_cndmask_b32_dpp v226, v208, v224, vcc quad_perm:[1,0,3,2] row_mask:0xf bank_mask:0xf
    v_cndmask_b32_dpp v227, v209, v225, vcc quad_perm:[1,0,3,2] row_mask:0xf bank_mask:0xf
    v_cndmask_b32_dpp v230, v212, v228, vcc quad_perm:[1,0,3,2] row_mask:0xf bank_mask:0xf
    v_cndmask_b32_dpp v231, v213, v229, vcc quad_perm:[1,0,3,2] row_mask:0xf bank_mask:0xf
    v_cndmask_b32_dpp v234, v216, v232, vcc quad_perm:[1,0,3,2] row_mask:0xf bank_mask:0xf
    v_cndmask_b32_dpp v235, v217, v233, vcc quad_perm:[1,0,3,2] row_mask:0xf bank_mask:0xf
    s_nop 0
    v_cndmask_b32_dpp v238, v220, v236, vcc quad_perm:[1,0,3,2] row_mask:0xf bank_mask:0xf
    v_cndmask_b32_dpp v239, v221, v237, vcc quad_perm:[1,0,3,2] row_mask:0xf bank_mask:0xf
    v_mov_b32_dpp v242, v240 quad_perm:[1,0,3,2] row_mask:0xf bank_mask:0xf
    v_mov_b32_dpp v243, v241 quad_perm:[1,0,3,2] row_mask:0xf bank_mask:0xf
    v_mov_b32_dpp v246, v244 quad_perm:[1,0,3,2] row_mask:0xf bank_mask:0xf
    v_mov_b32_dpp v247, v245 quad_perm:[1,0,3,2] row_mask:0xf bank_mask:0xf
    v_mov_b32_dpp v250, v248 quad_perm:[1,0,3,2] row_mask:0xf bank_mask:0xf
    v_mov_b32_dpp v251, v249 quad_perm:[1,0,3,2] row_mask:0xf bank_mask:0xf
    v_mov_b32_dpp v254, v252 quad_perm:[1,0,3,2] row_mask:0xf bank_mask:0xf
    v_mov_b32_dpp v255, v253 quad_perm:[1,0,3,2] row_mask:0xf bank_mask:0xf
    s_mov_b64 vcc, s[96:97]
    v_cndmask_b32_dpp v112, v240, v210, vcc quad_perm:[2,3,0,1] row_mask:0xf bank_mask:0xf
    v_cndmask_b32_dpp v113, v241, v211, vcc quad_perm:[2,3,0,1] row_mask:0xf bank_mask:0xf
    v_cndmask_b32_dpp v114, v244, v214, vcc quad_perm:[2,3,0,1] row_mask:0xf bank_mask:0xf
    v_cndmask_b32_dpp v115, v245, v215, vcc quad_perm:[2,3,0,1] row_mask:0xf bank_mask:0xf
    v_cndmask_b32_dpp v116, v248, v218, vcc quad_perm:[2,3,0,1] row_mask:0xf bank_mask:0xf
    s_nop 0
    v_cndmask_b32_dpp v117, v249, v219, vcc quad_perm:[2,3,0,1] row_mask:0xf bank_mask:0xf
    v_cndmask_b32_dpp v118, v252, v222, vcc quad_perm:[2,3,0,1] row_mask:0xf bank_mask:0xf
    v_cndmask_b32_dpp v119, v253, v223, vcc quad_perm:[2,3,0,1] row_mask:0xf bank_mask:0xf
    v_cndmask_b32_dpp v120, v242, v226, vcc quad_perm:[2,3,0,1] row_mask:0xf bank_mask:0xf
    v_cndmask_b32_dpp v121, v243, v227, vcc quad_perm:[2,3,0,1] row_mask:0xf bank_mask:0xf
    v_cndmask_b32_dpp v122, v246, v230, vcc quad_perm:[2,3,0,1] row_mask:0xf bank_mask:0xf
    v_cndmask_b32_dpp v123, v247, v231, vcc quad_perm:[2,3,0,1] row_mask:0xf bank_mask:0xf
    v_cndmask_b32_dpp v124, v250, v234, vcc quad_perm:[2,3,0,1] row_mask:0xf bank_mask:0xf
    v_cndmask_b32_dpp v125, v251, v235, vcc quad_perm:[2,3,0,1] row_mask:0xf bank_mask:0xf
    v_cndmask_b32_dpp v126, v254, v238, vcc quad_perm:[2,3,0,1] row_mask:0xf bank_mask:0xf
    v_cndmask_b32_dpp v127, v255, v239, vcc quad_perm:[2,3,0,1] row_mask:0xf bank_mask:0xf
    s_not_b64 vcc, vcc
    v_cndmask_b32_dpp v128, v210, v240, vcc quad_perm:[2,3,0,1] row_mask:0xf bank_mask:0xf
    v_cndmask_b32_dpp v129, v211, v241, vcc quad_perm:[2,3,0,1] row_mask:0xf bank_mask:0xf
    v_cndmask_b32_dpp v130, v214, v244, vcc quad_perm:[2,3,0,1] row_mask:0xf bank_mask:0xf
    v_cndmask_b32_dpp v131, v215, v245, vcc quad_perm:[2,3,0,1] row_mask:0xf bank_mask:0xf
    s_nop 0
    v_cndmask_b32_dpp v132, v218, v248, vcc quad_perm:[2,3,0,1] row_mask:0xf bank_mask:0xf
    v_cndmask_b32_dpp v133, v219, v249, vcc quad_perm:[2,3,0,1] row_mask:0xf bank_mask:0xf
    v_cndmask_b32_dpp v134, v222, v252, vcc quad_perm:[2,3,0,1] row_mask:0xf bank_mask:0xf
    v_cndmask_b32_dpp v135, v223, v253, vcc quad_perm:[2,3,0,1] row_mask:0xf bank_mask:0xf
    v_cndmask_b32_dpp v136, v226, v242, vcc quad_perm:[2,3,0,1] row_mask:0xf bank_mask:0xf
    v_cndmask_b32_dpp v137, v227, v243, vcc quad_perm:[2,3,0,1] row_mask:0xf bank_mask:0xf
    v_cndmask_b32_dpp v138, v230, v246, vcc quad_perm:[2,3,0,1] row_mask:0xf bank_mask:0xf
    v_cndmask_b32_dpp v139, v231, v247, vcc quad_perm:[2,3,0,1] row_mask:0xf bank_mask:0xf
    v_cndmask_b32_dpp v140, v234, v250, vcc quad_perm:[2,3,0,1] row_mask:0xf bank_mask:0xf
    v_cndmask_b32_dpp v141, v235, v251, vcc quad_perm:[2,3,0,1] row_mask:0xf bank_mask:0xf
    v_cndmask_b32_dpp v142, v238, v254, vcc quad_perm:[2,3,0,1] row_mask:0xf bank_mask:0xf
    v_cndmask_b32_dpp v143, v239, v255, vcc quad_perm:[2,3,0,1] row_mask:0xf bank_mask:0xf
    v_xor_b32 v136, s55, v136
    v_xor_b32 v137, s55, v137
    v_xor_b32 v138, s55, v138
    v_xor_b32 v139, s55, v139
    v_xor_b32 v140, s55, v140
    v_xor_b32 v141, s55, v141
    v_xor_b32 v142, s55, v142
    v_xor_b32_e64 v143, s55, v143
    s_cmp_eq_u32 s36, 0
    s_waitcnt vmcnt(12)
    s_cbranch_scc1 K2_z_69
    v_mfma_f32_16x16x32_bf16 v[208:211], v[80:83], v[96:99], 0
    v_add_u32_sdwa v13, s45, v2 dst_sel:DWORD dst_unused:UNUSED_PAD src0_sel:WORD_0 src1_sel:DWORD
    ds_read_b64_tr_b16 v[80:81], v108
    ds_read_b64_tr_b16 v[82:83], v108 offset:1024
    ds_read_b64 v[104:105], v12
    ds_read_b128 v[100:103], v13
    v_mfma_f32_16x16x32_bf16 v[212:215], v[84:87], v[96:99], 0
    ds_read_b64_tr_b16 v[84:85], v109
    ds_read_b64_tr_b16 v[86:87], v109 offset:1024
    v_mfma_f32_16x16x32_bf16 v[216:219], v[88:91], v[96:99], 0
    ds_read_b64_tr_b16 v[88:89], v108 offset:512
    ds_read_b64_tr_b16 v[90:91], v108 offset:1536
    v_mfma_f32_16x16x32_bf16 v[220:223], v[92:95], v[96:99], 0
    ds_read_b64_tr_b16 v[92:93], v109 offset:512
    ds_read_b64_tr_b16 v[94:95], v109 offset:1536
    ds_read_b64_tr_b16 v[96:97], v106
    ds_read_b64_tr_b16 v[98:99], v107 offset:8
    s_add_u32 m0, s19, s20
    s_add_u32 s20, s20, 4096
    s_and_b32 s20, s20, 16383
    s_cmp_lt_i32 s45, 0
    v_add_u32 v108, s20, v8
    v_add_u32 v109, s20, v9
    s_cbranch_scc1 K2_wrap_70
K2_wrap_70_ret:
    s_waitcnt lgkmcnt(8)
    v_cmp_eq_u32_sdwa vcc, v104, v5 src0_sel:BYTE_0 src1_sel:DWORD
    v_mfma_f32_16x16x32_bf16 a[192:195], a[96:99], v[112:115], a[192:195]
    v_cmp_eq_u32_sdwa s[46:47], v105, v5 src0_sel:BYTE_0 src1_sel:DWORD
    v_mad_u32_u16 v100, v100, s21, v1 op_sel:[1,0,0,0]
    v_mfma_f32_16x16x32_bf16 a[196:199], a[100:103], v[112:115], a[196:199]
    v_mad_u32_u16 v101, v101, s21, v1 op_sel:[1,0,0,0]
    v_cndmask_b32_e64 v106, v4, v7, vcc
    v_mfma_f32_16x16x32_bf16 a[200:203], a[104:107], v[112:115], a[200:203]
    v_cndmask_b32 v107, v4, v7, s[46:47]
    v_mad_u32_u16 v102, v102, s21, v1 op_sel:[1,0,0,0]
    v_mfma_f32_16x16x32_bf16 a[204:207], a[108:111], v[112:115], a[204:207]
    v_mad_u32_u16 v103, v103, s21, v1 op_sel:[1,0,0,0]
    v_add_u32_sdwa v12, s45, v3 dst_sel:DWORD dst_unused:UNUSED_PAD src0_sel:WORD_1 src1_sel:DWORD
    v_mfma_f32_16x16x32_bf16 a[192:195], a[112:115], v[116:119], a[192:195]
    v_lshl_add_u32 v7, v12, 1, s100
    s_add_u32 s26, s26, 1
    v_mfma_f32_16x16x32_bf16 a[196:199], a[116:119], v[116:119], a[196:199]
    s_waitcnt lgkmcnt(0)
    buffer_load_dwordx4 v100, s[4:7], s22 offen lds
    v_mfma_f32_16x16x32_bf16 a[200:203], a[120:123], v[116:119], a[200:203]
    v_readlane_b32 s45, v6, s26
    buffer_load_dwordx4 v101, s[4:7], s23 offen offset:1024 lds
    v_mfma_f32_16x16x32_bf16 a[204:207], a[124:127], v[116:119], a[204:207]
    buffer_load_dwordx4 v102, s[4:7], s24 offen offset:2048 lds
    buffer_load_dwordx4 v103, s[4:7], s25 offen offset:3072 lds
K2_z_69_ret:
    s_cmp_eq_u32 s37, 0
    s_waitcnt vmcnt(12)
    s_cbranch_scc1 K2_z_71
    v_mfma_f32_16x16x32_bf16 v[224:227], v[80:83], v[96:99], 0
    v_add_u32_sdwa v13, s45, v2 dst_sel:DWORD dst_unused:UNUSED_PAD src0_sel:WORD_0 src1_sel:DWORD
    ds_read_b64_tr_b16 v[80:81], v108
    ds_read_b64_tr_b16 v[82:83], v108 offset:1024
    ds_read_b64 v[104:105], v12
    ds_read_b128 v[100:103], v13
    s_nop 0
    v_mfma_f32_16x16x32_bf16 v[228:231], v[84:87], v[96:99], 0
    ds_read_b64_tr_b16 v[84:85], v109
    ds_read_b64_tr_b16 v[86:87], v109 offset:1024
    v_mfma_f32_16x16x32_bf16 v[232:235], v[88:91], v[96:99], 0
    ds_read_b64_tr_b16 v[88:89], v108 offset:512
    ds_read_b64_tr_b16 v[90:91], v108 offset:1536
    v_mfma_f32_16x16x32_bf16 v[236:239], v[92:95], v[96:99], 0
    ds_read_b64_tr_b16 v[92:93], v109 offset:512
    ds_read_b64_tr_b16 v[94:95], v109 offset:1536
    ds_read_b64_tr_b16 v[96:97], v106
    ds_read_b64_tr_b16 v[98:99], v107 offset:8
    s_add_u32 m0, s19, s20
    s_add_u32 s20, s20, 4096
    s_and_b32 s20, s20, 16383
    s_cmp_lt_i32 s45, 0
    v_add_u32 v108, s20, v8
    v_add_u32 v109, s20, v9
    s_cbranch_scc1 K2_wrap_72
K2_wrap_72_ret:
    s_waitcnt lgkmcnt(8)
    v_cmp_eq_u32_sdwa vcc, v104, v5 src0_sel:BYTE_0 src1_sel:DWORD
    v_mfma_f32_16x16x32_bf16 a[208:211], a[128:131], v[120:123], a[208:211]
    v_cmp_eq_u32_sdwa s[46:47], v105, v5 src0_sel:BYTE_0 src1_sel:DWORD
    v_mad_u32_u16 v100, v100, s21, v1 op_sel:[1,0,0,0]
    v_mfma_f32_16x16x32_bf16 a[212:215], a[132:135], v[120:123], a[212:215]
    v_mad_u32_u16 v101, v101, s21, v1 op_sel:[1,0,0,0]
    v_cndmask_b32_e64 v106, v4, v7, vcc
    v_mfma_f32_16x16x32_bf16 a[216:219], a[136:139], v[120:123], a[216:219]
    v_cndmask_b32 v107, v4, v7, s[46:47]
    v_mad_u32_u16 v102, v102, s21, v1 op_sel:[1,0,0,0]
    v_mfma_f32_16x16x32_bf16 a[220:223], a[140:143], v[120:123], a[220:223]
    v_mad_u32_u16 v103, v103, s21, v1 op_sel:[1,0,0,0]
    v_add_u32_sdwa v12, s45, v3 dst_sel:DWORD dst_unused:UNUSED_PAD src0_sel:WORD_1 src1_sel:DWORD
    v_mfma_f32_16x16x32_bf16 a[208:211], a[144:147], v[124:127], a[208:211]
    v_lshl_add_u32 v7, v12, 1, s100
    s_add_u32 s26, s26, 1
    v_mfma_f32_16x16x32_bf16 a[212:215], a[148:151], v[124:127], a[212:215]
    s_waitcnt lgkmcnt(0)
    buffer_load_dwordx4 v100, s[4:7], s22 offen lds
    v_mfma_f32_16x16x32_bf16 a[216:219], a[152:155], v[124:127], a[216:219]
    v_readlane_b32 s45, v6, s26
    buffer_load_dwordx4 v101, s[4:7], s23 offen offset:1024 lds
    v_mfma_f32_16x16x32_bf16 a[220:223], a[156:159], v[124:127], a[220:223]
    buffer_load_dwordx4 v102, s[4:7], s24 offen offset:2048 lds
    buffer_load_dwordx4 v103, s[4:7], s25 offen offset:3072 lds
K2_z_71_ret:
    s_cmp_eq_u32 s38, 0
    s_waitcnt vmcnt(12)
    s_cbranch_scc1 K2_z_73
    v_mfma_f32_16x16x32_bf16 v[240:243], v[80:83], v[96:99], 0
    v_add_u32_sdwa v13, s45, v2 dst_sel:DWORD dst_unused:UNUSED_PAD src0_sel:WORD_0 src1_sel:DWORD
    ds_read_b64_tr_b16 v[80:81], v108
    ds_read_b64_tr_b16 v[82:83], v108 offset:1024
    ds_read_b64 v[104:105], v12
    ds_read_b128 v[100:103], v13
    s_nop 0
    v_mfma_f32_16x16x32_bf16 v[244:247], v[84:87], v[96:99], 0
    ds_read_b64_tr_b16 v[84:85], v109
    ds_read_b64_tr_b16 v[86:87], v109 offset:1024
    v_mfma_f32_16x16x32_bf16 v[248:251], v[88:91], v[96:99], 0
    ds_read_b64_tr_b16 v[88:89], v108 offset:512
    ds_read_b64_tr_b16 v[90:91], v108 offset:1536
    v_mfma_f32_16x16x32_bf16 v[252:255], v[92:95], v[96:99], 0
    ds_read_b64_tr_b16 v[92:93], v109 offset:512
    ds_read_b64_tr_b16 v[94:95], v109 offset:1536
    ds_read_b64_tr_b16 v[96:97], v106
    ds_read_b64_tr_b16 v[98:99], v107 offset:8
    s_add_u32 m0, s19, s20
    s_add_u32 s20, s20, 4096
    s_and_b32 s20, s20, 16383
    s_cmp_lt_i32 s45, 0
    v_add_u32 v108, s20, v8
    v_add_u32 v109, s20, v9
    s_cbranch_scc1 K2_wrap_74
K2_wrap_74_ret:
    s_waitcnt lgkmcnt(8)
    v_cmp_eq_u32_sdwa vcc, v104, v5 src0_sel:BYTE_0 src1_sel:DWORD
    v_mfma_f32_16x16x32_bf16 a[160:163], a[32:35], v[128:131], a[160:163]
    v_cmp_eq_u32_sdwa s[46:47], v105, v5 src0_sel:BYTE_0 src1_sel:DWORD
    v_mad_u32_u16 v100, v100, s21, v1 op_sel:[1,0,0,0]
    v_mfma_f32_16x16x32_bf16 a[164:167], a[36:39], v[128:131], a[164:167]
    v_mad_u32_u16 v101, v101, s21, v1 op_sel:[1,0,0,0]
    v_cndmask_b32_e64 v106, v4, v7, vcc
    v_mfma_f32_16x16x32_bf16 a[168:171], a[40:43], v[128:131], a[168:171]
    v_cndmask_b32 v107, v4, v7, s[46:47]
    v_mad_u32_u16 v102, v102, s21, v1 op_sel:[1,0,0,0]
    v_mfma_f32_16x16x32_bf16 a[172:175], a[44:47], v[128:131], a[172:175]
    v_mad_u32_u16 v103, v103, s21, v1 op_sel:[1,0,0,0]
    v_add_u32_sdwa v12, s45, v3 dst_sel:DWORD dst_unused:UNUSED_PAD src0_sel:WORD_1 src1_sel:DWORD
    v_mfma_f32_16x16x32_bf16 a[160:163], a[48:51], v[132:135], a[160:163]
    v_lshl_add_u32 v7, v12, 1, s100
    s_add_u32 s26, s26, 1
    v_mfma_f32_16x16x32_bf16 a[164:167], a[52:55], v[132:135], a[164:167]
    s_waitcnt lgkmcnt(0)
    buffer_load_dwordx4 v100, s[4:7], s22 offen lds
    v_mfma_f32_16x16x32_bf16 a[168:171], a[56:59], v[132:135], a[168:171]
    v_readlane_b32 s45, v6, s26
    buffer_load_dwordx4 v101, s[4:7], s23 offen offset:1024 lds
    v_mfma_f32_16x16x32_bf16 a[172:175], a[60:63], v[132:135], a[172:175]
    buffer_load_dwordx4 v102, s[4:7], s24 offen offset:2048 lds
    buffer_load_dwordx4 v103, s[4:7], s25 offen offset:3072 lds
K2_z_73_ret:
    v_mfma_f32_16x16x32_bf16 a[176:179], a[128:131], v[136:139], a[176:179]
    v_mfma_f32_16x16x32_bf16 a[180:183], a[132:135], v[136:139], a[180:183]
    v_mfma_f32_16x16x32_bf16 a[184:187], a[136:139], v[136:139], a[184:187]
    v_mfma_f32_16x16x32_bf16 a[188:191], a[140:143], v[136:139], a[188:191]
    v_mfma_f32_16x16x32_bf16 a[176:179], a[144:147], v[140:143], a[176:179]
    v_mfma_f32_16x16x32_bf16 a[180:183], a[148:151], v[140:143], a[180:183]
    v_mfma_f32_16x16x32_bf16 a[184:187], a[152:155], v[140:143], a[184:187]
    v_mfma_f32_16x16x32_bf16 a[188:191], a[156:159], v[140:143], a[188:191]
    s_mov_b32 s52, 3
    s_mov_b32 s29, 1
    s_branch K2_fastchk
    s_nop 0
    s_nop 0
    s_nop 0
    s_nop 0
    s_nop 0
    s_nop 0
    s_nop 0
    s_nop 0
K2_bound3:
    s_cmp_eq_u32 s62, 0
    s_cbranch_scc1 K2_flush3
    s_mov_b32 s46, 0xbfb8aa3b
    s_mov_b32 s47, 0xbfb8aa3b
    s_mov_b64 vcc, s[94:95]
    v_and_b32 v5, 1, v15
    v_lshlrev_b32 v5, 6, v5
    s_nop 0
    v_cndmask_b32_dpp v1, v10, v10, vcc quad_perm:[1,0,3,2] row_mask:0xf bank_mask:0xf
    v_cndmask_b32_dpp v3, v11, v11, vcc quad_perm:[1,0,3,2] row_mask:0xf bank_mask:0xf
    s_not_b64 vcc, vcc
    v_cndmask_b32_dpp v2, v10, v10, vcc quad_perm:[1,0,3,2] row_mask:0xf bank_mask:0xf
    v_cndmask_b32_dpp v4, v11, v11, vcc quad_perm:[1,0,3,2] row_mask:0xf bank_mask:0xf
    v_add_u32 v1, v1, v5
    v_add_u32 v2, v2, v5
    v_add_u32 v3, v3, v5
    v_add_u32 v4, v4, v5
    v_cvt_pk_bf16_f32 v144, v144, v145
    v_cvt_pk_bf16_f32 v145, v146, v147
    v_cvt_pk_bf16_f32 v148, v148, v149
    v_cvt_pk_bf16_f32 v149, v150, v151
    v_cvt_pk_bf16_f32 v152, v152, v153
    v_cvt_pk_bf16_f32 v153, v154, v155
    v_cvt_pk_bf16_f32 v156, v156, v157
    v_cvt_pk_bf16_f32 v157, v158, v159
    v_cvt_pk_bf16_f32 v160, v160, v161
    v_cvt_pk_bf16_f32 v161, v162, v163
    v_cvt_pk_bf16_f32 v164, v164, v165
    v_cvt_pk_bf16_f32 v165, v166, v167
    v_cvt_pk_bf16_f32 v168, v168, v169
    v_cvt_pk_bf16_f32 v169, v170, v171
    v_cvt_pk_bf16_f32 v172, v172, v173
    v_cvt_pk_bf16_f32 v173, v174, v175
    v_cvt_pk_bf16_f32 v176, v176, v177
    v_cvt_pk_bf16_f32 v177, v178, v179
    v_cvt_pk_bf16_f32 v180, v180, v181
    v_cvt_pk_bf16_f32 v181, v182, v183
    v_cvt_pk_bf16_f32 v184, v184, v185
    v_cvt_pk_bf16_f32 v185, v186, v187
    v_cvt_pk_bf16_f32 v188, v188, v189
    v_cvt_pk_bf16_f32 v189, v190, v191
    v_cvt_pk_bf16_f32 v192, v192, v193
    v_cvt_pk_bf16_f32 v193, v194, v195
    v_cvt_pk_bf16_f32 v196, v196, v197
    v_cvt_pk_bf16_f32 v197, v198, v199
    v_cvt_pk_bf16_f32 v200, v200, v201
    v_cvt_pk_bf16_f32 v201, v202, v203
    v_cvt_pk_bf16_f32 v204, v204, v205
    v_cvt_pk_bf16_f32 v205, v206, v207
    s_mov_b64 vcc, s[94:95]
    v_cndmask_b32_dpp v146, v160, v144, vcc quad_perm:[1,0,3,2] row_mask:0xf bank_mask:0xf
    v_cndmask_b32_dpp v147, v161, v145, vcc quad_perm:[1,0,3,2] row_mask:0xf bank_mask:0xf
    v_cndmask_b32_dpp v150, v164, v148, vcc quad_perm:[1,0,3,2] row_mask:0xf bank_mask:0xf
    v_cndmask_b32_dpp v151, v165, v149, vcc quad_perm:[1,0,3,2] row_mask:0xf bank_mask:0xf
    v_cndmask_b32_dpp v154, v168, v152, vcc quad_perm:[1,0,3,2] row_mask:0xf bank_mask:0xf
    v_cndmask_b32_dpp v155, v169, v153, vcc quad_perm:[1,0,3,2] row_mask:0xf bank_mask:0xf
    s_nop 0
    v_cndmask_b32_dpp v158, v172, v156, vcc quad_perm:[1,0,3,2] row_mask:0xf bank_mask:0xf
    v_cndmask_b32_dpp v159, v173, v157, vcc quad_perm:[1,0,3,2] row_mask:0xf bank_mask:0xf
    v_cndmask_b32_dpp v178, v192, v176, vcc quad_perm:[1,0,3,2] row_mask:0xf bank_mask:0xf
    v_cndmask_b32_dpp v179, v193, v177, vcc quad_perm:[1,0,3,2] row_mask:0xf bank_mask:0xf
    v_cndmask_b32_dpp v182, v196, v180, vcc quad_perm:[1,0,3,2] row_mask:0xf bank_mask:0xf
    v_cndmask_b32_dpp v183, v197, v181, vcc quad_perm:[1,0,3,2] row_mask:0xf bank_mask:0xf
    v_cndmask_b32_dpp v186, v200, v184, vcc quad_perm:[1,0,3,2] row_mask:0xf bank_mask:0xf
    v_cndmask_b32_dpp v187, v201, v185, vcc quad_perm:[1,0,3,2] row_mask:0xf bank_mask:0xf
    v_cndmask_b32_dpp v190, v204, v188, vcc quad_perm:[1,0,3,2] row_mask:0xf bank_mask:0xf
    v_cndmask_b32_dpp v191, v205, v189, vcc quad_perm:[1,0,3,2] row_mask:0xf bank_mask:0xf
    s_not_b64 vcc, vcc
    v_cndmask_b32_dpp v162, v144, v160, vcc quad_perm:[1,0,3,2] row_mask:0xf bank_mask:0xf
    v_cndmask_b32_dpp v163, v145, v161, vcc quad_perm:[1,0,3,2] row_mask:0xf bank_mask:0xf
    v_cndmask_b32_dpp v166, v148, v164, vcc quad_perm:[1,0,3,2] row_mask:0xf bank_mask:0xf
    v_cndmask_b32_dpp v167, v149, v165, vcc quad_perm:[1,0,3,2] row_mask:0xf bank_mask:0xf
    v_cndmask_b32_dpp v170, v152, v168, vcc quad_perm:[1,0,3,2] row_mask:0xf bank_mask:0xf
    s_nop 0
    v_cndmask_b32_dpp v171, v153, v169, vcc quad_perm:[1,0,3,2] row_mask:0xf bank_mask:0xf
    v_cndmask_b32_dpp v174, v156, v172, vcc quad_perm:[1,0,3,2] row_mask:0xf bank_mask:0xf
    v_cndmask_b32_dpp v175, v157, v173, vcc quad_perm:[1,0,3,2] row_mask:0xf bank_mask:0xf
    v_cndmask_b32_dpp v194, v176, v192, vcc quad_perm:[1,0,3,2] row_mask:0xf bank_mask:0xf
    v_cndmask_b32_dpp v195, v177, v193, vcc quad_perm:[1,0,3,2] row_mask:0xf bank_mask:0xf
    v_cndmask_b32_dpp v198, v180, v196, vcc quad_perm:[1,0,3,2] row_mask:0xf bank_mask:0xf
    v_cndmask_b32_dpp v199, v181, v197, vcc quad_perm:[1,0,3,2] row_mask:0xf bank_mask:0xf
    v_cndmask_b32_dpp v202, v184, v200, vcc quad_perm:[1,0,3,2] row_mask:0xf bank_mask:0xf
    v_cndmask_b32_dpp v203, v185, v201, vcc quad_perm:[1,0,3,2] row_mask:0xf bank_mask:0xf
    v_cndmask_b32_dpp v206, v188, v204, vcc quad_perm:[1,0,3,2] row_mask:0xf bank_mask:0xf
    v_cndmask_b32_dpp v207, v189, v205, vcc quad_perm:[1,0,3,2] row_mask:0xf bank_mask:0xf
    s_mov_b64 vcc, s[96:97]
    v_cndmask_b32_dpp v112, v178, v146, vcc quad_perm:[2,3,0,1] row_mask:0xf bank_mask:0xf
    v_cndmask_b32_dpp v113, v179, v147, vcc quad_perm:[2,3,0,1] row_mask:0xf bank_mask:0xf
    v_cndmask_b32_dpp v114, v182, v150, vcc quad_perm:[2,3,0,1] row_mask:0xf bank_mask:0xf
    v_cndmask_b32_dpp v115, v183, v151, vcc quad_perm:[2,3,0,1] row_mask:0xf bank_mask:0xf
    s_nop 0
    v_cndmask_b32_dpp v116, v186, v154, vcc quad_perm:[2,3,0,1] row_mask:0xf bank_mask:0xf
    v_cndmask_b32_dpp v117, v187, v155, vcc quad_perm:[2,3,0,1] row_mask:0xf bank_mask:0xf
    v_cndmask_b32_dpp v118, v190, v158, vcc quad_perm:[2,3,0,1] row_mask:0xf bank_mask:0xf
    v_cndmask_b32_dpp v119, v191, v159, vcc quad_perm:[2,3,0,1] row_mask:0xf bank_mask:0xf
    v_cndmask_b32_dpp v120, v194, v162, vcc quad_perm:[2,3,0,1] row_mask:0xf bank_mask:0xf
    v_cndmask_b32_dpp v121, v195, v163, vcc quad_perm:[2,3,0,1] row_mask:0xf bank_mask:0xf
    v_cndmask_b32_dpp v122, v198, v166, vcc quad_perm:[2,3,0,1] row_mask:0xf bank_mask:0xf
    v_cndmask_b32_dpp v123, v199, v167, vcc quad_perm:[2,3,0,1] row_mask:0xf bank_mask:0xf
    v_cndmask_b32_dpp v124, v202, v170, vcc quad_perm:[2,3,0,1] row_mask:0xf bank_mask:0xf
    v_cndmask_b32_dpp v125, v203, v171, vcc quad_perm:[2,3,0,1] row_mask:0xf bank_mask:0xf
    v_cndmask_b32_dpp v126, v206, v174, vcc quad_perm:[2,3,0,1] row_mask:0xf bank_mask:0xf
    v_cndmask_b32_dpp v127, v207, v175, vcc quad_perm:[2,3,0,1] row_mask:0xf bank_mask:0xf
    s_not_b64 vcc, vcc
    v_cndmask_b32_dpp v128, v146, v178, vcc quad_perm:[2,3,0,1] row_mask:0xf bank_mask:0xf
    v_cndmask_b32_dpp v129, v147, v179, vcc quad_perm:[2,3,0,1] row_mask:0xf bank_mask:0xf
    v_cndmask_b32_dpp v130, v150, v182, vcc quad_perm:[2,3,0,1] row_mask:0xf bank_mask:0xf
    s_nop 0
    v_cndmask_b32_dpp v131, v151, v183, vcc quad_perm:[2,3,0,1] row_mask:0xf bank_mask:0xf
    v_cndmask_b32_dpp v132, v154, v186, vcc quad_perm:[2,3,0,1] row_mask:0xf bank_mask:0xf
    v_cndmask_b32_dpp v133, v155, v187, vcc quad_perm:[2,3,0,1] row_mask:0xf bank_mask:0xf
    v_cndmask_b32_dpp v134, v158, v190, vcc quad_perm:[2,3,0,1] row_mask:0xf bank_mask:0xf
    v_cndmask_b32_dpp v135, v159, v191, vcc quad_perm:[2,3,0,1] row_mask:0xf bank_mask:0xf
    v_cndmask_b32_dpp v136, v162, v194, vcc quad_perm:[2,3,0,1] row_mask:0xf bank_mask:0xf
    v_cndmask_b32_dpp v137, v163, v195, vcc quad_perm:[2,3,0,1] row_mask:0xf bank_mask:0xf
    v_cndmask_b32_dpp v138, v166, v198, vcc quad_perm:[2,3,0,1] row_mask:0xf bank_mask:0xf
    v_cndmask_b32_dpp v139, v167, v199, vcc quad_perm:[2,3,0,1] row_mask:0xf bank_mask:0xf
    v_cndmask_b32_dpp v140, v170, v202, vcc quad_perm:[2,3,0,1] row_mask:0xf bank_mask:0xf
    v_cndmask_b32_dpp v141, v171, v203, vcc quad_perm:[2,3,0,1] row_mask:0xf bank_mask:0xf
    v_cndmask_b32_dpp v142, v174, v206, vcc quad_perm:[2,3,0,1] row_mask:0xf bank_mask:0xf
    v_cndmask_b32_dpp v143, v175, v207, vcc quad_perm:[2,3,0,1] row_mask:0xf bank_mask:0xf
    v_xor_b32 v120, s55, v120
    v_xor_b32 v121, s55, v121
    v_xor_b32 v122, s55, v122
    v_xor_b32 v123, s55, v123
    v_xor_b32 v124, s55, v124
    v_xor_b32 v125, s55, v125
    v_xor_b32 v126, s55, v126
    v_xor_b32 v127, s55, v127
    v_cvt_pk_bf16_f32 v208, v208, v209
    v_cvt_pk_bf16_f32 v209, v210, v211
    v_mfma_f32_16x16x32_bf16 v[16:19], a[32:35], v[136:139], v[16:19]
    v_cvt_pk_bf16_f32 v212, v212, v213
    v_cvt_pk_bf16_f32 v213, v214, v215
    v_cvt_pk_bf16_f32 v216, v216, v217
    v_cvt_pk_bf16_f32 v217, v218, v219
    v_mfma_f32_16x16x32_bf16 v[20:23], a[36:39], v[136:139], v[20:23]
    v_cvt_pk_bf16_f32 v220, v220, v221
    v_cvt_pk_bf16_f32 v221, v222, v223
    v_cvt_pk_bf16_f32 v224, v224, v225
    v_cvt_pk_bf16_f32 v225, v226, v227
    v_mfma_f32_16x16x32_bf16 v[24:27], a[40:43], v[136:139], v[24:27]
    v_cvt_pk_bf16_f32 v228, v228, v229
    v_cvt_pk_bf16_f32 v229, v230, v231
    v_cvt_pk_bf16_f32 v232, v232, v233
    v_cvt_pk_bf16_f32 v233, v234, v235
    v_mfma_f32_16x16x32_bf16 v[28:31], a[44:47], v[136:139], v[28:31]
    v_cvt_pk_bf16_f32 v236, v236, v237
    v_cvt_pk_bf16_f32 v237, v238, v239
    v_cvt_pk_bf16_f32 v240, v240, v241
    v_cvt_pk_bf16_f32 v241, v242, v243
    v_mfma_f32_16x16x32_bf16 v[16:19], a[48:51], v[140:143], v[16:19]
    v_cvt_pk_bf16_f32 v244, v244, v245
    v_cvt_pk_bf16_f32 v245, v246, v247
    v_cvt_pk_bf16_f32 v248, v248, v249
    v_cvt_pk_bf16_f32 v249, v250, v251
    v_mfma_f32_16x16x32_bf16 v[20:23], a[52:55], v[140:143], v[20:23]
    v_cvt_pk_bf16_f32 v252, v252, v253
    v_cvt_pk_bf16_f32 v253, v254, v255
    s_mov_b64 vcc, s[94:95]
    s_nop 0
    v_cndmask_b32_dpp v210, v224, v208, vcc quad_perm:[1,0,3,2] row_mask:0xf bank_mask:0xf
    v_mfma_f32_16x16x32_bf16 v[24:27], a[56:59], v[140:143], v[24:27]
    v_cndmask_b32_dpp v211, v225, v209, vcc quad_perm:[1,0,3,2] row_mask:0xf bank_mask:0xf
    v_cndmask_b32_dpp v214, v228, v212, vcc quad_perm:[1,0,3,2] row_mask:0xf bank_mask:0xf
    v_cndmask_b32_dpp v215, v229, v213, vcc quad_perm:[1,0,3,2] row_mask:0xf bank_mask:0xf
    v_cndmask_b32_dpp v218, v232, v216, vcc quad_perm:[1,0,3,2] row_mask:0xf bank_mask:0xf
    v_mfma_f32_16x16x32_bf16 v[28:31], a[60:63], v[140:143], v[28:31]
    v_cndmask_b32_dpp v219, v233, v217, vcc quad_perm:[1,0,3,2] row_mask:0xf bank_mask:0xf
    v_cndmask_b32_dpp v222, v236, v220, vcc quad_perm:[1,0,3,2] row_mask:0xf bank_mask:0xf
    v_cndmask_b32_dpp v223, v237, v221, vcc quad_perm:[1,0,3,2] row_mask:0xf bank_mask:0xf
    s_not_b64 vcc, vcc
    v_mfma_f32_16x16x32_bf16 v[32:35], a[128:131], v[128:131], v[32:35]
    v_cndmask_b32_dpp v226, v208, v224, vcc quad_perm:[1,0,3,2] row_mask:0xf bank_mask:0xf
    v_cndmask_b32_dpp v227, v209, v225, vcc quad_perm:[1,0,3,2] row_mask:0xf bank_mask:0xf
    v_cndmask_b32_dpp v230, v212, v228, vcc quad_perm:[1,0,3,2] row_mask:0xf bank_mask:0xf
    v_cndmask_b32_dpp v231, v213, v229, vcc quad_perm:[1,0,3,2] row_mask:0xf bank_mask:0xf
    s_nop 0
    v_mfma_f32_16x16x32_bf16 v[36:39], a[132:135], v[128:131], v[36:39]
    v_cndmask_b32_dpp v234, v216, v232, vcc quad_perm:[1,0,3,2] row_mask:0xf bank_mask:0xf
    v_cndmask_b32_dpp v235, v217, v233, vcc quad_perm:[1,0,3,2] row_mask:0xf bank_mask:0xf
    v_cndmask_b32_dpp v238, v220, v236, vcc quad_perm:[1,0,3,2] row_mask:0xf bank_mask:0xf
    v_cndmask_b32_dpp v239, v221, v237, vcc quad_perm:[1,0,3,2] row_mask:0xf bank_mask:0xf
    v_mfma_f32_16x16x32_bf16 v[40:43], a[136:139], v[128:131], v[40:43]
    v_mov_b32_dpp v242, v240 quad_perm:[1,0,3,2] row_mask:0xf bank_mask:0xf
    v_mov_b32_dpp v243, v241 quad_perm:[1,0,3,2] row_mask:0xf bank_mask:0xf
    v_mov_b32_dpp v246, v244 quad_perm:[1,0,3,2] row_mask:0xf bank_mask:0xf
    v_mov_b32_dpp v247, v245 quad_perm:[1,0,3,2] row_mask:0xf bank_mask:0xf
    v_mfma_f32_16x16x32_bf16 v[44:47], a[140:143], v[128:131], v[44:47]
    v_mov_b32_dpp v250, v248 quad_perm:[1,0,3,2] row_mask:0xf bank_mask:0xf
    v_mov_b32_dpp v251, v249 quad_perm:[1,0,3,2] row_mask:0xf bank_mask:0xf
    v_mov_b32_dpp v254, v252 quad_perm:[1,0,3,2] row_mask:0xf bank_mask:0xf
    v_mov_b32_dpp v255, v253 quad_perm:[1,0,3,2] row_mask:0xf bank_mask:0xf
    v_mfma_f32_16x16x32_bf16 v[32:35], a[144:147], v[132:135], v[32:35]
    s_nop 0
    s_mov_b64 vcc, s[96:97]
    v_cndmask_b32_dpp v80, v240, v210, vcc quad_perm:[2,3,0,1] row_mask:0xf bank_mask:0xf
    v_cndmask_b32_dpp v81, v241, v211, vcc quad_perm:[2,3,0,1] row_mask:0xf bank_mask:0xf
    v_cndmask_b32_dpp v82, v244, v214, vcc quad_perm:[2,3,0,1] row_mask:0xf bank_mask:0xf
    v_mfma_f32_16x16x32_bf16 v[36:39], a[148:151], v[132:135], v[36:39]
    v_cndmask_b32_dpp v83, v245, v215, vcc quad_perm:[2,3,0,1] row_mask:0xf bank_mask:0xf
    v_cndmask_b32_dpp v84, v248, v218, vcc quad_perm:[2,3,0,1] row_mask:0xf bank_mask:0xf
    v_cndmask_b32_dpp v85, v249, v219, vcc quad_perm:[2,3,0,1] row_mask:0xf bank_mask:0xf
    v_cndmask_b32_dpp v86, v252, v222, vcc quad_perm:[2,3,0,1] row_mask:0xf bank_mask:0xf
    v_mfma_f32_16x16x32_bf16 v[40:43], a[152:155], v[132:135], v[40:43]
    v_cndmask_b32_dpp v87, v253, v223, vcc quad_perm:[2,3,0,1] row_mask:0xf bank_mask:0xf
    v_cndmask_b32_dpp v88, v242, v226, vcc quad_perm:[2,3,0,1] row_mask:0xf bank_mask:0xf
    v_cndmask_b32_dpp v89, v243, v227, vcc quad_perm:[2,3,0,1] row_mask:0xf bank_mask:0xf
    v_cndmask_b32_dpp v90, v246, v230, vcc quad_perm:[2,3,0,1] row_mask:0xf bank_mask:0xf
    v_mfma_f32_16x16x32_bf16 v[44:47], a[156:159], v[132:135], v[44:47]
    v_cndmask_b32_dpp v91, v247, v231, vcc quad_perm:[2,3,0,1] row_mask:0xf bank_mask:0xf
    v_cndmask_b32_dpp v92, v250, v234, vcc quad_perm:[2,3,0,1] row_mask:0xf bank_mask:0xf
    v_cndmask_b32_dpp v93, v251, v235, vcc quad_perm:[2,3,0,1] row_mask:0xf bank_mask:0xf
    v_cndmask_b32_dpp v94, v254, v238, vcc quad_perm:[2,3,0,1] row_mask:0xf bank_mask:0xf
    v_mfma_f32_16x16x32_bf16 v[48:51], a[128:131], v[120:123], v[48:51]
    v_cndmask_b32_dpp v95, v255, v239, vcc quad_perm:[2,3,0,1] row_mask:0xf bank_mask:0xf
    s_not_b64 vcc, vcc
    v_cndmask_b32_dpp v96, v210, v240, vcc quad_perm:[2,3,0,1] row_mask:0xf bank_mask:0xf
    v_cndmask_b32_dpp v97, v211, v241, vcc quad_perm:[2,3,0,1] row_mask:0xf bank_mask:0xf
    s_nop 0
    v_mfma_f32_16x16x32_bf16 v[52:55], a[132:135], v[120:123], v[52:55]
    v_cndmask_b32_dpp v98, v214, v244, vcc quad_perm:[2,3,0,1] row_mask:0xf bank_mask:0xf
    v_cndmask_b32_dpp v99, v215, v245, vcc quad_perm:[2,3,0,1] row_mask:0xf bank_mask:0xf
    v_cndmask_b32_dpp v100, v218, v248, vcc quad_perm:[2,3,0,1] row_mask:0xf bank_mask:0xf
    v_cndmask_b32_dpp v101, v219, v249, vcc quad_perm:[2,3,0,1] row_mask:0xf bank_mask:0xf
    v_mfma_f32_16x16x32_bf16 v[56:59], a[136:139], v[120:123], v[56:59]
    v_cndmask_b32_dpp v102, v222, v252, vcc quad_perm:[2,3,0,1] row_mask:0xf bank_mask:0xf
    v_cndmask_b32_dpp v103, v223, v253, vcc quad_perm:[2,3,0,1] row_mask:0xf bank_mask:0xf
    v_cndmask_b32_dpp v104, v226, v242, vcc quad_perm:[2,3,0,1] row_mask:0xf bank_mask:0xf
    v_cndmask_b32_dpp v105, v227, v243, vcc quad_perm:[2,3,0,1] row_mask:0xf bank_mask:0xf
    v_mfma_f32_16x16x32_bf16 v[60:63], a[140:143], v[120:123], v[60:63]
    v_cndmask_b32_dpp v106, v230, v246, vcc quad_perm:[2,3,0,1] row_mask:0xf bank_mask:0xf
    v_cndmask_b32_dpp v107, v231, v247, vcc quad_perm:[2,3,0,1] row_mask:0xf bank_mask:0xf
    v_cndmask_b32_dpp v108, v234, v250, vcc quad_perm:[2,3,0,1] row_mask:0xf bank_mask:0xf
    v_cndmask_b32_dpp v109, v235, v251, vcc quad_perm:[2,3,0,1] row_mask:0xf bank_mask:0xf
    v_mfma_f32_16x16x32_bf16 v[48:51], a[144:147], v[124:127], v[48:51]
    v_cndmask_b32_dpp v110, v238, v254, vcc quad_perm:[2,3,0,1] row_mask:0xf bank_mask:0xf
    v_cndmask_b32_dpp v111, v239, v255, vcc quad_perm:[2,3,0,1] row_mask:0xf bank_mask:0xf
    v_xor_b32 v88, s55, v88
    v_xor_b32 v89, s55, v89
    v_mfma_f32_16x16x32_bf16 v[52:55], a[148:151], v[124:127], v[52:55]
    v_xor_b32 v90, s55, v90
    v_xor_b32 v91, s55, v91
    v_xor_b32 v92, s55, v92
    v_xor_b32 v93, s55, v93
    v_mfma_f32_16x16x32_bf16 v[56:59], a[152:155], v[124:127], v[56:59]
    v_xor_b32 v94, s55, v94
    v_xor_b32 v95, s55, v95
    v_accvgpr_read_b32 v144, a160
    v_accvgpr_read_b32 v145, a161
    v_mfma_f32_16x16x32_bf16 v[60:63], a[156:159], v[124:127], v[60:63]
    v_accvgpr_read_b32 v146, a162
    v_accvgpr_read_b32 v147, a163
    v_accvgpr_read_b32 v148, a164
    v_accvgpr_read_b32 v149, a165
    v_mfma_f32_16x16x32_bf16 v[64:67], a[96:99], v[112:115], v[64:67]
    v_accvgpr_read_b32 v150, a166
    v_accvgpr_read_b32 v151, a167
    v_accvgpr_read_b32 v152, a168
    v_accvgpr_read_b32 v153, a169
    v_mfma_f32_16x16x32_bf16 v[68:71], a[100:103], v[112:115], v[68:71]
    v_accvgpr_read_b32 v154, a170
    v_accvgpr_read_b32 v155, a171
    v_accvgpr_read_b32 v156, a172
    v_accvgpr_read_b32 v157, a173
    v_mfma_f32_16x16x32_bf16 v[72:75], a[104:107], v[112:115], v[72:75]
    v_accvgpr_read_b32 v158, a174
    v_accvgpr_read_b32 v159, a175
    v_accvgpr_read_b32 v160, a176
    v_accvgpr_read_b32 v161, a177
    v_mfma_f32_16x16x32_bf16 v[76:79], a[108:111], v[112:115], v[76:79]
    v_accvgpr_read_b32 v162, a178
    v_accvgpr_read_b32 v163, a179
    v_accvgpr_read_b32 v164, a180
    v_accvgpr_read_b32 v165, a181
    v_mfma_f32_16x16x32_bf16 v[64:67], a[112:115], v[116:119], v[64:67]
    v_accvgpr_read_b32 v166, a182
    v_accvgpr_read_b32 v167, a183
    v_accvgpr_read_b32 v168, a184
    v_accvgpr_read_b32 v169, a185
    v_mfma_f32_16x16x32_bf16 v[68:71], a[116:119], v[116:119], v[68:71]
    v_accvgpr_read_b32 v170, a186
    v_accvgpr_read_b32 v171, a187
    v_accvgpr_read_b32 v172, a188
    v_accvgpr_read_b32 v173, a189
    v_mfma_f32_16x16x32_bf16 v[72:75], a[120:123], v[116:119], v[72:75]
    v_accvgpr_read_b32 v174, a190
    v_accvgpr_read_b32 v175, a191
    v_accvgpr_read_b32 v176, a192
    v_accvgpr_read_b32 v177, a193
    v_mfma_f32_16x16x32_bf16 v[76:79], a[124:127], v[116:119], v[76:79]
    v_accvgpr_read_b32 v178, a194
    v_accvgpr_read_b32 v179, a195
    v_accvgpr_read_b32 v180, a196
    v_accvgpr_read_b32 v181, a197
    v_accvgpr_read_b32 v182, a198
    v_accvgpr_read_b32 v183, a199
    v_accvgpr_read_b32 v184, a200
    v_accvgpr_read_b32 v185, a201
    v_accvgpr_read_b32 v186, a202
    v_accvgpr_read_b32 v187, a203
    v_accvgpr_read_b32 v188, a204
    v_accvgpr_read_b32 v189, a205
    v_accvgpr_read_b32 v190, a206
    v_accvgpr_read_b32 v191, a207
    v_accvgpr_read_b32 v192, a208
    v_accvgpr_read_b32 v193, a209
    v_accvgpr_read_b32 v194, a210
    v_accvgpr_read_b32 v195, a211
    v_accvgpr_read_b32 v196, a212
    v_accvgpr_read_b32 v197, a213
    v_accvgpr_read_b32 v198, a214
    v_accvgpr_read_b32 v199, a215
    v_accvgpr_read_b32 v200, a216
    v_accvgpr_read_b32 v201, a217
    v_accvgpr_read_b32 v202, a218
    v_accvgpr_read_b32 v203, a219
    v_accvgpr_read_b32 v204, a220
    v_accvgpr_read_b32 v205, a221
    v_accvgpr_read_b32 v206, a222
    v_accvgpr_read_b32 v207, a223
    v_pk_mul_f32 v[208:209], v[16:17], s[46:47]
    v_mfma_f32_16x16x32_bf16 v[144:147], a[32:35], v[104:107], v[144:147]
    v_pk_mul_f32 v[210:211], v[18:19], s[46:47]
    v_pk_mul_f32 v[212:213], v[20:21], s[46:47]
    v_mfma_f32_16x16x32_bf16 v[148:151], a[36:39], v[104:107], v[148:151]
    v_pk_mul_f32 v[214:215], v[22:23], s[46:47]
    v_pk_mul_f32 v[216:217], v[24:25], s[46:47]
    v_mfma_f32_16x16x32_bf16 v[152:155], a[40:43], v[104:107], v[152:155]
    v_pk_mul_f32 v[218:219], v[26:27], s[46:47]
    v_pk_mul_f32 v[220:221], v[28:29], s[46:47]
    v_mfma_f32_16x16x32_bf16 v[156:159], a[44:47], v[104:107], v[156:159]
    v_pk_mul_f32 v[222:223], v[30:31], s[46:47]
    v_exp_f32 v208, v208
    v_mfma_f32_16x16x32_bf16 v[144:147], a[48:51], v[108:111], v[144:147]
    v_exp_f32 v209, v209
    v_exp_f32 v210, v210
    v_mfma_f32_16x16x32_bf16 v[148:151], a[52:55], v[108:111], v[148:151]
    v_exp_f32 v211, v211
    v_exp_f32 v212, v212
    v_mfma_f32_16x16x32_bf16 v[152:155], a[56:59], v[108:111], v[152:155]
    v_exp_f32 v213, v213
    v_exp_f32 v214, v214
    v_mfma_f32_16x16x32_bf16 v[156:159], a[60:63], v[108:111], v[156:159]
    v_exp_f32 v215, v215
    v_exp_f32 v216, v216
    v_mfma_f32_16x16x32_bf16 v[160:163], a[128:131], v[96:99], v[160:163]
    v_exp_f32 v217, v217
    v_exp_f32 v218, v218
    v_mfma_f32_16x16x32_bf16 v[164:167], a[132:135], v[96:99], v[164:167]
    v_exp_f32 v219, v219
    v_exp_f32 v220, v220
    v_mfma_f32_16x16x32_bf16 v[168:171], a[136:139], v[96:99], v[168:171]
    v_exp_f32 v221, v221
    v_exp_f32 v222, v222
    v_mfma_f32_16x16x32_bf16 v[172:175], a[140:143], v[96:99], v[172:175]
    v_exp_f32 v223, v223
    v_cvt_pk_bf16_f32 v240, v16, v17
    v_mfma_f32_16x16x32_bf16 v[160:163], a[144:147], v[100:103], v[160:163]
    v_cvt_pk_bf16_f32 v241, v18, v19
    v_cvt_pk_bf16_f32 v242, v20, v21
    v_mfma_f32_16x16x32_bf16 v[164:167], a[148:151], v[100:103], v[164:167]
    v_cvt_pk_bf16_f32 v243, v22, v23
    v_cvt_pk_bf16_f32 v244, v24, v25
    v_mfma_f32_16x16x32_bf16 v[168:171], a[152:155], v[100:103], v[168:171]
    v_cvt_pk_bf16_f32 v245, v26, v27
    v_cvt_pk_bf16_f32 v246, v28, v29
    v_mfma_f32_16x16x32_bf16 v[172:175], a[156:159], v[100:103], v[172:175]
    v_cvt_pk_bf16_f32 v247, v30, v31
    s_mov_b64 vcc, s[94:95]
    v_mfma_f32_16x16x32_bf16 v[176:179], a[128:131], v[88:91], v[176:179]
    v_cndmask_b32_dpp v248, v244, v240, vcc quad_perm:[1,0,3,2] row_mask:0xf bank_mask:0xf
    v_cndmask_b32_dpp v249, v245, v241, vcc quad_perm:[1,0,3,2] row_mask:0xf bank_mask:0xf
    v_mfma_f32_16x16x32_bf16 v[180:183], a[132:135], v[88:91], v[180:183]
    v_cndmask_b32_dpp v250, v246, v242, vcc quad_perm:[1,0,3,2] row_mask:0xf bank_mask:0xf
    v_cndmask_b32_dpp v251, v247, v243, vcc quad_perm:[1,0,3,2] row_mask:0xf bank_mask:0xf
    v_mfma_f32_16x16x32_bf16 v[184:187], a[136:139], v[88:91], v[184:187]
    s_not_b64 vcc, vcc
    buffer_store_dwordx4 v[248:251], v1, s[12:15], 0 offen offset:0 sc0 sc1
    v_mfma_f32_16x16x32_bf16 v[188:191], a[140:143], v[88:91], v[188:191]
    v_cndmask_b32_dpp v252, v240, v244, vcc quad_perm:[1,0,3,2] row_mask:0xf bank_mask:0xf
    v_cndmask_b32_dpp v253, v241, v245, vcc quad_perm:[1,0,3,2] row_mask:0xf bank_mask:0xf
    v_mfma_f32_16x16x32_bf16 v[176:179], a[144:147], v[92:95], v[176:179]
    v_cndmask_b32_dpp v254, v242, v246, vcc quad_perm:[1,0,3,2] row_mask:0xf bank_mask:0xf
    v_cndmask_b32_dpp v255, v243, v247, vcc quad_perm:[1,0,3,2] row_mask:0xf bank_mask:0xf
    v_mfma_f32_16x16x32_bf16 v[180:183], a[148:151], v[92:95], v[180:183]
    buffer_store_dwordx4 v[252:255], v2, s[12:15], 0 offen offset:0 sc0 sc1
    v_pk_add_f32 v[208:209], v[208:209], 1.0 op_sel_hi:[1,0]
    v_mfma_f32_16x16x32_bf16 v[184:187], a[152:155], v[92:95], v[184:187]
    v_pk_add_f32 v[210:211], v[210:211], 1.0 op_sel_hi:[1,0]
    v_pk_add_f32 v[212:213], v[212:213], 1.0 op_sel_hi:[1,0]
    v_mfma_f32_16x16x32_bf16 v[188:191], a[156:159], v[92:95], v[188:191]
    v_pk_add_f32 v[214:215], v[214:215], 1.0 op_sel_hi:[1,0]
    v_pk_add_f32 v[216:217], v[216:217], 1.0 op_sel_hi:[1,0]
    v_mfma_f32_16x16x32_bf16 v[192:195], a[96:99], v[80:83], v[192:195]
    v_pk_add_f32 v[218:219], v[218:219], 1.0 op_sel_hi:[1,0]
    v_pk_add_f32 v[220:221], v[220:221], 1.0 op_sel_hi:[1,0]
    v_mfma_f32_16x16x32_bf16 v[196:199], a[100:103], v[80:83], v[196:199]
    v_pk_add_f32 v[222:223], v[222:223], 1.0 op_sel_hi:[1,0]
    v_rcp_f32 v208, v208
    v_mfma_f32_16x16x32_bf16 v[200:203], a[104:107], v[80:83], v[200:203]
    v_rcp_f32 v209, v209
    v_rcp_f32_e64 v210, v210
    v_mfma_f32_16x16x32_bf16 v[204:207], a[108:111], v[80:83], v[204:207]
    v_rcp_f32 v211, v211
    v_rcp_f32 v212, v212
    v_mfma_f32_16x16x32_bf16 v[192:195], a[112:115], v[84:87], v[192:195]
    v_rcp_f32 v213, v213
    v_rcp_f32 v214, v214
    v_mfma_f32_16x16x32_bf16 v[196:199], a[116:119], v[84:87], v[196:199]
    v_rcp_f32 v215, v215
    v_rcp_f32 v216, v216
    v_mfma_f32_16x16x32_bf16 v[200:203], a[120:123], v[84:87], v[200:203]
    v_rcp_f32 v217, v217
    v_rcp_f32 v218, v218
    v_mfma_f32_16x16x32_bf16 v[204:207], a[124:127], v[84:87], v[204:207]
    v_rcp_f32 v219, v219
    v_rcp_f32 v220, v220
    v_rcp_f32 v221, v221
    v_rcp_f32 v222, v222
    v_rcp_f32 v223, v223
    s_nop 3
    v_pk_mul_f32 v[224:225], v[144:145], s[46:47]
    v_pk_mul_f32 v[226:227], v[146:147], s[46:47]
    v_pk_mul_f32 v[228:229], v[148:149], s[46:47]
    v_pk_mul_f32 v[230:231], v[150:151], s[46:47]
    v_pk_mul_f32 v[232:233], v[152:153], s[46:47]
    v_pk_mul_f32 v[234:235], v[154:155], s[46:47]
    v_pk_mul_f32 v[236:237], v[156:157], s[46:47]
    v_pk_mul_f32 v[238:239], v[158:159], s[46:47]
    v_exp_f32 v224, v224
    v_exp_f32 v225, v225
    v_exp_f32 v226, v226
    v_exp_f32 v227, v227
    v_exp_f32 v228, v228
    v_exp_f32 v229, v229
    v_exp_f32 v230, v230
    v_exp_f32 v231, v231
    v_exp_f32 v232, v232
    v_exp_f32 v233, v233
    v_exp_f32 v234, v234
    v_exp_f32 v235, v235
    v_exp_f32 v236, v236
    v_exp_f32 v237, v237
    v_exp_f32 v238, v238
    v_exp_f32 v239, v239
    v_pk_mul_f32 v[32:33], v[32:33], v[208:209]
    v_pk_mul_f32 v[34:35], v[34:35], v[210:211]
    v_pk_mul_f32 v[36:37], v[36:37], v[212:213]
    v_pk_mul_f32 v[38:39], v[38:39], v[214:215]
    v_pk_mul_f32 v[40:41], v[40:41], v[216:217]
    v_pk_mul_f32 v[42:43], v[42:43], v[218:219]
    v_pk_mul_f32 v[44:45], v[44:45], v[220:221]
    v_pk_mul_f32 v[46:47], v[46:47], v[222:223]
    v_cvt_pk_bf16_f32 v240, v32, v33
    v_cvt_pk_bf16_f32 v241, v34, v35
    v_cvt_pk_bf16_f32 v242, v36, v37
    v_cvt_pk_bf16_f32 v243, v38, v39
    v_cvt_pk_bf16_f32 v244, v40, v41
    v_cvt_pk_bf16_f32 v245, v42, v43
    v_cvt_pk_bf16_f32 v246, v44, v45
    v_cvt_pk_bf16_f32 v247, v46, v47
    s_mov_b64 vcc, s[94:95]
    v_cndmask_b32_dpp v248, v244, v240, vcc quad_perm:[1,0,3,2] row_mask:0xf bank_mask:0xf
    v_cndmask_b32_dpp v249, v245, v241, vcc quad_perm:[1,0,3,2] row_mask:0xf bank_mask:0xf
    s_nop 0
    v_cndmask_b32_dpp v250, v246, v242, vcc quad_perm:[1,0,3,2] row_mask:0xf bank_mask:0xf
    v_cndmask_b32_dpp v251, v247, v243, vcc quad_perm:[1,0,3,2] row_mask:0xf bank_mask:0xf
    s_not_b64 vcc, vcc
    buffer_store_dwordx4 v[248:251], v1, s[12:15], 0 offen offset:128 sc0 sc1
    v_cndmask_b32_dpp v252, v240, v244, vcc quad_perm:[1,0,3,2] row_mask:0xf bank_mask:0xf
    v_cndmask_b32_dpp v253, v241, v245, vcc quad_perm:[1,0,3,2] row_mask:0xf bank_mask:0xf
    v_cndmask_b32_dpp v254, v242, v246, vcc quad_perm:[1,0,3,2] row_mask:0xf bank_mask:0xf
    v_cndmask_b32_dpp v255, v243, v247, vcc quad_perm:[1,0,3,2] row_mask:0xf bank_mask:0xf
    s_nop 0
    buffer_store_dwordx4 v[252:255], v2, s[12:15], 0 offen offset:128 sc0 sc1
    v_cvt_pk_bf16_f32 v240, v144, v145
    v_cvt_pk_bf16_f32 v241, v146, v147
    v_cvt_pk_bf16_f32 v242, v148, v149
    v_cvt_pk_bf16_f32 v243, v150, v151
    v_cvt_pk_bf16_f32 v244, v152, v153
    v_cvt_pk_bf16_f32 v245, v154, v155
    v_cvt_pk_bf16_f32 v246, v156, v157
    v_cvt_pk_bf16_f32 v247, v158, v159
    s_mov_b64 vcc, s[94:95]
    v_cndmask_b32_dpp v248, v244, v240, vcc quad_perm:[1,0,3,2] row_mask:0xf bank_mask:0xf
    v_cndmask_b32_dpp v249, v245, v241, vcc quad_perm:[1,0,3,2] row_mask:0xf bank_mask:0xf
    v_cndmask_b32_dpp v250, v246, v242, vcc quad_perm:[1,0,3,2] row_mask:0xf bank_mask:0xf
    v_cndmask_b32_dpp v251, v247, v243, vcc quad_perm:[1,0,3,2] row_mask:0xf bank_mask:0xf
    s_not_b64 vcc, vcc
    buffer_store_dwordx4 v[248:251], v3, s[12:15], 0 offen offset:0 sc0 sc1
    v_cndmask_b32_dpp v252, v240, v244, vcc quad_perm:[1,0,3,2] row_mask:0xf bank_mask:0xf
    v_cndmask_b32_dpp v253, v241, v245, vcc quad_perm:[1,0,3,2] row_mask:0xf bank_mask:0xf
    v_cndmask_b32_dpp v254, v242, v246, vcc quad_perm:[1,0,3,2] row_mask:0xf bank_mask:0xf
    v_cndmask_b32_dpp v255, v243, v247, vcc quad_perm:[1,0,3,2] row_mask:0xf bank_mask:0xf
    buffer_store_dwordx4 v[252:255], v4, s[12:15], 0 offen offset:0 sc0 sc1
    v_pk_mul_f32 v[48:49], v[48:49], v[208:209]
    v_pk_mul_f32 v[50:51], v[50:51], v[210:211]
    v_pk_mul_f32 v[52:53], v[52:53], v[212:213]
    v_pk_mul_f32 v[54:55], v[54:55], v[214:215]
    v_pk_mul_f32 v[56:57], v[56:57], v[216:217]
    v_pk_mul_f32 v[58:59], v[58:59], v[218:219]
    v_pk_mul_f32 v[60:61], v[60:61], v[220:221]
    v_pk_mul_f32 v[62:63], v[62:63], v[222:223]
    v_cvt_pk_bf16_f32 v240, v48, v49
    v_cvt_pk_bf16_f32 v241, v50, v51
    v_cvt_pk_bf16_f32 v242, v52, v53
    v_cvt_pk_bf16_f32 v243, v54, v55
    v_cvt_pk_bf16_f32 v244, v56, v57
    v_cvt_pk_bf16_f32 v245, v58, v59
    v_cvt_pk_bf16_f32 v246, v60, v61
    v_cvt_pk_bf16_f32 v247, v62, v63
    s_mov_b64 vcc, s[94:95]
    v_cndmask_b32_dpp v248, v244, v240, vcc quad_perm:[1,0,3,2] row_mask:0xf bank_mask:0xf
    v_cndmask_b32_dpp v249, v245, v241, vcc quad_perm:[1,0,3,2] row_mask:0xf bank_mask:0xf
    v_cndmask_b32_dpp v250, v246, v242, vcc quad_perm:[1,0,3,2] row_mask:0xf bank_mask:0xf
    v_cndmask_b32_dpp v251, v247, v243, vcc quad_perm:[1,0,3,2] row_mask:0xf bank_mask:0xf
    s_not_b64 vcc, vcc
    buffer_store_dwordx4 v[248:251], v1, s[12:15], 0 offen offset:256 sc0 sc1
    v_cndmask_b32_dpp v252, v240, v244, vcc quad_perm:[1,0,3,2] row_mask:0xf bank_mask:0xf
    v_cndmask_b32_dpp v253, v241, v245, vcc quad_perm:[1,0,3,2] row_mask:0xf bank_mask:0xf
    v_cndmask_b32_dpp v254, v242, v246, vcc quad_perm:[1,0,3,2] row_mask:0xf bank_mask:0xf
    v_cndmask_b32_dpp v255, v243, v247, vcc quad_perm:[1,0,3,2] row_mask:0xf bank_mask:0xf
    buffer_store_dwordx4 v[252:255], v2, s[12:15], 0 offen offset:256 sc0 sc1
    v_pk_add_f32 v[224:225], v[224:225], 1.0 op_sel_hi:[1,0]
    v_pk_add_f32 v[226:227], v[226:227], 1.0 op_sel_hi:[1,0]
    v_pk_add_f32 v[228:229], v[228:229], 1.0 op_sel_hi:[1,0]
    v_pk_add_f32 v[230:231], v[230:231], 1.0 op_sel_hi:[1,0]
    v_pk_add_f32 v[232:233], v[232:233], 1.0 op_sel_hi:[1,0]
    v_pk_add_f32 v[234:235], v[234:235], 1.0 op_sel_hi:[1,0]
    v_pk_add_f32 v[236:237], v[236:237], 1.0 op_sel_hi:[1,0]
    v_pk_add_f32 v[238:239], v[238:239], 1.0 op_sel_hi:[1,0]
    v_rcp_f32 v224, v224
    v_rcp_f32 v225, v225
    v_rcp_f32 v226, v226
    v_rcp_f32 v227, v227
    v_rcp_f32 v228, v228
    v_rcp_f32 v229, v229
    v_rcp_f32 v230, v230
    v_rcp_f32 v231, v231
    v_rcp_f32 v232, v232
    v_rcp_f32 v233, v233
    v_rcp_f32 v234, v234
    v_rcp_f32 v235, v235
    v_rcp_f32_e64 v236, v236
    v_rcp_f32_e64 v237, v237
    v_rcp_f32_e64 v238, v238
    v_rcp_f32_e64 v239, v239
    v_pk_mul_f32 v[64:65], v[64:65], v[208:209]
    v_pk_mul_f32 v[66:67], v[66:67], v[210:211]
    v_pk_mul_f32 v[68:69], v[68:69], v[212:213]
    v_pk_mul_f32 v[70:71], v[70:71], v[214:215]
    v_pk_mul_f32 v[72:73], v[72:73], v[216:217]
    v_pk_mul_f32 v[74:75], v[74:75], v[218:219]
    v_pk_mul_f32 v[76:77], v[76:77], v[220:221]
    v_pk_mul_f32 v[78:79], v[78:79], v[222:223]
    v_cvt_pk_bf16_f32 v240, v64, v65
    v_cvt_pk_bf16_f32 v241, v66, v67
    v_cvt_pk_bf16_f32 v242, v68, v69
    v_cvt_pk_bf16_f32 v243, v70, v71
    v_cvt_pk_bf16_f32 v244, v72, v73
    v_cvt_pk_bf16_f32 v245, v74, v75
    v_cvt_pk_bf16_f32 v246, v76, v77
    v_cvt_pk_bf16_f32 v247, v78, v79
    s_mov_b64 vcc, s[94:95]
    v_cndmask_b32_dpp v248, v244, v240, vcc quad_perm:[1,0,3,2] row_mask:0xf bank_mask:0xf
    v_cndmask_b32_dpp v249, v245, v241, vcc quad_perm:[1,0,3,2] row_mask:0xf bank_mask:0xf
    v_cndmask_b32_dpp v250, v246, v242, vcc quad_perm:[1,0,3,2] row_mask:0xf bank_mask:0xf
    v_cndmask_b32_dpp v251, v247, v243, vcc quad_perm:[1,0,3,2] row_mask:0xf bank_mask:0xf
    s_not_b64 vcc, vcc
    buffer_store_dwordx4 v[248:251], v1, s[12:15], 0 offen offset:384 sc0 sc1
    v_cndmask_b32_dpp v252, v240, v244, vcc quad_perm:[1,0,3,2] row_mask:0xf bank_mask:0xf
    v_cndmask_b32_dpp v253, v241, v245, vcc quad_perm:[1,0,3,2] row_mask:0xf bank_mask:0xf
    v_cndmask_b32_dpp v254, v242, v246, vcc quad_perm:[1,0,3,2] row_mask:0xf bank_mask:0xf
    v_cndmask_b32_dpp v255, v243, v247, vcc quad_perm:[1,0,3,2] row_mask:0xf bank_mask:0xf
    buffer_store_dwordx4 v[252:255], v2, s[12:15], 0 offen offset:384 sc0 sc1
    v_pk_mul_f32 v[160:161], v[160:161], v[224:225]
    v_pk_mul_f32 v[162:163], v[162:163], v[226:227]
    v_pk_mul_f32 v[164:165], v[164:165], v[228:229]
    v_pk_mul_f32 v[166:167], v[166:167], v[230:231]
    v_pk_mul_f32 v[168:169], v[168:169], v[232:233]
    v_pk_mul_f32 v[170:171], v[170:171], v[234:235]
    v_pk_mul_f32 v[172:173], v[172:173], v[236:237]
    v_pk_mul_f32 v[174:175], v[174:175], v[238:239]
    v_cvt_pk_bf16_f32 v240, v160, v161
    v_cvt_pk_bf16_f32 v241, v162, v163
    v_cvt_pk_bf16_f32 v242, v164, v165
    v_cvt_pk_bf16_f32 v243, v166, v167
    v_cvt_pk_bf16_f32 v244, v168, v169
    v_cvt_pk_bf16_f32 v245, v170, v171
    v_cvt_pk_bf16_f32 v246, v172, v173
    v_cvt_pk_bf16_f32 v247, v174, v175
    s_mov_b64 vcc, s[94:95]
    v_cndmask_b32_dpp v248, v244, v240, vcc quad_perm:[1,0,3,2] row_mask:0xf bank_mask:0xf
    v_cndmask_b32_dpp v249, v245, v241, vcc quad_perm:[1,0,3,2] row_mask:0xf bank_mask:0xf
    v_cndmask_b32_dpp v250, v246, v242, vcc quad_perm:[1,0,3,2] row_mask:0xf bank_mask:0xf
    v_cndmask_b32_dpp v251, v247, v243, vcc quad_perm:[1,0,3,2] row_mask:0xf bank_mask:0xf
    s_not_b64 vcc, vcc
    buffer_store_dwordx4 v[248:251], v3, s[12:15], 0 offen offset:128 sc0 sc1
    v_cndmask_b32_dpp v252, v240, v244, vcc quad_perm:[1,0,3,2] row_mask:0xf bank_mask:0xf
    v_cndmask_b32_dpp v253, v241, v245, vcc quad_perm:[1,0,3,2] row_mask:0xf bank_mask:0xf
    v_cndmask_b32_dpp v254, v242, v246, vcc quad_perm:[1,0,3,2] row_mask:0xf bank_mask:0xf
    v_cndmask_b32_dpp v255, v243, v247, vcc quad_perm:[1,0,3,2] row_mask:0xf bank_mask:0xf
    buffer_store_dwordx4 v[252:255], v4, s[12:15], 0 offen offset:128 sc0 sc1
    v_pk_mul_f32 v[176:177], v[176:177], v[224:225]
    v_pk_mul_f32 v[178:179], v[178:179], v[226:227]
    v_pk_mul_f32 v[180:181], v[180:181], v[228:229]
    v_pk_mul_f32 v[182:183], v[182:183], v[230:231]
    v_pk_mul_f32 v[184:185], v[184:185], v[232:233]
    v_pk_mul_f32 v[186:187], v[186:187], v[234:235]
    v_pk_mul_f32 v[188:189], v[188:189], v[236:237]
    v_pk_mul_f32 v[190:191], v[190:191], v[238:239]
    v_cvt_pk_bf16_f32 v240, v176, v177
    v_cvt_pk_bf16_f32 v241, v178, v179
    v_cvt_pk_bf16_f32 v242, v180, v181
    v_cvt_pk_bf16_f32 v243, v182, v183
    v_cvt_pk_bf16_f32 v244, v184, v185
    v_cvt_pk_bf16_f32 v245, v186, v187
    v_cvt_pk_bf16_f32 v246, v188, v189
    v_cvt_pk_bf16_f32 v247, v190, v191
    s_mov_b64 vcc, s[94:95]
    s_nop 0
    v_cndmask_b32_dpp v248, v244, v240, vcc quad_perm:[1,0,3,2] row_mask:0xf bank_mask:0xf
    v_cndmask_b32_dpp v249, v245, v241, vcc quad_perm:[1,0,3,2] row_mask:0xf bank_mask:0xf
    v_cndmask_b32_dpp v250, v246, v242, vcc quad_perm:[1,0,3,2] row_mask:0xf bank_mask:0xf
    v_cndmask_b32_dpp v251, v247, v243, vcc quad_perm:[1,0,3,2] row_mask:0xf bank_mask:0xf
    s_not_b64 vcc, vcc
    buffer_store_dwordx4 v[248:251], v3, s[12:15], 0 offen offset:256 sc0 sc1
    v_cndmask_b32_dpp v252, v240, v244, vcc quad_perm:[1,0,3,2] row_mask:0xf bank_mask:0xf
    v_cndmask_b32_dpp v253, v241, v245, vcc quad_perm:[1,0,3,2] row_mask:0xf bank_mask:0xf
    s_nop 0
    v_cndmask_b32_dpp v254, v242, v246, vcc quad_perm:[1,0,3,2] row_mask:0xf bank_mask:0xf
    v_cndmask_b32_dpp v255, v243, v247, vcc quad_perm:[1,0,3,2] row_mask:0xf bank_mask:0xf
    buffer_store_dwordx4 v[252:255], v4, s[12:15], 0 offen offset:256 sc0 sc1
    v_pk_mul_f32 v[192:193], v[192:193], v[224:225]
    v_pk_mul_f32 v[194:195], v[194:195], v[226:227]
    v_pk_mul_f32 v[196:197], v[196:197], v[228:229]
    v_pk_mul_f32 v[198:199], v[198:199], v[230:231]
    v_pk_mul_f32 v[200:201], v[200:201], v[232:233]
    v_pk_mul_f32 v[202:203], v[202:203], v[234:235]
    v_pk_mul_f32 v[204:205], v[204:205], v[236:237]
    v_pk_mul_f32 v[206:207], v[206:207], v[238:239]
    v_cvt_pk_bf16_f32 v240, v192, v193
    v_cvt_pk_bf16_f32 v241, v194, v195
    v_cvt_pk_bf16_f32 v242, v196, v197
    v_cvt_pk_bf16_f32 v243, v198, v199
    v_cvt_pk_bf16_f32 v244, v200, v201
    v_cvt_pk_bf16_f32 v245, v202, v203
    v_cvt_pk_bf16_f32 v246, v204, v205
    v_cvt_pk_bf16_f32 v247, v206, v207
    s_mov_b64 vcc, s[94:95]
    v_cndmask_b32_dpp v248, v244, v240, vcc quad_perm:[1,0,3,2] row_mask:0xf bank_mask:0xf
    v_cndmask_b32_dpp v249, v245, v241, vcc quad_perm:[1,0,3,2] row_mask:0xf bank_mask:0xf
    v_cndmask_b32_dpp v250, v246, v242, vcc quad_perm:[1,0,3,2] row_mask:0xf bank_mask:0xf
    v_cndmask_b32_dpp v251, v247, v243, vcc quad_perm:[1,0,3,2] row_mask:0xf bank_mask:0xf
    s_not_b64 vcc, vcc
    buffer_store_dwordx4 v[248:251], v3, s[12:15], 0 offen offset:384 sc0 sc1
    v_cndmask_b32_dpp v252, v240, v244, vcc quad_perm:[1,0,3,2] row_mask:0xf bank_mask:0xf
    v_cndmask_b32_dpp v253, v241, v245, vcc quad_perm:[1,0,3,2] row_mask:0xf bank_mask:0xf
    v_cndmask_b32_dpp v254, v242, v246, vcc quad_perm:[1,0,3,2] row_mask:0xf bank_mask:0xf
    v_cndmask_b32_dpp v255, v243, v247, vcc quad_perm:[1,0,3,2] row_mask:0xf bank_mask:0xf
    buffer_store_dwordx4 v[252:255], v4, s[12:15], 0 offen offset:384 sc0 sc1
    s_branch K2_fin
    s_nop 0
K2_flush3:
    v_cvt_pk_bf16_f32 v144, v144, v145
    v_cvt_pk_bf16_f32 v145, v146, v147
    v_cvt_pk_bf16_f32 v148, v148, v149
    v_cvt_pk_bf16_f32 v149, v150, v151
    v_cvt_pk_bf16_f32 v152, v152, v153
    v_cvt_pk_bf16_f32 v153, v154, v155
    v_cvt_pk_bf16_f32 v156, v156, v157
    v_cvt_pk_bf16_f32 v157, v158, v159
    v_cvt_pk_bf16_f32 v160, v160, v161
    v_cvt_pk_bf16_f32 v161, v162, v163
    v_cvt_pk_bf16_f32 v164, v164, v165
    v_cvt_pk_bf16_f32 v165, v166, v167
    v_cvt_pk_bf16_f32 v168, v168, v169
    v_cvt_pk_bf16_f32 v169, v170, v171
    v_cvt_pk_bf16_f32 v172, v172, v173
    v_cvt_pk_bf16_f32 v173, v174, v175
    v_cvt_pk_bf16_f32 v176, v176, v177
    v_cvt_pk_bf16_f32 v177, v178, v179
    v_cvt_pk_bf16_f32 v180, v180, v181
    v_cvt_pk_bf16_f32 v181, v182, v183
    v_cvt_pk_bf16_f32 v184, v184, v185
    v_cvt_pk_bf16_f32 v185, v186, v187
    v_cvt_pk_bf16_f32 v188, v188, v189
    v_cvt_pk_bf16_f32 v189, v190, v191
    v_cvt_pk_bf16_f32 v192, v192, v193
    v_cvt_pk_bf16_f32 v193, v194, v195
    v_cvt_pk_bf16_f32 v196, v196, v197
    v_cvt_pk_bf16_f32 v197, v198, v199
    v_cvt_pk_bf16_f32 v200, v200, v201
    v_cvt_pk_bf16_f32 v201, v202, v203
    v_cvt_pk_bf16_f32 v204, v204, v205
    v_cvt_pk_bf16_f32 v205, v206, v207
    s_mov_b64 vcc, s[94:95]
    s_nop 0
    v_cndmask_b32_dpp v146, v160, v144, vcc quad_perm:[1,0,3,2] row_mask:0xf bank_mask:0xf
    v_cndmask_b32_dpp v147, v161, v145, vcc quad_perm:[1,0,3,2] row_mask:0xf bank_mask:0xf
    v_cndmask_b32_dpp v150, v164, v148, vcc quad_perm:[1,0,3,2] row_mask:0xf bank_mask:0xf
    v_cndmask_b32_dpp v151, v165, v149, vcc quad_perm:[1,0,3,2] row_mask:0xf bank_mask:0xf
    v_cndmask_b32_dpp v154, v168, v152, vcc quad_perm:[1,0,3,2] row_mask:0xf bank_mask:0xf
    v_cndmask_b32_dpp v155, v169, v153, vcc quad_perm:[1,0,3,2] row_mask:0xf bank_mask:0xf
    v_cndmask_b32_dpp v158, v172, v156, vcc quad_perm:[1,0,3,2] row_mask:0xf bank_mask:0xf
    v_cndmask_b32_dpp v159, v173, v157, vcc quad_perm:[1,0,3,2] row_mask:0xf bank_mask:0xf
    v_cndmask_b32_dpp v178, v192, v176, vcc quad_perm:[1,0,3,2] row_mask:0xf bank_mask:0xf
    v_cndmask_b32_dpp v179, v193, v177, vcc quad_perm:[1,0,3,2] row_mask:0xf bank_mask:0xf
    v_cndmask_b32_dpp v182, v196, v180, vcc quad_perm:[1,0,3,2] row_mask:0xf bank_mask:0xf
    v_cndmask_b32_dpp v183, v197, v181, vcc quad_perm:[1,0,3,2] row_mask:0xf bank_mask:0xf
    v_cndmask_b32_dpp v186, v200, v184, vcc quad_perm:[1,0,3,2] row_mask:0xf bank_mask:0xf
    v_cndmask_b32_dpp v187, v201, v185, vcc quad_perm:[1,0,3,2] row_mask:0xf bank_mask:0xf
    v_cndmask_b32_dpp v190, v204, v188, vcc quad_perm:[1,0,3,2] row_mask:0xf bank_mask:0xf
    v_cndmask_b32_dpp v191, v205, v189, vcc quad_perm:[1,0,3,2] row_mask:0xf bank_mask:0xf
    s_nop 0
    s_not_b64 vcc, vcc
    v_cndmask_b32_dpp v162, v144, v160, vcc quad_perm:[1,0,3,2] row_mask:0xf bank_mask:0xf
    v_cndmask_b32_dpp v163, v145, v161, vcc quad_perm:[1,0,3,2] row_mask:0xf bank_mask:0xf
    v_cndmask_b32_dpp v166, v148, v164, vcc quad_perm:[1,0,3,2] row_mask:0xf bank_mask:0xf
    v_cndmask_b32_dpp v167, v149, v165, vcc quad_perm:[1,0,3,2] row_mask:0xf bank_mask:0xf
    v_cndmask_b32_dpp v170, v152, v168, vcc quad_perm:[1,0,3,2] row_mask:0xf bank_mask:0xf
    v_cndmask_b32_dpp v171, v153, v169, vcc quad_perm:[1,0,3,2] row_mask:0xf bank_mask:0xf
    v_cndmask_b32_dpp v174, v156, v172, vcc quad_perm:[1,0,3,2] row_mask:0xf bank_mask:0xf
    v_cndmask_b32_dpp v175, v157, v173, vcc quad_perm:[1,0,3,2] row_mask:0xf bank_mask:0xf
    v_cndmask_b32_dpp v194, v176, v192, vcc quad_perm:[1,0,3,2] row_mask:0xf bank_mask:0xf
    v_cndmask_b32_dpp v195, v177, v193, vcc quad_perm:[1,0,3,2] row_mask:0xf bank_mask:0xf
    v_cndmask_b32_dpp v198, v180, v196, vcc quad_perm:[1,0,3,2] row_mask:0xf bank_mask:0xf
    v_cndmask_b32_dpp v199, v181, v197, vcc quad_perm:[1,0,3,2] row_mask:0xf bank_mask:0xf
    v_cndmask_b32_dpp v202, v184, v200, vcc quad_perm:[1,0,3,2] row_mask:0xf bank_mask:0xf
    v_cndmask_b32_dpp v203, v185, v201, vcc quad_perm:[1,0,3,2] row_mask:0xf bank_mask:0xf
    v_cndmask_b32_dpp v206, v188, v204, vcc quad_perm:[1,0,3,2] row_mask:0xf bank_mask:0xf
    v_cndmask_b32_dpp v207, v189, v205, vcc quad_perm:[1,0,3,2] row_mask:0xf bank_mask:0xf
    s_mov_b64 vcc, s[96:97]
    v_cndmask_b32_dpp v112, v178, v146, vcc quad_perm:[2,3,0,1] row_mask:0xf bank_mask:0xf
    v_cndmask_b32_dpp v113, v179, v147, vcc quad_perm:[2,3,0,1] row_mask:0xf bank_mask:0xf
    v_cndmask_b32_dpp v114, v182, v150, vcc quad_perm:[2,3,0,1] row_mask:0xf bank_mask:0xf
    v_cndmask_b32_dpp v115, v183, v151, vcc quad_perm:[2,3,0,1] row_mask:0xf bank_mask:0xf
    v_cndmask_b32_dpp v116, v186, v154, vcc quad_perm:[2,3,0,1] row_mask:0xf bank_mask:0xf
    v_cndmask_b32_dpp v117, v187, v155, vcc quad_perm:[2,3,0,1] row_mask:0xf bank_mask:0xf
    s_nop 0
    v_cndmask_b32_dpp v118, v190, v158, vcc quad_perm:[2,3,0,1] row_mask:0xf bank_mask:0xf
    v_cndmask_b32_dpp v119, v191, v159, vcc quad_perm:[2,3,0,1] row_mask:0xf bank_mask:0xf
    v_cndmask_b32_dpp v120, v194, v162, vcc quad_perm:[2,3,0,1] row_mask:0xf bank_mask:0xf
    v_cndmask_b32_dpp v121, v195, v163, vcc quad_perm:[2,3,0,1] row_mask:0xf bank_mask:0xf
    v_cndmask_b32_dpp v122, v198, v166, vcc quad_perm:[2,3,0,1] row_mask:0xf bank_mask:0xf
    v_cndmask_b32_dpp v123, v199, v167, vcc quad_perm:[2,3,0,1] row_mask:0xf bank_mask:0xf
    v_cndmask_b32_dpp v124, v202, v170, vcc quad_perm:[2,3,0,1] row_mask:0xf bank_mask:0xf
    v_cndmask_b32_dpp v125, v203, v171, vcc quad_perm:[2,3,0,1] row_mask:0xf bank_mask:0xf
    v_cndmask_b32_dpp v126, v206, v174, vcc quad_perm:[2,3,0,1] row_mask:0xf bank_mask:0xf
    v_cndmask_b32_dpp v127, v207, v175, vcc quad_perm:[2,3,0,1] row_mask:0xf bank_mask:0xf
    s_not_b64 vcc, vcc
    v_cndmask_b32_dpp v128, v146, v178, vcc quad_perm:[2,3,0,1] row_mask:0xf bank_mask:0xf
    v_cndmask_b32_dpp v129, v147, v179, vcc quad_perm:[2,3,0,1] row_mask:0xf bank_mask:0xf
    v_cndmask_b32_dpp v130, v150, v182, vcc quad_perm:[2,3,0,1] row_mask:0xf bank_mask:0xf
    v_cndmask_b32_dpp v131, v151, v183, vcc quad_perm:[2,3,0,1] row_mask:0xf bank_mask:0xf
    v_cndmask_b32_dpp v132, v154, v186, vcc quad_perm:[2,3,0,1] row_mask:0xf bank_mask:0xf
    s_nop 0
    v_cndmask_b32_dpp v133, v155, v187, vcc quad_perm:[2,3,0,1] row_mask:0xf bank_mask:0xf
    v_cndmask_b32_dpp v134, v158, v190, vcc quad_perm:[2,3,0,1] row_mask:0xf bank_mask:0xf
    v_cndmask_b32_dpp v135, v159, v191, vcc quad_perm:[2,3,0,1] row_mask:0xf bank_mask:0xf
    v_cndmask_b32_dpp v136, v162, v194, vcc quad_perm:[2,3,0,1] row_mask:0xf bank_mask:0xf
    v_cndmask_b32_dpp v137, v163, v195, vcc quad_perm:[2,3,0,1] row_mask:0xf bank_mask:0xf
    v_cndmask_b32_dpp v138, v166, v198, vcc quad_perm:[2,3,0,1] row_mask:0xf bank_mask:0xf
    v_cndmask_b32_dpp v139, v167, v199, vcc quad_perm:[2,3,0,1] row_mask:0xf bank_mask:0xf
    v_cndmask_b32_dpp v140, v170, v202, vcc quad_perm:[2,3,0,1] row_mask:0xf bank_mask:0xf
    v_cndmask_b32_dpp v141, v171, v203, vcc quad_perm:[2,3,0,1] row_mask:0xf bank_mask:0xf
    v_cndmask_b32_dpp v142, v174, v206, vcc quad_perm:[2,3,0,1] row_mask:0xf bank_mask:0xf
    v_cndmask_b32_dpp v143, v175, v207, vcc quad_perm:[2,3,0,1] row_mask:0xf bank_mask:0xf
    v_xor_b32 v120, s55, v120
    v_xor_b32 v121, s55, v121
    v_xor_b32 v122, s55, v122
    v_xor_b32 v123, s55, v123
    v_xor_b32 v124, s55, v124
    v_xor_b32 v125, s55, v125
    v_xor_b32 v126, s55, v126
    v_xor_b32_e64 v127, s55, v127
    s_nop 1
    v_mfma_f32_16x16x32_bf16 v[64:67], a[96:99], v[112:115], v[64:67]
    v_mfma_f32_16x16x32_bf16 v[68:71], a[100:103], v[112:115], v[68:71]
    v_mfma_f32_16x16x32_bf16 v[72:75], a[104:107], v[112:115], v[72:75]
    v_mfma_f32_16x16x32_bf16 v[76:79], a[108:111], v[112:115], v[76:79]
    v_mfma_f32_16x16x32_bf16 v[64:67], a[112:115], v[116:119], v[64:67]
    v_mfma_f32_16x16x32_bf16 v[68:71], a[116:119], v[116:119], v[68:71]
    v_mfma_f32_16x16x32_bf16 v[72:75], a[120:123], v[116:119], v[72:75]
    v_mfma_f32_16x16x32_bf16 v[76:79], a[124:127], v[116:119], v[76:79]
    v_mfma_f32_16x16x32_bf16 v[48:51], a[128:131], v[120:123], v[48:51]
    v_mfma_f32_16x16x32_bf16 v[52:55], a[132:135], v[120:123], v[52:55]
    v_mfma_f32_16x16x32_bf16 v[56:59], a[136:139], v[120:123], v[56:59]
    v_mfma_f32_16x16x32_bf16 v[60:63], a[140:143], v[120:123], v[60:63]
    v_mfma_f32_16x16x32_bf16 v[48:51], a[144:147], v[124:127], v[48:51]
    v_mfma_f32_16x16x32_bf16 v[52:55], a[148:151], v[124:127], v[52:55]
    v_mfma_f32_16x16x32_bf16 v[56:59], a[152:155], v[124:127], v[56:59]
    v_mfma_f32_16x16x32_bf16 v[60:63], a[156:159], v[124:127], v[60:63]
    v_mfma_f32_16x16x32_bf16 v[32:35], a[128:131], v[128:131], v[32:35]
    v_mfma_f32_16x16x32_bf16 v[36:39], a[132:135], v[128:131], v[36:39]
    v_mfma_f32_16x16x32_bf16 v[40:43], a[136:139], v[128:131], v[40:43]
    v_mfma_f32_16x16x32_bf16 v[44:47], a[140:143], v[128:131], v[44:47]
    v_mfma_f32_16x16x32_bf16 v[32:35], a[144:147], v[132:135], v[32:35]
    v_mfma_f32_16x16x32_bf16 v[36:39], a[148:151], v[132:135], v[36:39]
    v_mfma_f32_16x16x32_bf16 v[40:43], a[152:155], v[132:135], v[40:43]
    v_mfma_f32_16x16x32_bf16 v[44:47], a[156:159], v[132:135], v[44:47]
    v_mfma_f32_16x16x32_bf16 v[16:19], a[32:35], v[136:139], v[16:19]
    v_mfma_f32_16x16x32_bf16 v[20:23], a[36:39], v[136:139], v[20:23]
    v_mfma_f32_16x16x32_bf16 v[24:27], a[40:43], v[136:139], v[24:27]
    v_mfma_f32_16x16x32_bf16 v[28:31], a[44:47], v[136:139], v[28:31]
    v_mfma_f32_16x16x32_bf16 v[16:19], a[48:51], v[140:143], v[16:19]
    v_mfma_f32_16x16x32_bf16 v[20:23], a[52:55], v[140:143], v[20:23]
    v_mfma_f32_16x16x32_bf16 v[24:27], a[56:59], v[140:143], v[24:27]
    v_mfma_f32_16x16x32_bf16 v[28:31], a[60:63], v[140:143], v[28:31]
    v_cvt_pk_bf16_f32 v208, v208, v209
    v_cvt_pk_bf16_f32 v209, v210, v211
    v_cvt_pk_bf16_f32 v212, v212, v213
    v_cvt_pk_bf16_f32 v213, v214, v215
    v_cvt_pk_bf16_f32 v216, v216, v217
    v_cvt_pk_bf16_f32 v217, v218, v219
    v_cvt_pk_bf16_f32 v220, v220, v221
    v_cvt_pk_bf16_f32 v221, v222, v223
    v_cvt_pk_bf16_f32 v224, v224, v225
    v_cvt_pk_bf16_f32 v225, v226, v227
    v_cvt_pk_bf16_f32 v228, v228, v229
    v_cvt_pk_bf16_f32 v229, v230, v231
    v_cvt_pk_bf16_f32 v232, v232, v233
    v_cvt_pk_bf16_f32 v233, v234, v235
    v_cvt_pk_bf16_f32 v236, v236, v237
    v_cvt_pk_bf16_f32 v237, v238, v239
    v_cvt_pk_bf16_f32 v240, v240, v241
    v_cvt_pk_bf16_f32 v241, v242, v243
    v_cvt_pk_bf16_f32 v244, v244, v245
    v_cvt_pk_bf16_f32 v245, v246, v247
    v_cvt_pk_bf16_f32 v248, v248, v249
    v_cvt_pk_bf16_f32 v249, v250, v251
    v_cvt_pk_bf16_f32 v252, v252, v253
    v_cvt_pk_bf16_f32 v253, v254, v255
    s_nop 0
    s_mov_b64 vcc, s[94:95]
    v_cndmask_b32_dpp v210, v224, v208, vcc quad_perm:[1,0,3,2] row_mask:0xf bank_mask:0xf
    v_cndmask_b32_dpp v211, v225, v209, vcc quad_perm:[1,0,3,2] row_mask:0xf bank_mask:0xf
    v_cndmask_b32_dpp v214, v228, v212, vcc quad_perm:[1,0,3,2] row_mask:0xf bank_mask:0xf
    v_cndmask_b32_dpp v215, v229, v213, vcc quad_perm:[1,0,3,2] row_mask:0xf bank_mask:0xf
    v_cndmask_b32_dpp v218, v232, v216, vcc quad_perm:[1,0,3,2] row_mask:0xf bank_mask:0xf
    v_cndmask_b32_dpp v219, v233, v217, vcc quad_perm:[1,0,3,2] row_mask:0xf bank_mask:0xf
    v_cndmask_b32_dpp v222, v236, v220, vcc quad_perm:[1,0,3,2] row_mask:0xf bank_mask:0xf
    v_cndmask_b32_dpp v223, v237, v221, vcc quad_perm:[1,0,3,2] row_mask:0xf bank_mask:0xf
    s_not_b64 vcc, vcc
    v_cndmask_b32_dpp v226, v208, v224, vcc quad_perm:[1,0,3,2] row_mask:0xf bank_mask:0xf
    v_cndmask_b32_dpp v227, v209, v225, vcc quad_perm:[1,0,3,2] row_mask:0xf bank_mask:0xf
    v_cndmask_b32_dpp v230, v212, v228, vcc quad_perm:[1,0,3,2] row_mask:0xf bank_mask:0xf
    v_cndmask_b32_dpp v231, v213, v229, vcc quad_perm:[1,0,3,2] row_mask:0xf bank_mask:0xf
    v_cndmask_b32_dpp v234, v216, v232, vcc quad_perm:[1,0,3,2] row_mask:0xf bank_mask:0xf
    v_cndmask_b32_dpp v235, v217, v233, vcc quad_perm:[1,0,3,2] row_mask:0xf bank_mask:0xf
    s_nop 0
    v_cndmask_b32_dpp v238, v220, v236, vcc quad_perm:[1,0,3,2] row_mask:0xf bank_mask:0xf
    v_cndmask_b32_dpp v239, v221, v237, vcc quad_perm:[1,0,3,2] row_mask:0xf bank_mask:0xf
    v_mov_b32_dpp v242, v240 quad_perm:[1,0,3,2] row_mask:0xf bank_mask:0xf
    v_mov_b32_dpp v243, v241 quad_perm:[1,0,3,2] row_mask:0xf bank_mask:0xf
    v_mov_b32_dpp v246, v244 quad_perm:[1,0,3,2] row_mask:0xf bank_mask:0xf
    v_mov_b32_dpp v247, v245 quad_perm:[1,0,3,2] row_mask:0xf bank_mask:0xf
    v_mov_b32_dpp v250, v248 quad_perm:[1,0,3,2] row_mask:0xf bank_mask:0xf
    v_mov_b32_dpp v251, v249 quad_perm:[1,0,3,2] row_mask:0xf bank_mask:0xf
    v_mov_b32_dpp v254, v252 quad_perm:[1,0,3,2] row_mask:0xf bank_mask:0xf
    v_mov_b32_dpp v255, v253 quad_perm:[1,0,3,2] row_mask:0xf bank_mask:0xf
    s_mov_b64 vcc, s[96:97]
    v_cndmask_b32_dpp v112, v240, v210, vcc quad_perm:[2,3,0,1] row_mask:0xf bank_mask:0xf
    v_cndmask_b32_dpp v113, v241, v211, vcc quad_perm:[2,3,0,1] row_mask:0xf bank_mask:0xf
    v_cndmask_b32_dpp v114, v244, v214, vcc quad_perm:[2,3,0,1] row_mask:0xf bank_mask:0xf
    v_cndmask_b32_dpp v115, v245, v215, vcc quad_perm:[2,3,0,1] row_mask:0xf bank_mask:0xf
    v_cndmask_b32_dpp v116, v248, v218, vcc quad_perm:[2,3,0,1] row_mask:0xf bank_mask:0xf
    s_nop 0
    v_cndmask_b32_dpp v117, v249, v219, vcc quad_perm:[2,3,0,1] row_mask:0xf bank_mask:0xf
    v_cndmask_b32_dpp v118, v252, v222, vcc quad_perm:[2,3,0,1] row_mask:0xf bank_mask:0xf
    v_cndmask_b32_dpp v119, v253, v223, vcc quad_perm:[2,3,0,1] row_mask:0xf bank_mask:0xf
    v_cndmask_b32_dpp v120, v242, v226, vcc quad_perm:[2,3,0,1] row_mask:0xf bank_mask:0xf
    v_cndmask_b32_dpp v121, v243, v227, vcc quad_perm:[2,3,0,1] row_mask:0xf bank_mask:0xf
    v_cndmask_b32_dpp v122, v246, v230, vcc quad_perm:[2,3,0,1] row_mask:0xf bank_mask:0xf
    v_cndmask_b32_dpp v123, v247, v231, vcc quad_perm:[2,3,0,1] row_mask:0xf bank_mask:0xf
    v_cndmask_b32_dpp v124, v250, v234, vcc quad_perm:[2,3,0,1] row_mask:0xf bank_mask:0xf
    v_cndmask_b32_dpp v125, v251, v235, vcc quad_perm:[2,3,0,1] row_mask:0xf bank_mask:0xf
    v_cndmask_b32_dpp v126, v254, v238, vcc quad_perm:[2,3,0,1] row_mask:0xf bank_mask:0xf
    v_cndmask_b32_dpp v127, v255, v239, vcc quad_perm:[2,3,0,1] row_mask:0xf bank_mask:0xf
    s_not_b64 vcc, vcc
    v_cndmask_b32_dpp v128, v210, v240, vcc quad_perm:[2,3,0,1] row_mask:0xf bank_mask:0xf
    v_cndmask_b32_dpp v129, v211, v241, vcc quad_perm:[2,3,0,1] row_mask:0xf bank_mask:0xf
    v_cndmask_b32_dpp v130, v214, v244, vcc quad_perm:[2,3,0,1] row_mask:0xf bank_mask:0xf
    v_cndmask_b32_dpp v131, v215, v245, vcc quad_perm:[2,3,0,1] row_mask:0xf bank_mask:0xf
    s_nop 0
    v_cndmask_b32_dpp v132, v218, v248, vcc quad_perm:[2,3,0,1] row_mask:0xf bank_mask:0xf
    v_cndmask_b32_dpp v133, v219, v249, vcc quad_perm:[2,3,0,1] row_mask:0xf bank_mask:0xf
    v_cndmask_b32_dpp v134, v222, v252, vcc quad_perm:[2,3,0,1] row_mask:0xf bank_mask:0xf
    v_cndmask_b32_dpp v135, v223, v253, vcc quad_perm:[2,3,0,1] row_mask:0xf bank_mask:0xf
    v_cndmask_b32_dpp v136, v226, v242, vcc quad_perm:[2,3,0,1] row_mask:0xf bank_mask:0xf
    v_cndmask_b32_dpp v137, v227, v243, vcc quad_perm:[2,3,0,1] row_mask:0xf bank_mask:0xf
    v_cndmask_b32_dpp v138, v230, v246, vcc quad_perm:[2,3,0,1] row_mask:0xf bank_mask:0xf
    v_cndmask_b32_dpp v139, v231, v247, vcc quad_perm:[2,3,0,1] row_mask:0xf bank_mask:0xf
    v_cndmask_b32_dpp v140, v234, v250, vcc quad_perm:[2,3,0,1] row_mask:0xf bank_mask:0xf
    v_cndmask_b32_dpp v141, v235, v251, vcc quad_perm:[2,3,0,1] row_mask:0xf bank_mask:0xf
    v_cndmask_b32_dpp v142, v238, v254, vcc quad_perm:[2,3,0,1] row_mask:0xf bank_mask:0xf
    v_cndmask_b32_dpp v143, v239, v255, vcc quad_perm:[2,3,0,1] row_mask:0xf bank_mask:0xf
    v_xor_b32 v120, s55, v120
    v_xor_b32 v121, s55, v121
    v_xor_b32 v122, s55, v122
    v_xor_b32 v123, s55, v123
    v_xor_b32 v124, s55, v124
    v_xor_b32 v125, s55, v125
    v_xor_b32 v126, s55, v126
    v_xor_b32_e64 v127, s55, v127
    s_nop 1
    v_mfma_f32_16x16x32_bf16 a[208:211], a[96:99], v[112:115], a[208:211]
    v_mfma_f32_16x16x32_bf16 a[212:215], a[100:103], v[112:115], a[212:215]
    v_mfma_f32_16x16x32_bf16 a[216:219], a[104:107], v[112:115], a[216:219]
    v_mfma_f32_16x16x32_bf16 a[220:223], a[108:111], v[112:115], a[220:223]
    v_mfma_f32_16x16x32_bf16 a[208:211], a[112:115], v[116:119], a[208:211]
    v_mfma_f32_16x16x32_bf16 a[212:215], a[116:119], v[116:119], a[212:215]
    v_mfma_f32_16x16x32_bf16 a[216:219], a[120:123], v[116:119], a[216:219]
    v_mfma_f32_16x16x32_bf16 a[220:223], a[124:127], v[116:119], a[220:223]
    v_mfma_f32_16x16x32_bf16 a[192:195], a[128:131], v[120:123], a[192:195]
    v_mfma_f32_16x16x32_bf16 a[196:199], a[132:135], v[120:123], a[196:199]
    v_mfma_f32_16x16x32_bf16 a[200:203], a[136:139], v[120:123], a[200:203]
    v_mfma_f32_16x16x32_bf16 a[204:207], a[140:143], v[120:123], a[204:207]
    v_mfma_f32_16x16x32_bf16 a[192:195], a[144:147], v[124:127], a[192:195]
    v_mfma_f32_16x16x32_bf16 a[196:199], a[148:151], v[124:127], a[196:199]
    v_mfma_f32_16x16x32_bf16 a[200:203], a[152:155], v[124:127], a[200:203]
    v_mfma_f32_16x16x32_bf16 a[204:207], a[156:159], v[124:127], a[204:207]
    v_mfma_f32_16x16x32_bf16 a[176:179], a[128:131], v[128:131], a[176:179]
    v_mfma_f32_16x16x32_bf16 a[180:183], a[132:135], v[128:131], a[180:183]
    v_mfma_f32_16x16x32_bf16 a[184:187], a[136:139], v[128:131], a[184:187]
    v_mfma_f32_16x16x32_bf16 a[188:191], a[140:143], v[128:131], a[188:191]
    v_mfma_f32_16x16x32_bf16 a[176:179], a[144:147], v[132:135], a[176:179]
    v_mfma_f32_16x16x32_bf16 a[180:183], a[148:151], v[132:135], a[180:183]
    v_mfma_f32_16x16x32_bf16 a[184:187], a[152:155], v[132:135], a[184:187]
    v_mfma_f32_16x16x32_bf16 a[188:191], a[156:159], v[132:135], a[188:191]
    v_mfma_f32_16x16x32_bf16 a[160:163], a[32:35], v[136:139], a[160:163]
    v_mfma_f32_16x16x32_bf16 a[164:167], a[36:39], v[136:139], a[164:167]
    v_mfma_f32_16x16x32_bf16 a[168:171], a[40:43], v[136:139], a[168:171]
    v_mfma_f32_16x16x32_bf16 a[172:175], a[44:47], v[136:139], a[172:175]
    v_mfma_f32_16x16x32_bf16 a[160:163], a[48:51], v[140:143], a[160:163]
    v_mfma_f32_16x16x32_bf16 a[164:167], a[52:55], v[140:143], a[164:167]
    v_mfma_f32_16x16x32_bf16 a[168:171], a[56:59], v[140:143], a[168:171]
    v_mfma_f32_16x16x32_bf16 a[172:175], a[60:63], v[140:143], a[172:175]
K2_pass_end:
    s_add_u32 s40, s40, s41
    s_cmp_lt_u32 s40, 256
    s_cbranch_scc1 K2_again
    s_cmp_eq_u32 s49, 0
    s_cbranch_scc1 K2_epilogue
    s_mov_b32 s49, 0
    s_mov_b32 s40, 0
    s_movk_i32 s41, 256
    s_add_u32 s39, s39, 32
    s_cmp_ge_u32 s39, 3200
    s_cbranch_scc1 K2_epilogue
    s_branch K2_again
K2_overflow:
    s_lshr_b32 s41, s41, 1
    s_cmp_lt_u32 s41, 4
    s_cbranch_scc1 K2_end
K2_again:
    s_waitcnt vmcnt(0) lgkmcnt(0)
    s_barrier
    s_branch K2_pass
    s_nop 0
    s_nop 0
    s_nop 0
    s_nop 0
    s_nop 0
    s_nop 0
    s_nop 0
    s_nop 0
K2_epilogue:
    s_mov_b32 s46, 0xbfb8aa3b
    s_mov_b32 s47, 0xbfb8aa3b
    s_nop 7
    s_mov_b64 vcc, s[94:95]
    v_and_b32 v5, 1, v15
    v_lshlrev_b32 v5, 6, v5
    s_nop 0
    v_cndmask_b32_dpp v1, v10, v10, vcc quad_perm:[1,0,3,2] row_mask:0xf bank_mask:0xf
    v_cndmask_b32_dpp v3, v11, v11, vcc quad_perm:[1,0,3,2] row_mask:0xf bank_mask:0xf
    s_not_b64 vcc, vcc
    v_cndmask_b32_dpp v2, v10, v10, vcc quad_perm:[1,0,3,2] row_mask:0xf bank_mask:0xf
    v_cndmask_b32_dpp v4, v11, v11, vcc quad_perm:[1,0,3,2] row_mask:0xf bank_mask:0xf
    v_add_u32 v1, v1, v5
    v_add_u32 v2, v2, v5
    v_add_u32 v3, v3, v5
    v_add_u32 v4, v4, v5
    v_accvgpr_read_b32 v144, a160
    v_accvgpr_read_b32 v145, a161
    v_accvgpr_read_b32 v146, a162
    v_accvgpr_read_b32 v147, a163
    v_accvgpr_read_b32 v148, a164
    v_accvgpr_read_b32 v149, a165
    v_accvgpr_read_b32 v150, a166
    v_accvgpr_read_b32 v151, a167
    v_accvgpr_read_b32 v152, a168
    v_accvgpr_read_b32 v153, a169
    v_accvgpr_read_b32 v154, a170
    v_accvgpr_read_b32 v155, a171
    v_accvgpr_read_b32 v156, a172
    v_accvgpr_read_b32 v157, a173
    v_accvgpr_read_b32 v158, a174
    v_accvgpr_read_b32 v159, a175
    v_accvgpr_read_b32 v160, a176
    v_accvgpr_read_b32 v161, a177
    v_accvgpr_read_b32 v162, a178
    v_accvgpr_read_b32 v163, a179
    v_accvgpr_read_b32 v164, a180
    v_accvgpr_read_b32 v165, a181
    v_accvgpr_read_b32 v166, a182
    v_accvgpr_read_b32 v167, a183
    v_accvgpr_read_b32 v168, a184
    v_accvgpr_read_b32 v169, a185
    v_accvgpr_read_b32 v170, a186
    v_accvgpr_read_b32 v171, a187
    v_accvgpr_read_b32 v172, a188
    v_accvgpr_read_b32 v173, a189
    v_accvgpr_read_b32 v174, a190
    v_accvgpr_read_b32 v175, a191
    v_accvgpr_read_b32 v176, a192
    v_accvgpr_read_b32 v177, a193
    v_accvgpr_read_b32 v178, a194
    v_accvgpr_read_b32 v179, a195
    v_accvgpr_read_b32 v180, a196
    v_accvgpr_read_b32 v181, a197
    v_accvgpr_read_b32 v182, a198
    v_accvgpr_read_b32 v183, a199
    v_accvgpr_read_b32 v184, a200
    v_accvgpr_read_b32 v185, a201
    v_accvgpr_read_b32 v186, a202
    v_accvgpr_read_b32 v187, a203
    v_accvgpr_read_b32 v188, a204
    v_accvgpr_read_b32 v189, a205
    v_accvgpr_read_b32 v190, a206
    v_accvgpr_read_b32 v191, a207
    v_accvgpr_read_b32 v192, a208
    v_accvgpr_read_b32 v193, a209
    v_accvgpr_read_b32 v194, a210
    v_accvgpr_read_b32 v195, a211
    v_accvgpr_read_b32 v196, a212
    v_accvgpr_read_b32 v197, a213
    v_accvgpr_read_b32 v198, a214
    v_accvgpr_read_b32 v199, a215
    v_accvgpr_read_b32 v200, a216
    v_accvgpr_read_b32 v201, a217
    v_accvgpr_read_b32 v202, a218
    v_accvgpr_read_b32 v203, a219
    v_accvgpr_read_b32 v204, a220
    v_accvgpr_read_b32 v205, a221
    v_accvgpr_read_b32 v206, a222
    v_accvgpr_read_b32 v207, a223
    v_pk_mul_f32 v[208:209], v[16:17], s[46:47]
    v_pk_mul_f32 v[210:211], v[18:19], s[46:47]
    v_pk_mul_f32 v[212:213], v[20:21], s[46:47]
    v_pk_mul_f32 v[214:215], v[22:23], s[46:47]
    v_pk_mul_f32 v[216:217], v[24:25], s[46:47]
    v_pk_mul_f32 v[218:219], v[26:27], s[46:47]
    v_pk_mul_f32 v[220:221], v[28:29], s[46:47]
    v_pk_mul_f32 v[222:223], v[30:31], s[46:47]
    v_exp_f32 v208, v208
    v_exp_f32 v209, v209
    v_exp_f32 v210, v210
    v_exp_f32 v211, v211
    v_exp_f32 v212, v212
    v_exp_f32 v213, v213
    v_exp_f32 v214, v214
    v_exp_f32 v215, v215
    v_exp_f32 v216, v216
    v_exp_f32 v217, v217
    v_exp_f32 v218, v218
    v_exp_f32 v219, v219
    v_exp_f32 v220, v220
    v_exp_f32 v221, v221
    v_exp_f32 v222, v222
    v_exp_f32 v223, v223
    v_cvt_pk_bf16_f32 v240, v16, v17
    v_cvt_pk_bf16_f32 v241, v18, v19
    v_cvt_pk_bf16_f32 v242, v20, v21
    v_cvt_pk_bf16_f32 v243, v22, v23
    v_cvt_pk_bf16_f32 v244, v24, v25
    v_cvt_pk_bf16_f32 v245, v26, v27
    v_cvt_pk_bf16_f32 v246, v28, v29
    v_cvt_pk_bf16_f32 v247, v30, v31
    s_mov_b64 vcc, s[94:95]
    v_cndmask_b32_dpp v248, v244, v240, vcc quad_perm:[1,0,3,2] row_mask:0xf bank_mask:0xf
    v_cndmask_b32_dpp v249, v245, v241, vcc quad_perm:[1,0,3,2] row_mask:0xf bank_mask:0xf
    v_cndmask_b32_dpp v250, v246, v242, vcc quad_perm:[1,0,3,2] row_mask:0xf bank_mask:0xf
    v_cndmask_b32_dpp v251, v247, v243, vcc quad_perm:[1,0,3,2] row_mask:0xf bank_mask:0xf
    s_not_b64 vcc, vcc
    buffer_store_dwordx4 v[248:251], v1, s[12:15], 0 offen offset:0 sc0 sc1
    v_cndmask_b32_dpp v252, v240, v244, vcc quad_perm:[1,0,3,2] row_mask:0xf bank_mask:0xf
    v_cndmask_b32_dpp v253, v241, v245, vcc quad_perm:[1,0,3,2] row_mask:0xf bank_mask:0xf
    v_cndmask_b32_dpp v254, v242, v246, vcc quad_perm:[1,0,3,2] row_mask:0xf bank_mask:0xf
    v_cndmask_b32_dpp v255, v243, v247, vcc quad_perm:[1,0,3,2] row_mask:0xf bank_mask:0xf
    buffer_store_dwordx4 v[252:255], v2, s[12:15], 0 offen offset:0 sc0 sc1
    v_pk_add_f32 v[208:209], v[208:209], 1.0 op_sel_hi:[1,0]
    v_pk_add_f32 v[210:211], v[210:211], 1.0 op_sel_hi:[1,0]
    v_pk_add_f32 v[212:213], v[212:213], 1.0 op_sel_hi:[1,0]
    v_pk_add_f32 v[214:215], v[214:215], 1.0 op_sel_hi:[1,0]
    v_pk_add_f32 v[216:217], v[216:217], 1.0 op_sel_hi:[1,0]
    v_pk_add_f32 v[218:219], v[218:219], 1.0 op_sel_hi:[1,0]
    v_pk_add_f32 v[220:221], v[220:221], 1.0 op_sel_hi:[1,0]
    v_pk_add_f32 v[222:223], v[222:223], 1.0 op_sel_hi:[1,0]
    v_rcp_f32 v208, v208
    v_rcp_f32 v209, v209
    v_rcp_f32 v210, v210
    v_rcp_f32 v211, v211
    v_rcp_f32 v212, v212
    v_rcp_f32 v213, v213
    v_rcp_f32 v214, v214
    v_rcp_f32 v215, v215
    v_rcp_f32 v216, v216
    v_rcp_f32 v217, v217
    v_rcp_f32 v218, v218
    v_rcp_f32 v219, v219
    v_rcp_f32 v220, v220
    v_rcp_f32 v221, v221
    v_rcp_f32 v222, v222
    v_rcp_f32 v223, v223
    v_pk_mul_f32 v[32:33], v[32:33], v[208:209]
    v_pk_mul_f32 v[34:35], v[34:35], v[210:211]
    v_pk_mul_f32 v[36:37], v[36:37], v[212:213]
    v_pk_mul_f32 v[38:39], v[38:39], v[214:215]
    v_pk_mul_f32 v[40:41], v[40:41], v[216:217]
    v_pk_mul_f32 v[42:43], v[42:43], v[218:219]
    v_pk_mul_f32 v[44:45], v[44:45], v[220:221]
    v_pk_mul_f32 v[46:47], v[46:47], v[222:223]
    v_cvt_pk_bf16_f32 v240, v32, v33
    v_cvt_pk_bf16_f32 v241, v34, v35
    v_cvt_pk_bf16_f32 v242, v36, v37
    v_cvt_pk_bf16_f32 v243, v38, v39
    v_cvt_pk_bf16_f32 v244, v40, v41
    v_cvt_pk_bf16_f32 v245, v42, v43
    v_cvt_pk_bf16_f32 v246, v44, v45
    v_cvt_pk_bf16_f32 v247, v46, v47
    s_mov_b64 vcc, s[94:95]
    v_cndmask_b32_dpp v248, v244, v240, vcc quad_perm:[1,0,3,2] row_mask:0xf bank_mask:0xf
    v_cndmask_b32_dpp v249, v245, v241, vcc quad_perm:[1,0,3,2] row_mask:0xf bank_mask:0xf
    s_nop 0
    v_cndmask_b32_dpp v250, v246, v242, vcc quad_perm:[1,0,3,2] row_mask:0xf bank_mask:0xf
    v_cndmask_b32_dpp v251, v247, v243, vcc quad_perm:[1,0,3,2] row_mask:0xf bank_mask:0xf
    s_not_b64 vcc, vcc
    buffer_store_dwordx4 v[248:251], v1, s[12:15], 0 offen offset:128 sc0 sc1
    v_cndmask_b32_dpp v252, v240, v244, vcc quad_perm:[1,0,3,2] row_mask:0xf bank_mask:0xf
    v_cndmask_b32_dpp v253, v241, v245, vcc quad_perm:[1,0,3,2] row_mask:0xf bank_mask:0xf
    v_cndmask_b32_dpp v254, v242, v246, vcc quad_perm:[1,0,3,2] row_mask:0xf bank_mask:0xf
    v_cndmask_b32_dpp v255, v243, v247, vcc quad_perm:[1,0,3,2] row_mask:0xf bank_mask:0xf
    s_nop 0
    buffer_store_dwordx4 v[252:255], v2, s[12:15], 0 offen offset:128 sc0 sc1
    v_pk_mul_f32 v[48:49], v[48:49], v[208:209]
    v_pk_mul_f32 v[50:51], v[50:51], v[210:211]
    v_pk_mul_f32 v[52:53], v[52:53], v[212:213]
    v_pk_mul_f32 v[54:55], v[54:55], v[214:215]
    v_pk_mul_f32 v[56:57], v[56:57], v[216:217]
    v_pk_mul_f32 v[58:59], v[58:59], v[218:219]
    v_pk_mul_f32 v[60:61], v[60:61], v[220:221]
    v_pk_mul_f32 v[62:63], v[62:63], v[222:223]
    v_cvt_pk_bf16_f32 v240, v48, v49
    v_cvt_pk_bf16_f32 v241, v50, v51
    v_cvt_pk_bf16_f32 v242, v52, v53
    v_cvt_pk_bf16_f32 v243, v54, v55
    v_cvt_pk_bf16_f32 v244, v56, v57
    v_cvt_pk_bf16_f32 v245, v58, v59
    v_cvt_pk_bf16_f32 v246, v60, v61
    v_cvt_pk_bf16_f32 v247, v62, v63
    s_mov_b64 vcc, s[94:95]
    v_cndmask_b32_dpp v248, v244, v240, vcc quad_perm:[1,0,3,2] row_mask:0xf bank_mask:0xf
    v_cndmask_b32_dpp v249, v245, v241, vcc quad_perm:[1,0,3,2] row_mask:0xf bank_mask:0xf
    v_cndmask_b32_dpp v250, v246, v242, vcc quad_perm:[1,0,3,2] row_mask:0xf bank_mask:0xf
    v_cndmask_b32_dpp v251, v247, v243, vcc quad_perm:[1,0,3,2] row_mask:0xf bank_mask:0xf
    s_not_b64 vcc, vcc
    buffer_store_dwordx4 v[248:251], v1, s[12:15], 0 offen offset:256 sc0 sc1
    v_cndmask_b32_dpp v252, v240, v244, vcc quad_perm:[1,0,3,2] row_mask:0xf bank_mask:0xf
    v_cndmask_b32_dpp v253, v241, v245, vcc quad_perm:[1,0,3,2] row_mask:0xf bank_mask:0xf
    v_cndmask_b32_dpp v254, v242, v246, vcc quad_perm:[1,0,3,2] row_mask:0xf bank_mask:0xf
    v_cndmask_b32_dpp v255, v243, v247, vcc quad_perm:[1,0,3,2] row_mask:0xf bank_mask:0xf
    buffer_store_dwordx4 v[252:255], v2, s[12:15], 0 offen offset:256 sc0 sc1
    v_pk_mul_f32 v[64:65], v[64:65], v[208:209]
    v_pk_mul_f32 v[66:67], v[66:67], v[210:211]
    v_pk_mul_f32 v[68:69], v[68:69], v[212:213]
    v_pk_mul_f32 v[70:71], v[70:71], v[214:215]
    v_pk_mul_f32 v[72:73], v[72:73], v[216:217]
    v_pk_mul_f32 v[74:75], v[74:75], v[218:219]
    v_pk_mul_f32 v[76:77], v[76:77], v[220:221]
    v_pk_mul_f32 v[78:79], v[78:79], v[222:223]
    v_cvt_pk_bf16_f32 v240, v64, v65
    v_cvt_pk_bf16_f32 v241, v66, v67
    v_cvt_pk_bf16_f32 v242, v68, v69
    v_cvt_pk_bf16_f32 v243, v70, v71
    v_cvt_pk_bf16_f32 v244, v72, v73
    v_cvt_pk_bf16_f32 v245, v74, v75
    v_cvt_pk_bf16_f32 v246, v76, v77
    v_cvt_pk_bf16_f32 v247, v78, v79
    s_mov_b64 vcc, s[94:95]
    v_cndmask_b32_dpp v248, v244, v240, vcc quad_perm:[1,0,3,2] row_mask:0xf bank_mask:0xf
    v_cndmask_b32_dpp v249, v245, v241, vcc quad_perm:[1,0,3,2] row_mask:0xf bank_mask:0xf
    v_cndmask_b32_dpp v250, v246, v242, vcc quad_perm:[1,0,3,2] row_mask:0xf bank_mask:0xf
    v_cndmask_b32_dpp v251, v247, v243, vcc quad_perm:[1,0,3,2] row_mask:0xf bank_mask:0xf
    s_not_b64 vcc, vcc
    buffer_store_dwordx4 v[248:251], v1, s[12:15], 0 offen offset:384 sc0 sc1
    v_cndmask_b32_dpp v252, v240, v244, vcc quad_perm:[1,0,3,2] row_mask:0xf bank_mask:0xf
    v_cndmask_b32_dpp v253, v241, v245, vcc quad_perm:[1,0,3,2] row_mask:0xf bank_mask:0xf
    v_cndmask_b32_dpp v254, v242, v246, vcc quad_perm:[1,0,3,2] row_mask:0xf bank_mask:0xf
    v_cndmask_b32_dpp v255, v243, v247, vcc quad_perm:[1,0,3,2] row_mask:0xf bank_mask:0xf
    buffer_store_dwordx4 v[252:255], v2, s[12:15], 0 offen offset:384 sc0 sc1
    v_pk_mul_f32 v[208:209], v[144:145], s[46:47]
    v_pk_mul_f32 v[210:211], v[146:147], s[46:47]
    v_pk_mul_f32 v[212:213], v[148:149], s[46:47]
    v_pk_mul_f32 v[214:215], v[150:151], s[46:47]
    v_pk_mul_f32 v[216:217], v[152:153], s[46:47]
    v_pk_mul_f32 v[218:219], v[154:155], s[46:47]
    v_pk_mul_f32 v[220:221], v[156:157], s[46:47]
    v_pk_mul_f32 v[222:223], v[158:159], s[46:47]
    v_exp_f32 v208, v208
    v_exp_f32 v209, v209
    v_exp_f32 v210, v210
    v_exp_f32 v211, v211
    v_exp_f32 v212, v212
    v_exp_f32 v213, v213
    v_exp_f32 v214, v214
    v_exp_f32 v215, v215
    v_exp_f32 v216, v216
    v_exp_f32 v217, v217
    v_exp_f32 v218, v218
    v_exp_f32 v219, v219
    v_exp_f32_e64 v220, v220
    v_exp_f32_e64 v221, v221
    v_exp_f32_e64 v222, v222
    v_exp_f32_e64 v223, v223
    v_cvt_pk_bf16_f32 v240, v144, v145
    v_cvt_pk_bf16_f32 v241, v146, v147
    v_cvt_pk_bf16_f32 v242, v148, v149
    v_cvt_pk_bf16_f32 v243, v150, v151
    v_cvt_pk_bf16_f32 v244, v152, v153
    v_cvt_pk_bf16_f32 v245, v154, v155
    v_cvt_pk_bf16_f32 v246, v156, v157
    v_cvt_pk_bf16_f32 v247, v158, v159
    s_mov_b64 vcc, s[94:95]
    v_cndmask_b32_dpp v248, v244, v240, vcc quad_perm:[1,0,3,2] row_mask:0xf bank_mask:0xf
    v_cndmask_b32_dpp v249, v245, v241, vcc quad_perm:[1,0,3,2] row_mask:0xf bank_mask:0xf
    v_cndmask_b32_dpp v250, v246, v242, vcc quad_perm:[1,0,3,2] row_mask:0xf bank_mask:0xf
    v_cndmask_b32_dpp v251, v247, v243, vcc quad_perm:[1,0,3,2] row_mask:0xf bank_mask:0xf
    s_not_b64 vcc, vcc
    buffer_store_dwordx4 v[248:251], v3, s[12:15], 0 offen offset:0 sc0 sc1
    v_cndmask_b32_dpp v252, v240, v244, vcc quad_perm:[1,0,3,2] row_mask:0xf bank_mask:0xf
    v_cndmask_b32_dpp v253, v241, v245, vcc quad_perm:[1,0,3,2] row_mask:0xf bank_mask:0xf
    v_cndmask_b32_dpp v254, v242, v246, vcc quad_perm:[1,0,3,2] row_mask:0xf bank_mask:0xf
    v_cndmask_b32_dpp v255, v243, v247, vcc quad_perm:[1,0,3,2] row_mask:0xf bank_mask:0xf
    buffer_store_dwordx4 v[252:255], v4, s[12:15], 0 offen offset:0 sc0 sc1
    v_pk_add_f32 v[208:209], v[208:209], 1.0 op_sel_hi:[1,0]
    v_pk_add_f32 v[210:211], v[210:211], 1.0 op_sel_hi:[1,0]
    v_pk_add_f32 v[212:213], v[212:213], 1.0 op_sel_hi:[1,0]
    v_pk_add_f32 v[214:215], v[214:215], 1.0 op_sel_hi:[1,0]
    v_pk_add_f32 v[216:217], v[216:217], 1.0 op_sel_hi:[1,0]
    v_pk_add_f32 v[218:219], v[218:219], 1.0 op_sel_hi:[1,0]
    v_pk_add_f32 v[220:221], v[220:221], 1.0 op_sel_hi:[1,0]
    v_pk_add_f32 v[222:223], v[222:223], 1.0 op_sel_hi:[1,0]
    v_rcp_f32 v208, v208
    v_rcp_f32 v209, v209
    v_rcp_f32 v210, v210
    v_rcp_f32 v211, v211
    v_rcp_f32 v212, v212
    v_rcp_f32 v213, v213
    v_rcp_f32 v214, v214
    v_rcp_f32 v215, v215
    v_rcp_f32 v216, v216
    v_rcp_f32 v217, v217
    v_rcp_f32 v218, v218
    v_rcp_f32 v219, v219
    v_rcp_f32 v220, v220
    v_rcp_f32 v221, v221
    v_rcp_f32 v222, v222
    v_rcp_f32 v223, v223
    v_pk_mul_f32 v[160:161], v[160:161], v[208:209]
    v_pk_mul_f32 v[162:163], v[162:163], v[210:211]
    v_pk_mul_f32 v[164:165], v[164:165], v[212:213]
    v_pk_mul_f32 v[166:167], v[166:167], v[214:215]
    v_pk_mul_f32 v[168:169], v[168:169], v[216:217]
    v_pk_mul_f32 v[170:171], v[170:171], v[218:219]
    v_pk_mul_f32 v[172:173], v[172:173], v[220:221]
    v_pk_mul_f32 v[174:175], v[174:175], v[222:223]
    v_cvt_pk_bf16_f32 v240, v160, v161
    v_cvt_pk_bf16_f32 v241, v162, v163
    v_cvt_pk_bf16_f32 v242, v164, v165
    v_cvt_pk_bf16_f32 v243, v166, v167
    v_cvt_pk_bf16_f32 v244, v168, v169
    v_cvt_pk_bf16_f32 v245, v170, v171
    v_cvt_pk_bf16_f32 v246, v172, v173
    v_cvt_pk_bf16_f32 v247, v174, v175
    s_mov_b64 vcc, s[94:95]
    v_cndmask_b32_dpp v248, v244, v240, vcc quad_perm:[1,0,3,2] row_mask:0xf bank_mask:0xf
    v_cndmask_b32_dpp v249, v245, v241, vcc quad_perm:[1,0,3,2] row_mask:0xf bank_mask:0xf
    v_cndmask_b32_dpp v250, v246, v242, vcc quad_perm:[1,0,3,2] row_mask:0xf bank_mask:0xf
    v_cndmask_b32_dpp v251, v247, v243, vcc quad_perm:[1,0,3,2] row_mask:0xf bank_mask:0xf
    s_not_b64 vcc, vcc
    buffer_store_dwordx4 v[248:251], v3, s[12:15], 0 offen offset:128 sc0 sc1
    v_cndmask_b32_dpp v252, v240, v244, vcc quad_perm:[1,0,3,2] row_mask:0xf bank_mask:0xf
    v_cndmask_b32_dpp v253, v241, v245, vcc quad_perm:[1,0,3,2] row_mask:0xf bank_mask:0xf
    v_cndmask_b32_dpp v254, v242, v246, vcc quad_perm:[1,0,3,2] row_mask:0xf bank_mask:0xf
    v_cndmask_b32_dpp v255, v243, v247, vcc quad_perm:[1,0,3,2] row_mask:0xf bank_mask:0xf
    buffer_store_dwordx4 v[252:255], v4, s[12:15], 0 offen offset:128 sc0 sc1
    v_pk_mul_f32 v[176:177], v[176:177], v[208:209]
    v_pk_mul_f32 v[178:179], v[178:179], v[210:211]
    v_pk_mul_f32 v[180:181], v[180:181], v[212:213]
    v_pk_mul_f32 v[182:183], v[182:183], v[214:215]
    v_pk_mul_f32 v[184:185], v[184:185], v[216:217]
    v_pk_mul_f32 v[186:187], v[186:187], v[218:219]
    v_pk_mul_f32 v[188:189], v[188:189], v[220:221]
    v_pk_mul_f32 v[190:191], v[190:191], v[222:223]
    v_cvt_pk_bf16_f32 v240, v176, v177
    v_cvt_pk_bf16_f32 v241, v178, v179
    v_cvt_pk_bf16_f32 v242, v180, v181
    v_cvt_pk_bf16_f32 v243, v182, v183
    v_cvt_pk_bf16_f32 v244, v184, v185
    v_cvt_pk_bf16_f32 v245, v186, v187
    v_cvt_pk_bf16_f32 v246, v188, v189
    v_cvt_pk_bf16_f32 v247, v190, v191
    s_mov_b64 vcc, s[94:95]
    s_nop 0
    v_cndmask_b32_dpp v248, v244, v240, vcc quad_perm:[1,0,3,2] row_mask:0xf bank_mask:0xf
    v_cndmask_b32_dpp v249, v245, v241, vcc quad_perm:[1,0,3,2] row_mask:0xf bank_mask:0xf
    v_cndmask_b32_dpp v250, v246, v242, vcc quad_perm:[1,0,3,2] row_mask:0xf bank_mask:0xf
    v_cndmask_b32_dpp v251, v247, v243, vcc quad_perm:[1,0,3,2] row_mask:0xf bank_mask:0xf
    s_not_b64 vcc, vcc
    buffer_store_dwordx4 v[248:251], v3, s[12:15], 0 offen offset:256 sc0 sc1
    v_cndmask_b32_dpp v252, v240, v244, vcc quad_perm:[1,0,3,2] row_mask:0xf bank_mask:0xf
    v_cndmask_b32_dpp v253, v241, v245, vcc quad_perm:[1,0,3,2] row_mask:0xf bank_mask:0xf
    s_nop 0
    v_cndmask_b32_dpp v254, v242, v246, vcc quad_perm:[1,0,3,2] row_mask:0xf bank_mask:0xf
    v_cndmask_b32_dpp v255, v243, v247, vcc quad_perm:[1,0,3,2] row_mask:0xf bank_mask:0xf
    buffer_store_dwordx4 v[252:255], v4, s[12:15], 0 offen offset:256 sc0 sc1
    v_pk_mul_f32 v[192:193], v[192:193], v[208:209]
    v_pk_mul_f32 v[194:195], v[194:195], v[210:211]
    v_pk_mul_f32 v[196:197], v[196:197], v[212:213]
    v_pk_mul_f32 v[198:199], v[198:199], v[214:215]
    v_pk_mul_f32 v[200:201], v[200:201], v[216:217]
    v_pk_mul_f32 v[202:203], v[202:203], v[218:219]
    v_pk_mul_f32 v[204:205], v[204:205], v[220:221]
    v_pk_mul_f32 v[206:207], v[206:207], v[222:223]
    v_cvt_pk_bf16_f32 v240, v192, v193
    v_cvt_pk_bf16_f32 v241, v194, v195
    v_cvt_pk_bf16_f32 v242, v196, v197
    v_cvt_pk_bf16_f32 v243, v198, v199
    v_cvt_pk_bf16_f32 v244, v200, v201
    v_cvt_pk_bf16_f32 v245, v202, v203
    v_cvt_pk_bf16_f32 v246, v204, v205
    v_cvt_pk_bf16_f32 v247, v206, v207
    s_mov_b64 vcc, s[94:95]
    v_cndmask_b32_dpp v248, v244, v240, vcc quad_perm:[1,0,3,2] row_mask:0xf bank_mask:0xf
    v_cndmask_b32_dpp v249, v245, v241, vcc quad_perm:[1,0,3,2] row_mask:0xf bank_mask:0xf
    v_cndmask_b32_dpp v250, v246, v242, vcc quad_perm:[1,0,3,2] row_mask:0xf bank_mask:0xf
    v_cndmask_b32_dpp v251, v247, v243, vcc quad_perm:[1,0,3,2] row_mask:0xf bank_mask:0xf
    s_not_b64 vcc, vcc
    buffer_store_dwordx4 v[248:251], v3, s[12:15], 0 offen offset:384 sc0 sc1
    v_cndmask_b32_dpp v252, v240, v244, vcc quad_perm:[1,0,3,2] row_mask:0xf bank_mask:0xf
    v_cndmask_b32_dpp v253, v241, v245, vcc quad_perm:[1,0,3,2] row_mask:0xf bank_mask:0xf
    v_cndmask_b32_dpp v254, v242, v246, vcc quad_perm:[1,0,3,2] row_mask:0xf bank_mask:0xf
    v_cndmask_b32_dpp v255, v243, v247, vcc quad_perm:[1,0,3,2] row_mask:0xf bank_mask:0xf
    buffer_store_dwordx4 v[252:255], v4, s[12:15], 0 offen offset:384 sc0 sc1
K2_fin:
    s_or_b32 s43, s2, s18
    s_cmp_lg_u32 s43, 0
    s_cbranch_scc1 K2_noepoch
    v_mov_b32 v90, 656384
    v_mov_b32 v91, s3
    global_store_dword v90, v91, s[16:17] sc0 sc1
K2_noepoch:
K2_end:
    s_endpgm
K2_wwait:
    global_load_dword v97, v96, s[16:17] sc1
    s_add_u32 s43, s43, 1
    s_cmp_gt_u32 s43, 8000000
    s_cbranch_scc1 K2_end
    s_waitcnt vmcnt(0)
    s_branch K2_wchk
    s_nop 0
K2_nochunks:
    v_and_b32 v84, 3, v15
    v_lshlrev_b32 v85, 2, v84
    ds_bpermute_b32 v82, v85, v86
    v_add_u32 v85, 16, v85
    ds_bpermute_b32 v83, v85, v86
    v_cmp_gt_u32 vcc, 3, v84
    v_bfe_u32 v84, v15, 2, 2
    v_lshrrev_b32 v85, 4, v15
    v_lshlrev_b32 v85, 4, v85
    s_mul_i32 s43, s27, 98
    s_movk_i32 s53, 98
    v_mov_b32 v88, 0x80000000
    s_waitcnt lgkmcnt(0)
    v_cndmask_b32 v83, 0, v83, vcc
    v_and_b32 v89, 31, v82
    v_and_b32 v90, 31, v83
    v_lshl_add_u32 v89, v89, 2, v84
    v_lshl_add_u32 v90, v90, 2, v84
    v_cmp_gt_u32 vcc, s53, v89
    v_cmp_gt_u32 s[58:59], s53, v90
    v_add_u32 v89, s43, v89
    v_add_u32 v90, s43, v90
    v_lshl_add_u32 v89, v89, 9, v85
    v_lshl_add_u32 v90, v90, 9, v85
    v_and_b32 v82, 0x80, v82
    v_and_b32 v83, 0x80, v83
    v_cndmask_b32 v89, v88, v89, vcc
    v_cndmask_b32 v90, v88, v90, s[58:59]
    v_cmp_ne_u32 vcc, 0, v82
    v_cmp_ne_u32 s[58:59], 0, v83
    s_nop 1
    v_cndmask_b32 v10, v88, v89, vcc
    v_cndmask_b32 v11, v88, v90, s[58:59]
    s_branch K2_pass_end
    s_nop 0
K2_pb_8:
    s_add_u32 s31, s31, 1
    s_cmp_eq_u32 s31, 4
    s_cselect_b32 s43, 0x40000000, 128
    s_add_u32 s22, s22, s43
    s_add_u32 s23, s23, s43
    s_add_u32 s24, s24, s43
    s_add_u32 s25, s25, s43
    s_branch K2_pb_8_ret
K2_pb_9:
    s_add_u32 s31, s31, 1
    s_cmp_eq_u32 s31, 4
    s_cselect_b32 s43, 0x40000000, 128
    s_add_u32 s22, s22, s43
    s_add_u32 s23, s23, s43
    s_add_u32 s24, s24, s43
    s_add_u32 s25, s25, s43
    s_branch K2_pb_9_ret
K2_pb_10:
    s_add_u32 s31, s31, 1
    s_cmp_eq_u32 s31, 4
    s_cselect_b32 s43, 0x40000000, 128
    s_add_u32 s22, s22, s43
    s_add_u32 s23, s23, s43
    s_add_u32 s24, s24, s43
    s_add_u32 s25, s25, s43
    s_branch K2_pb_10_ret
K2_pb_11:
    s_add_u32 s31, s31, 1
    s_cmp_eq_u32 s31, 4
    s_cselect_b32 s43, 0x40000000, 128
    s_add_u32 s22, s22, s43
    s_add_u32 s23, s23, s43
    s_add_u32 s24, s24, s43
    s_add_u32 s25, s25, s43
    s_branch K2_pb_11_ret
K2_wrap_12:
    s_bitset0_b32 s45, 31
    s_add_u32 s31, s31, 1
    s_cmp_eq_u32 s31, 4
    s_cselect_b32 s43, 0x40000000, 128
    s_add_u32 s22, s22, s43
    s_add_u32 s23, s23, s43
    s_add_u32 s24, s24, s43
    s_add_u32 s25, s25, s43
    s_branch K2_wrap_12_ret
    s_nop 0
K2_wrap_13:
    s_bitset0_b32 s45, 31
    s_add_u32 s31, s31, 1
    s_cmp_eq_u32 s31, 4
    s_cselect_b32 s43, 0x40000000, 128
    s_add_u32 s22, s22, s43
    s_add_u32 s23, s23, s43
    s_add_u32 s24, s24, s43
    s_add_u32 s25, s25, s43
    s_branch K2_wrap_13_ret
K2_wrap_14:
    s_bitset0_b32 s45, 31
    s_add_u32 s31, s31, 1
    s_cmp_eq_u32 s31, 4
    s_cselect_b32 s43, 0x40000000, 128
    s_add_u32 s22, s22, s43
    s_add_u32 s23, s23, s43
    s_add_u32 s24, s24, s43
    s_add_u32 s25, s25, s43
    s_branch K2_wrap_14_ret
K2_wrap_15:
    s_bitset0_b32 s45, 31
    s_add_u32 s31, s31, 1
    s_cmp_eq_u32 s31, 4
    s_cselect_b32 s43, 0x40000000, 128
    s_add_u32 s22, s22, s43
    s_add_u32 s23, s23, s43
    s_add_u32 s24, s24, s43
    s_add_u32 s25, s25, s43
    s_branch K2_wrap_15_ret
K2_wrap_16:
    s_bitset0_b32 s45, 31
    s_add_u32 s31, s31, 1
    s_cmp_eq_u32 s31, 4
    s_cselect_b32 s43, 0x40000000, 128
    s_add_u32 s22, s22, s43
    s_add_u32 s23, s23, s43
    s_add_u32 s24, s24, s43
    s_add_u32 s25, s25, s43
    s_branch K2_wrap_16_ret
K2_wrap_17:
    s_bitset0_b32 s45, 31
    s_add_u32 s31, s31, 1
    s_cmp_eq_u32 s31, 4
    s_cselect_b32 s43, 0x40000000, 128
    s_add_u32 s22, s22, s43
    s_add_u32 s23, s23, s43
    s_add_u32 s24, s24, s43
    s_add_u32 s25, s25, s43
    s_branch K2_wrap_17_ret
K2_wrap_19:
    s_bitset0_b32 s45, 31
    s_add_u32 s31, s31, 1
    s_cmp_eq_u32 s31, 4
    s_cselect_b32 s43, 0x40000000, 128
    s_add_u32 s22, s22, s43
    s_add_u32 s23, s23, s43
    s_add_u32 s24, s24, s43
    s_add_u32 s25, s25, s43
    s_branch K2_wrap_19_ret
K2_wrap_21:
    s_bitset0_b32 s45, 31
    s_add_u32 s31, s31, 1
    s_cmp_eq_u32 s31, 4
    s_cselect_b32 s43, 0x40000000, 128
    s_add_u32 s22, s22, s43
    s_add_u32 s23, s23, s43
    s_add_u32 s24, s24, s43
    s_add_u32 s25, s25, s43
    s_branch K2_wrap_21_ret
K2_wrap_23:
    s_bitset0_b32 s45, 31
    s_add_u32 s31, s31, 1
    s_cmp_eq_u32 s31, 4
    s_cselect_b32 s43, 0x40000000, 128
    s_add_u32 s22, s22, s43
    s_add_u32 s23, s23, s43
    s_add_u32 s24, s24, s43
    s_add_u32 s25, s25, s43
    s_branch K2_wrap_23_ret
K2_wrap_25:
    s_bitset0_b32 s45, 31
    s_add_u32 s31, s31, 1
    s_cmp_eq_u32 s31, 4
    s_cselect_b32 s43, 0x40000000, 128
    s_add_u32 s22, s22, s43
    s_add_u32 s23, s23, s43
    s_add_u32 s24, s24, s43
    s_add_u32 s25, s25, s43
    s_branch K2_wrap_25_ret
K2_wrap_27:
    s_bitset0_b32 s45, 31
    s_add_u32 s31, s31, 1
    s_cmp_eq_u32 s31, 4
    s_cselect_b32 s43, 0x40000000, 128
    s_add_u32 s22, s22, s43
    s_add_u32 s23, s23, s43
    s_add_u32 s24, s24, s43
    s_add_u32 s25, s25, s43
    s_branch K2_wrap_27_ret
K2_wrap_29:
    s_bitset0_b32 s45, 31
    s_add_u32 s31, s31, 1
    s_cmp_eq_u32 s31, 4
    s_cselect_b32 s43, 0x40000000, 128
    s_add_u32 s22, s22, s43
    s_add_u32 s23, s23, s43
    s_add_u32 s24, s24, s43
    s_add_u32 s25, s25, s43
    s_branch K2_wrap_29_ret
K2_wrap_31:
    s_bitset0_b32 s45, 31
    s_add_u32 s31, s31, 1
    s_cmp_eq_u32 s31, 4
    s_cselect_b32 s43, 0x40000000, 128
    s_add_u32 s22, s22, s43
    s_add_u32 s23, s23, s43
    s_add_u32 s24, s24, s43
    s_add_u32 s25, s25, s43
    s_branch K2_wrap_31_ret
K2_wrap_32:
    s_bitset0_b32 s45, 31
    s_add_u32 s31, s31, 1
    s_cmp_eq_u32 s31, 4
    s_cselect_b32 s43, 0x40000000, 128
    s_add_u32 s22, s22, s43
    s_add_u32 s23, s23, s43
    s_add_u32 s24, s24, s43
    s_add_u32 s25, s25, s43
    s_branch K2_wrap_32_ret
K2_fast6:
    s_waitcnt vmcnt(12)
    v_mfma_f32_16x16x32_bf16 v[240:243], v[80:83], v[96:99], v[240:243]
    v_add_u32_sdwa v13, s45, v2 dst_sel:DWORD dst_unused:UNUSED_PAD src0_sel:WORD_0 src1_sel:DWORD
    ds_read_b64_tr_b16 v[80:81], v108
    ds_read_b64_tr_b16 v[82:83], v108 offset:1024
    ds_read_b64 v[104:105], v12
    ds_read_b128 v[100:103], v13
    v_mfma_f32_16x16x32_bf16 v[244:247], v[84:87], v[96:99], v[244:247]
    ds_read_b64_tr_b16 v[84:85], v109
    ds_read_b64_tr_b16 v[86:87], v109 offset:1024
    v_mfma_f32_16x16x32_bf16 v[248:251], v[88:91], v[96:99], v[248:251]
    ds_read_b64_tr_b16 v[88:89], v108 offset:512
    ds_read_b64_tr_b16 v[90:91], v108 offset:1536
    v_mfma_f32_16x16x32_bf16 v[252:255], v[92:95], v[96:99], v[252:255]
    ds_read_b64_tr_b16 v[92:93], v109 offset:512
    ds_read_b64_tr_b16 v[94:95], v109 offset:1536
    ds_read_b64_tr_b16 v[96:97], v106
    ds_read_b64_tr_b16 v[98:99], v107 offset:8
    s_add_u32 m0, s19, s20
    s_add_u32 s20, s20, 4096
    s_and_b32 s20, s20, 16383
    s_cmp_lt_i32 s45, 0
    v_add_u32 v108, s20, v8
    v_add_u32 v109, s20, v9
    s_cbranch_scc1 K2_wrap_32
K2_wrap_32_ret:
    s_waitcnt lgkmcnt(8)
    v_cmp_eq_u32_sdwa vcc, v104, v5 src0_sel:BYTE_0 src1_sel:DWORD
    v_cmp_eq_u32_sdwa s[46:47], v105, v5 src0_sel:BYTE_0 src1_sel:DWORD
    v_mad_u32_u16 v100, v100, s21, v1 op_sel:[1,0,0,0]
    v_mad_u32_u16 v101, v101, s21, v1 op_sel:[1,0,0,0]
    v_cndmask_b32 v106, v4, v7, vcc
    v_cndmask_b32 v107, v4, v7, s[46:47]
    v_mad_u32_u16 v102, v102, s21, v1 op_sel:[1,0,0,0]
    v_mad_u32_u16 v103, v103, s21, v1 op_sel:[1,0,0,0]
    v_add_u32_sdwa v12, s45, v3 dst_sel:DWORD dst_unused:UNUSED_PAD src0_sel:WORD_1 src1_sel:DWORD
    v_lshl_add_u32 v7, v12, 1, s100
    s_add_u32 s26, s26, 1
    s_waitcnt lgkmcnt(0)
    buffer_load_dwordx4 v100, s[4:7], s22 offen lds
    v_readlane_b32 s45, v6, s26
    buffer_load_dwordx4 v101, s[4:7], s23 offen offset:1024 lds
    buffer_load_dwordx4 v102, s[4:7], s24 offen offset:2048 lds
    buffer_load_dwordx4 v103, s[4:7], s25 offen offset:3072 lds
    s_branch K2_fast6_ret
    s_nop 0
K2_wrap_34:
    s_bitset0_b32 s45, 31
    s_add_u32 s31, s31, 1
    s_cmp_eq_u32 s31, 4
    s_cselect_b32 s43, 0x40000000, 128
    s_add_u32 s22, s22, s43
    s_add_u32 s23, s23, s43
    s_add_u32 s24, s24, s43
    s_add_u32 s25, s25, s43
    s_branch K2_wrap_34_ret
    s_nop 0
K2_z_33:
    v_mfma_f32_16x16x32_bf16 v[16:19], a[0:3], v[112:115], v[16:19]
    v_mfma_f32_16x16x32_bf16 v[20:23], a[4:7], v[112:115], v[20:23]
    v_mfma_f32_16x16x32_bf16 v[24:27], a[8:11], v[112:115], v[24:27]
    v_mfma_f32_16x16x32_bf16 v[28:31], a[12:15], v[112:115], v[28:31]
    v_mfma_f32_16x16x32_bf16 v[16:19], a[16:19], v[116:119], v[16:19]
    v_mfma_f32_16x16x32_bf16 v[20:23], a[20:23], v[116:119], v[20:23]
    v_mfma_f32_16x16x32_bf16 v[24:27], a[24:27], v[116:119], v[24:27]
    v_mfma_f32_16x16x32_bf16 v[28:31], a[28:31], v[116:119], v[28:31]
    v_mov_b32 v144, 0
    v_mov_b32 v145, 0
    v_mov_b32 v146, 0
    v_mov_b32 v147, 0
    v_mov_b32 v148, 0
    v_mov_b32 v149, 0
    v_mov_b32 v150, 0
    v_mov_b32 v151, 0
    v_mov_b32 v152, 0
    v_mov_b32 v153, 0
    v_mov_b32 v154, 0
    v_mov_b32 v155, 0
    v_mov_b32 v156, 0
    v_mov_b32 v157, 0
    v_mov_b32 v158, 0
    v_mov_b32 v159, 0
    s_branch K2_z_33_ret
K2_wrap_36:
    s_bitset0_b32 s45, 31
    s_add_u32 s31, s31, 1
    s_cmp_eq_u32 s31, 4
    s_cselect_b32 s43, 0x40000000, 128
    s_add_u32 s22, s22, s43
    s_add_u32 s23, s23, s43
    s_add_u32 s24, s24, s43
    s_add_u32 s25, s25, s43
    s_branch K2_wrap_36_ret
    s_nop 0
K2_z_35:
    v_mfma_f32_16x16x32_bf16 v[32:35], a[64:67], v[120:123], v[32:35]
    v_mfma_f32_16x16x32_bf16 v[36:39], a[68:71], v[120:123], v[36:39]
    v_mfma_f32_16x16x32_bf16 v[40:43], a[72:75], v[120:123], v[40:43]
    v_mfma_f32_16x16x32_bf16 v[44:47], a[76:79], v[120:123], v[44:47]
    v_mfma_f32_16x16x32_bf16 v[32:35], a[80:83], v[124:127], v[32:35]
    v_mfma_f32_16x16x32_bf16 v[36:39], a[84:87], v[124:127], v[36:39]
    v_mfma_f32_16x16x32_bf16 v[40:43], a[88:91], v[124:127], v[40:43]
    v_mfma_f32_16x16x32_bf16 v[44:47], a[92:95], v[124:127], v[44:47]
    v_mov_b32 v160, 0
    v_mov_b32 v161, 0
    v_mov_b32 v162, 0
    v_mov_b32 v163, 0
    v_mov_b32 v164, 0
    v_mov_b32 v165, 0
    v_mov_b32 v166, 0
    v_mov_b32 v167, 0
    v_mov_b32 v168, 0
    v_mov_b32 v169, 0
    v_mov_b32 v170, 0
    v_mov_b32 v171, 0
    v_mov_b32 v172, 0
    v_mov_b32 v173, 0
    v_mov_b32 v174, 0
    v_mov_b32 v175, 0
    s_branch K2_z_35_ret
    s_nop 0
K2_wrap_38:
    s_bitset0_b32 s45, 31
    s_add_u32 s31, s31, 1
    s_cmp_eq_u32 s31, 4
    s_cselect_b32 s43, 0x40000000, 128
    s_add_u32 s22, s22, s43
    s_add_u32 s23, s23, s43
    s_add_u32 s24, s24, s43
    s_add_u32 s25, s25, s43
    s_branch K2_wrap_38_ret
K2_z_37:
    v_mfma_f32_16x16x32_bf16 v[48:51], a[64:67], v[128:131], v[48:51]
    v_mfma_f32_16x16x32_bf16 v[52:55], a[68:71], v[128:131], v[52:55]
    v_mfma_f32_16x16x32_bf16 v[56:59], a[72:75], v[128:131], v[56:59]
    v_mfma_f32_16x16x32_bf16 v[60:63], a[76:79], v[128:131], v[60:63]
    v_mfma_f32_16x16x32_bf16 v[48:51], a[80:83], v[132:135], v[48:51]
    v_mfma_f32_16x16x32_bf16 v[52:55], a[84:87], v[132:135], v[52:55]
    v_mfma_f32_16x16x32_bf16 v[56:59], a[88:91], v[132:135], v[56:59]
    v_mfma_f32_16x16x32_bf16 v[60:63], a[92:95], v[132:135], v[60:63]
    v_mov_b32 v176, 0
    v_mov_b32 v177, 0
    v_mov_b32 v178, 0
    v_mov_b32 v179, 0
    v_mov_b32 v180, 0
    v_mov_b32 v181, 0
    v_mov_b32 v182, 0
    v_mov_b32 v183, 0
    v_mov_b32 v184, 0
    v_mov_b32 v185, 0
    v_mov_b32 v186, 0
    v_mov_b32 v187, 0
    v_mov_b32 v188, 0
    v_mov_b32 v189, 0
    v_mov_b32 v190, 0
    v_mov_b32 v191, 0
    s_branch K2_z_37_ret
K2_wrap_40:
    s_bitset0_b32 s45, 31
    s_add_u32 s31, s31, 1
    s_cmp_eq_u32 s31, 4
    s_cselect_b32 s43, 0x40000000, 128
    s_add_u32 s22, s22, s43
    s_add_u32 s23, s23, s43
    s_add_u32 s24, s24, s43
    s_add_u32 s25, s25, s43
    s_branch K2_wrap_40_ret
    s_nop 0
K2_z_39:
    v_mfma_f32_16x16x32_bf16 v[64:67], a[64:67], v[136:139], v[64:67]
    v_mfma_f32_16x16x32_bf16 v[68:71], a[68:71], v[136:139], v[68:71]
    v_mfma_f32_16x16x32_bf16 v[72:75], a[72:75], v[136:139], v[72:75]
    v_mfma_f32_16x16x32_bf16 v[76:79], a[76:79], v[136:139], v[76:79]
    v_mfma_f32_16x16x32_bf16 v[64:67], a[80:83], v[140:143], v[64:67]
    v_mfma_f32_16x16x32_bf16 v[68:71], a[84:87], v[140:143], v[68:71]
    v_mfma_f32_16x16x32_bf16 v[72:75], a[88:91], v[140:143], v[72:75]
    v_mfma_f32_16x16x32_bf16 v[76:79], a[92:95], v[140:143], v[76:79]
    v_mov_b32 v192, 0
    v_mov_b32 v193, 0
    v_mov_b32 v194, 0
    v_mov_b32 v195, 0
    v_mov_b32 v196, 0
    v_mov_b32 v197, 0
    v_mov_b32 v198, 0
    v_mov_b32 v199, 0
    v_mov_b32 v200, 0
    v_mov_b32 v201, 0
    v_mov_b32 v202, 0
    v_mov_b32 v203, 0
    v_mov_b32 v204, 0
    v_mov_b32 v205, 0
    v_mov_b32 v206, 0
    v_mov_b32 v207, 0
    s_branch K2_z_39_ret
K2_wrap_42:
    s_bitset0_b32 s45, 31
    s_add_u32 s31, s31, 1
    s_cmp_eq_u32 s31, 4
    s_cselect_b32 s43, 0x40000000, 128
    s_add_u32 s22, s22, s43
    s_add_u32 s23, s23, s43
    s_add_u32 s24, s24, s43
    s_add_u32 s25, s25, s43
    s_branch K2_wrap_42_ret
    s_nop 0
K2_z_41:
    v_mfma_f32_16x16x32_bf16 a[160:163], a[0:3], v[112:115], a[160:163]
    v_mfma_f32_16x16x32_bf16 a[164:167], a[4:7], v[112:115], a[164:167]
    v_mfma_f32_16x16x32_bf16 a[168:171], a[8:11], v[112:115], a[168:171]
    v_mfma_f32_16x16x32_bf16 a[172:175], a[12:15], v[112:115], a[172:175]
    v_mfma_f32_16x16x32_bf16 a[160:163], a[16:19], v[116:119], a[160:163]
    v_mfma_f32_16x16x32_bf16 a[164:167], a[20:23], v[116:119], a[164:167]
    v_mfma_f32_16x16x32_bf16 a[168:171], a[24:27], v[116:119], a[168:171]
    v_mfma_f32_16x16x32_bf16 a[172:175], a[28:31], v[116:119], a[172:175]
    v_mov_b32 v208, 0
    v_mov_b32 v209, 0
    v_mov_b32 v210, 0
    v_mov_b32 v211, 0
    v_mov_b32 v212, 0
    v_mov_b32 v213, 0
    v_mov_b32 v214, 0
    v_mov_b32 v215, 0
    v_mov_b32 v216, 0
    v_mov_b32 v217, 0
    v_mov_b32 v218, 0
    v_mov_b32 v219, 0
    v_mov_b32 v220, 0
    v_mov_b32 v221, 0
    v_mov_b32 v222, 0
    v_mov_b32 v223, 0
    s_branch K2_z_41_ret
K2_wrap_44:
    s_bitset0_b32 s45, 31
    s_add_u32 s31, s31, 1
    s_cmp_eq_u32 s31, 4
    s_cselect_b32 s43, 0x40000000, 128
    s_add_u32 s22, s22, s43
    s_add_u32 s23, s23, s43
    s_add_u32 s24, s24, s43
    s_add_u32 s25, s25, s43
    s_branch K2_wrap_44_ret
    s_nop 0
K2_z_43:
    v_mfma_f32_16x16x32_bf16 a[176:179], a[64:67], v[120:123], a[176:179]
    v_mfma_f32_16x16x32_bf16 a[180:183], a[68:71], v[120:123], a[180:183]
    v_mfma_f32_16x16x32_bf16 a[184:187], a[72:75], v[120:123], a[184:187]
    v_mfma_f32_16x16x32_bf16 a[188:191], a[76:79], v[120:123], a[188:191]
    v_mfma_f32_16x16x32_bf16 a[176:179], a[80:83], v[124:127], a[176:179]
    v_mfma_f32_16x16x32_bf16 a[180:183], a[84:87], v[124:127], a[180:183]
    v_mfma_f32_16x16x32_bf16 a[184:187], a[88:91], v[124:127], a[184:187]
    v_mfma_f32_16x16x32_bf16 a[188:191], a[92:95], v[124:127], a[188:191]
    v_mov_b32 v224, 0
    v_mov_b32 v225, 0
    v_mov_b32 v226, 0
    v_mov_b32 v227, 0
    v_mov_b32 v228, 0
    v_mov_b32 v229, 0
    v_mov_b32 v230, 0
    v_mov_b32 v231, 0
    v_mov_b32 v232, 0
    v_mov_b32 v233, 0
    v_mov_b32 v234, 0
    v_mov_b32 v235, 0
    v_mov_b32 v236, 0
    v_mov_b32 v237, 0
    v_mov_b32 v238, 0
    v_mov_b32 v239, 0
    s_branch K2_z_43_ret
    s_nop 0
K2_wrap_46:
    s_bitset0_b32 s45, 31
    s_add_u32 s31, s31, 1
    s_cmp_eq_u32 s31, 4
    s_cselect_b32 s43, 0x40000000, 128
    s_add_u32 s22, s22, s43
    s_add_u32 s23, s23, s43
    s_add_u32 s24, s24, s43
    s_add_u32 s25, s25, s43
    s_branch K2_wrap_46_ret
K2_z_45:
    v_mfma_f32_16x16x32_bf16 a[192:195], a[64:67], v[128:131], a[192:195]
    v_mfma_f32_16x16x32_bf16 a[196:199], a[68:71], v[128:131], a[196:199]
    v_mfma_f32_16x16x32_bf16 a[200:203], a[72:75], v[128:131], a[200:203]
    v_mfma_f32_16x16x32_bf16 a[204:207], a[76:79], v[128:131], a[204:207]
    v_mfma_f32_16x16x32_bf16 a[192:195], a[80:83], v[132:135], a[192:195]
    v_mfma_f32_16x16x32_bf16 a[196:199], a[84:87], v[132:135], a[196:199]
    v_mfma_f32_16x16x32_bf16 a[200:203], a[88:91], v[132:135], a[200:203]
    v_mfma_f32_16x16x32_bf16 a[204:207], a[92:95], v[132:135], a[204:207]
    v_mov_b32 v240, 0
    v_mov_b32 v241, 0
    v_mov_b32 v242, 0
    v_mov_b32 v243, 0
    v_mov_b32 v244, 0
    v_mov_b32 v245, 0
    v_mov_b32 v246, 0
    v_mov_b32 v247, 0
    v_mov_b32 v248, 0
    v_mov_b32 v249, 0
    v_mov_b32 v250, 0
    v_mov_b32 v251, 0
    v_mov_b32 v252, 0
    v_mov_b32 v253, 0
    v_mov_b32 v254, 0
    v_mov_b32 v255, 0
    s_branch K2_z_45_ret
K2_wrap_48:
    s_bitset0_b32 s45, 31
    s_add_u32 s31, s31, 1
    s_cmp_eq_u32 s31, 4
    s_cselect_b32 s43, 0x40000000, 128
    s_add_u32 s22, s22, s43
    s_add_u32 s23, s23, s43
    s_add_u32 s24, s24, s43
    s_add_u32 s25, s25, s43
    s_branch K2_wrap_48_ret
    s_nop 0
K2_z_47:
    v_mfma_f32_16x16x32_bf16 v[32:35], a[96:99], v[112:115], v[32:35]
    v_mfma_f32_16x16x32_bf16 v[36:39], a[100:103], v[112:115], v[36:39]
    v_mfma_f32_16x16x32_bf16 v[40:43], a[104:107], v[112:115], v[40:43]
    v_mfma_f32_16x16x32_bf16 v[44:47], a[108:111], v[112:115], v[44:47]
    v_mfma_f32_16x16x32_bf16 v[32:35], a[112:115], v[116:119], v[32:35]
    v_mfma_f32_16x16x32_bf16 v[36:39], a[116:119], v[116:119], v[36:39]
    v_mfma_f32_16x16x32_bf16 v[40:43], a[120:123], v[116:119], v[40:43]
    v_mfma_f32_16x16x32_bf16 v[44:47], a[124:127], v[116:119], v[44:47]
    v_mov_b32 v144, 0
    v_mov_b32 v145, 0
    v_mov_b32 v146, 0
    v_mov_b32 v147, 0
    v_mov_b32 v148, 0
    v_mov_b32 v149, 0
    v_mov_b32 v150, 0
    v_mov_b32 v151, 0
    v_mov_b32 v152, 0
    v_mov_b32 v153, 0
    v_mov_b32 v154, 0
    v_mov_b32 v155, 0
    v_mov_b32 v156, 0
    v_mov_b32 v157, 0
    v_mov_b32 v158, 0
    v_mov_b32 v159, 0
    s_branch K2_z_47_ret
K2_wrap_50:
    s_bitset0_b32 s45, 31
    s_add_u32 s31, s31, 1
    s_cmp_eq_u32 s31, 4
    s_cselect_b32 s43, 0x40000000, 128
    s_add_u32 s22, s22, s43
    s_add_u32 s23, s23, s43
    s_add_u32 s24, s24, s43
    s_add_u32 s25, s25, s43
    s_branch K2_wrap_50_ret
    s_nop 0
K2_z_49:
    v_mfma_f32_16x16x32_bf16 v[16:19], a[32:35], v[120:123], v[16:19]
    v_mfma_f32_16x16x32_bf16 v[20:23], a[36:39], v[120:123], v[20:23]
    v_mfma_f32_16x16x32_bf16 v[24:27], a[40:43], v[120:123], v[24:27]
    v_mfma_f32_16x16x32_bf16 v[28:31], a[44:47], v[120:123], v[28:31]
    v_mfma_f32_16x16x32_bf16 v[16:19], a[48:51], v[124:127], v[16:19]
    v_mfma_f32_16x16x32_bf16 v[20:23], a[52:55], v[124:127], v[20:23]
    v_mfma_f32_16x16x32_bf16 v[24:27], a[56:59], v[124:127], v[24:27]
    v_mfma_f32_16x16x32_bf16 v[28:31], a[60:63], v[124:127], v[28:31]
    v_mov_b32 v160, 0
    v_mov_b32 v161, 0
    v_mov_b32 v162, 0
    v_mov_b32 v163, 0
    v_mov_b32 v164, 0
    v_mov_b32 v165, 0
    v_mov_b32 v166, 0
    v_mov_b32 v167, 0
    v_mov_b32 v168, 0
    v_mov_b32 v169, 0
    v_mov_b32 v170, 0
    v_mov_b32 v171, 0
    v_mov_b32 v172, 0
    v_mov_b32 v173, 0
    v_mov_b32 v174, 0
    v_mov_b32 v175, 0
    s_branch K2_z_49_ret
K2_wrap_52:
    s_bitset0_b32 s45, 31
    s_add_u32 s31, s31, 1
    s_cmp_eq_u32 s31, 4
    s_cselect_b32 s43, 0x40000000, 128
    s_add_u32 s22, s22, s43
    s_add_u32 s23, s23, s43
    s_add_u32 s24, s24, s43
    s_add_u32 s25, s25, s43
    s_branch K2_wrap_52_ret
    s_nop 0
K2_z_51:
    v_mfma_f32_16x16x32_bf16 v[64:67], a[128:131], v[128:131], v[64:67]
    v_mfma_f32_16x16x32_bf16 v[68:71], a[132:135], v[128:131], v[68:71]
    v_mfma_f32_16x16x32_bf16 v[72:75], a[136:139], v[128:131], v[72:75]
    v_mfma_f32_16x16x32_bf16 v[76:79], a[140:143], v[128:131], v[76:79]
    v_mfma_f32_16x16x32_bf16 v[64:67], a[144:147], v[132:135], v[64:67]
    v_mfma_f32_16x16x32_bf16 v[68:71], a[148:151], v[132:135], v[68:71]
    v_mfma_f32_16x16x32_bf16 v[72:75], a[152:155], v[132:135], v[72:75]
    v_mfma_f32_16x16x32_bf16 v[76:79], a[156:159], v[132:135], v[76:79]
    v_mov_b32 v176, 0
    v_mov_b32 v177, 0
    v_mov_b32 v178, 0
    v_mov_b32 v179, 0
    v_mov_b32 v180, 0
    v_mov_b32 v181, 0
    v_mov_b32 v182, 0
    v_mov_b32 v183, 0
    v_mov_b32 v184, 0
    v_mov_b32 v185, 0
    v_mov_b32 v186, 0
    v_mov_b32 v187, 0
    v_mov_b32 v188, 0
    v_mov_b32 v189, 0
    v_mov_b32 v190, 0
    v_mov_b32 v191, 0
    s_branch K2_z_51_ret
    s_nop 0
K2_wrap_54:
    s_bitset0_b32 s45, 31
    s_add_u32 s31, s31, 1
    s_cmp_eq_u32 s31, 4
    s_cselect_b32 s43, 0x40000000, 128
    s_add_u32 s22, s22, s43
    s_add_u32 s23, s23, s43
    s_add_u32 s24, s24, s43
    s_add_u32 s25, s25, s43
    s_branch K2_wrap_54_ret
K2_z_53:
    v_mfma_f32_16x16x32_bf16 v[48:51], a[128:131], v[136:139], v[48:51]
    v_mfma_f32_16x16x32_bf16 v[52:55], a[132:135], v[136:139], v[52:55]
    v_mfma_f32_16x16x32_bf16 v[56:59], a[136:139], v[136:139], v[56:59]
    v_mfma_f32_16x16x32_bf16 v[60:63], a[140:143], v[136:139], v[60:63]
    v_mfma_f32_16x16x32_bf16 v[48:51], a[144:147], v[140:143], v[48:51]
    v_mfma_f32_16x16x32_bf16 v[52:55], a[148:151], v[140:143], v[52:55]
    v_mfma_f32_16x16x32_bf16 v[56:59], a[152:155], v[140:143], v[56:59]
    v_mfma_f32_16x16x32_bf16 v[60:63], a[156:159], v[140:143], v[60:63]
    v_mov_b32 v192, 0
    v_mov_b32 v193, 0
    v_mov_b32 v194, 0
    v_mov_b32 v195, 0
    v_mov_b32 v196, 0
    v_mov_b32 v197, 0
    v_mov_b32 v198, 0
    v_mov_b32 v199, 0
    v_mov_b32 v200, 0
    v_mov_b32 v201, 0
    v_mov_b32 v202, 0
    v_mov_b32 v203, 0
    v_mov_b32 v204, 0
    v_mov_b32 v205, 0
    v_mov_b32 v206, 0
    v_mov_b32 v207, 0
    s_branch K2_z_53_ret
K2_wrap_56:
    s_bitset0_b32 s45, 31
    s_add_u32 s31, s31, 1
    s_cmp_eq_u32 s31, 4
    s_cselect_b32 s43, 0x40000000, 128
    s_add_u32 s22, s22, s43
    s_add_u32 s23, s23, s43
    s_add_u32 s24, s24, s43
    s_add_u32 s25, s25, s43
    s_branch K2_wrap_56_ret
    s_nop 0
K2_z_55:
    v_mfma_f32_16x16x32_bf16 a[176:179], a[96:99], v[112:115], a[176:179]
    v_mfma_f32_16x16x32_bf16 a[180:183], a[100:103], v[112:115], a[180:183]
    v_mfma_f32_16x16x32_bf16 a[184:187], a[104:107], v[112:115], a[184:187]
    v_mfma_f32_16x16x32_bf16 a[188:191], a[108:111], v[112:115], a[188:191]
    v_mfma_f32_16x16x32_bf16 a[176:179], a[112:115], v[116:119], a[176:179]
    v_mfma_f32_16x16x32_bf16 a[180:183], a[116:119], v[116:119], a[180:183]
    v_mfma_f32_16x16x32_bf16 a[184:187], a[120:123], v[116:119], a[184:187]
    v_mfma_f32_16x16x32_bf16 a[188:191], a[124:127], v[116:119], a[188:191]
    v_mov_b32 v208, 0
    v_mov_b32 v209, 0
    v_mov_b32 v210, 0
    v_mov_b32 v211, 0
    v_mov_b32 v212, 0
    v_mov_b32 v213, 0
    v_mov_b32 v214, 0
    v_mov_b32 v215, 0
    v_mov_b32 v216, 0
    v_mov_b32 v217, 0
    v_mov_b32 v218, 0
    v_mov_b32 v219, 0
    v_mov_b32 v220, 0
    v_mov_b32 v221, 0
    v_mov_b32 v222, 0
    v_mov_b32 v223, 0
    s_branch K2_z_55_ret
K2_wrap_58:
    s_bitset0_b32 s45, 31
    s_add_u32 s31, s31, 1
    s_cmp_eq_u32 s31, 4
    s_cselect_b32 s43, 0x40000000, 128
    s_add_u32 s22, s22, s43
    s_add_u32 s23, s23, s43
    s_add_u32 s24, s24, s43
    s_add_u32 s25, s25, s43
    s_branch K2_wrap_58_ret
    s_nop 0
K2_z_57:
    v_mfma_f32_16x16x32_bf16 a[160:163], a[32:35], v[120:123], a[160:163]
    v_mfma_f32_16x16x32_bf16 a[164:167], a[36:39], v[120:123], a[164:167]
    v_mfma_f32_16x16x32_bf16 a[168:171], a[40:43], v[120:123], a[168:171]
    v_mfma_f32_16x16x32_bf16 a[172:175], a[44:47], v[120:123], a[172:175]
    v_mfma_f32_16x16x32_bf16 a[160:163], a[48:51], v[124:127], a[160:163]
    v_mfma_f32_16x16x32_bf16 a[164:167], a[52:55], v[124:127], a[164:167]
    v_mfma_f32_16x16x32_bf16 a[168:171], a[56:59], v[124:127], a[168:171]
    v_mfma_f32_16x16x32_bf16 a[172:175], a[60:63], v[124:127], a[172:175]
    v_mov_b32 v224, 0
    v_mov_b32 v225, 0
    v_mov_b32 v226, 0
    v_mov_b32 v227, 0
    v_mov_b32 v228, 0
    v_mov_b32 v229, 0
    v_mov_b32 v230, 0
    v_mov_b32 v231, 0
    v_mov_b32 v232, 0
    v_mov_b32 v233, 0
    v_mov_b32 v234, 0
    v_mov_b32 v235, 0
    v_mov_b32 v236, 0
    v_mov_b32 v237, 0
    v_mov_b32 v238, 0
    v_mov_b32 v239, 0
    s_branch K2_z_57_ret
K2_wrap_60:
    s_bitset0_b32 s45, 31
    s_add_u32 s31, s31, 1
    s_cmp_eq_u32 s31, 4
    s_cselect_b32 s43, 0x40000000, 128
    s_add_u32 s22, s22, s43
    s_add_u32 s23, s23, s43
    s_add_u32 s24, s24, s43
    s_add_u32 s25, s25, s43
    s_branch K2_wrap_60_ret
    s_nop 0
K2_z_59:
    v_mfma_f32_16x16x32_bf16 a[208:211], a[128:131], v[128:131], a[208:211]
    v_mfma_f32_16x16x32_bf16 a[212:215], a[132:135], v[128:131], a[212:215]
    v_mfma_f32_16x16x32_bf16 a[216:219], a[136:139], v[128:131], a[216:219]
    v_mfma_f32_16x16x32_bf16 a[220:223], a[140:143], v[128:131], a[220:223]
    v_mfma_f32_16x16x32_bf16 a[208:211], a[144:147], v[132:135], a[208:211]
    v_mfma_f32_16x16x32_bf16 a[212:215], a[148:151], v[132:135], a[212:215]
    v_mfma_f32_16x16x32_bf16 a[216:219], a[152:155], v[132:135], a[216:219]
    v_mfma_f32_16x16x32_bf16 a[220:223], a[156:159], v[132:135], a[220:223]
    v_mov_b32 v240, 0
    v_mov_b32 v241, 0
    v_mov_b32 v242, 0
    v_mov_b32 v243, 0
    v_mov_b32 v244, 0
    v_mov_b32 v245, 0
    v_mov_b32 v246, 0
    v_mov_b32 v247, 0
    v_mov_b32 v248, 0
    v_mov_b32 v249, 0
    v_mov_b32 v250, 0
    v_mov_b32 v251, 0
    v_mov_b32 v252, 0
    v_mov_b32 v253, 0
    v_mov_b32 v254, 0
    v_mov_b32 v255, 0
    s_branch K2_z_59_ret
    s_nop 0
K2_wrap_62:
    s_bitset0_b32 s45, 31
    s_add_u32 s31, s31, 1
    s_cmp_eq_u32 s31, 4
    s_cselect_b32 s43, 0x40000000, 128
    s_add_u32 s22, s22, s43
    s_add_u32 s23, s23, s43
    s_add_u32 s24, s24, s43
    s_add_u32 s25, s25, s43
    s_branch K2_wrap_62_ret
K2_z_61:
    v_mfma_f32_16x16x32_bf16 v[48:51], a[96:99], v[112:115], v[48:51]
    v_mfma_f32_16x16x32_bf16 v[52:55], a[100:103], v[112:115], v[52:55]
    v_mfma_f32_16x16x32_bf16 v[56:59], a[104:107], v[112:115], v[56:59]
    v_mfma_f32_16x16x32_bf16 v[60:63], a[108:111], v[112:115], v[60:63]
    v_mfma_f32_16x16x32_bf16 v[48:51], a[112:115], v[116:119], v[48:51]
    v_mfma_f32_16x16x32_bf16 v[52:55], a[116:119], v[116:119], v[52:55]
    v_mfma_f32_16x16x32_bf16 v[56:59], a[120:123], v[116:119], v[56:59]
    v_mfma_f32_16x16x32_bf16 v[60:63], a[124:127], v[116:119], v[60:63]
    v_mov_b32 v144, 0
    v_mov_b32 v145, 0
    v_mov_b32 v146, 0
    v_mov_b32 v147, 0
    v_mov_b32 v148, 0
    v_mov_b32 v149, 0
    v_mov_b32 v150, 0
    v_mov_b32 v151, 0
    v_mov_b32 v152, 0
    v_mov_b32 v153, 0
    v_mov_b32 v154, 0
    v_mov_b32 v155, 0
    v_mov_b32 v156, 0
    v_mov_b32 v157, 0
    v_mov_b32 v158, 0
    v_mov_b32 v159, 0
    s_branch K2_z_61_ret
K2_wrap_64:
    s_bitset0_b32 s45, 31
    s_add_u32 s31, s31, 1
    s_cmp_eq_u32 s31, 4
    s_cselect_b32 s43, 0x40000000, 128
    s_add_u32 s22, s22, s43
    s_add_u32 s23, s23, s43
    s_add_u32 s24, s24, s43
    s_add_u32 s25, s25, s43
    s_branch K2_wrap_64_ret
    s_nop 0
K2_z_63:
    v_mfma_f32_16x16x32_bf16 v[64:67], a[128:131], v[120:123], v[64:67]
    v_mfma_f32_16x16x32_bf16 v[68:71], a[132:135], v[120:123], v[68:71]
    v_mfma_f32_16x16x32_bf16 v[72:75], a[136:139], v[120:123], v[72:75]
    v_mfma_f32_16x16x32_bf16 v[76:79], a[140:143], v[120:123], v[76:79]
    v_mfma_f32_16x16x32_bf16 v[64:67], a[144:147], v[124:127], v[64:67]
    v_mfma_f32_16x16x32_bf16 v[68:71], a[148:151], v[124:127], v[68:71]
    v_mfma_f32_16x16x32_bf16 v[72:75], a[152:155], v[124:127], v[72:75]
    v_mfma_f32_16x16x32_bf16 v[76:79], a[156:159], v[124:127], v[76:79]
    v_mov_b32 v160, 0
    v_mov_b32 v161, 0
    v_mov_b32 v162, 0
    v_mov_b32 v163, 0
    v_mov_b32 v164, 0
    v_mov_b32 v165, 0
    v_mov_b32 v166, 0
    v_mov_b32 v167, 0
    v_mov_b32 v168, 0
    v_mov_b32 v169, 0
    v_mov_b32 v170, 0
    v_mov_b32 v171, 0
    v_mov_b32 v172, 0
    v_mov_b32 v173, 0
    v_mov_b32 v174, 0
    v_mov_b32 v175, 0
    s_branch K2_z_63_ret
K2_wrap_66:
    s_bitset0_b32 s45, 31
    s_add_u32 s31, s31, 1
    s_cmp_eq_u32 s31, 4
    s_cselect_b32 s43, 0x40000000, 128
    s_add_u32 s22, s22, s43
    s_add_u32 s23, s23, s43
    s_add_u32 s24, s24, s43
    s_add_u32 s25, s25, s43
    s_branch K2_wrap_66_ret
    s_nop 0
K2_z_65:
    v_mfma_f32_16x16x32_bf16 v[16:19], a[32:35], v[128:131], v[16:19]
    v_mfma_f32_16x16x32_bf16 v[20:23], a[36:39], v[128:131], v[20:23]
    v_mfma_f32_16x16x32_bf16 v[24:27], a[40:43], v[128:131], v[24:27]
    v_mfma_f32_16x16x32_bf16 v[28:31], a[44:47], v[128:131], v[28:31]
    v_mfma_f32_16x16x32_bf16 v[16:19], a[48:51], v[132:135], v[16:19]
    v_mfma_f32_16x16x32_bf16 v[20:23], a[52:55], v[132:135], v[20:23]
    v_mfma_f32_16x16x32_bf16 v[24:27], a[56:59], v[132:135], v[24:27]
    v_mfma_f32_16x16x32_bf16 v[28:31], a[60:63], v[132:135], v[28:31]
    v_mov_b32 v176, 0
    v_mov_b32 v177, 0
    v_mov_b32 v178, 0
    v_mov_b32 v179, 0
    v_mov_b32 v180, 0
    v_mov_b32 v181, 0
    v_mov_b32 v182, 0
    v_mov_b32 v183, 0
    v_mov_b32 v184, 0
    v_mov_b32 v185, 0
    v_mov_b32 v186, 0
    v_mov_b32 v187, 0
    v_mov_b32 v188, 0
    v_mov_b32 v189, 0
    v_mov_b32 v190, 0
    v_mov_b32 v191, 0
    s_branch K2_z_65_ret
K2_wrap_68:
    s_bitset0_b32 s45, 31
    s_add_u32 s31, s31, 1
    s_cmp_eq_u32 s31, 4
    s_cselect_b32 s43, 0x40000000, 128
    s_add_u32 s22, s22, s43
    s_add_u32 s23, s23, s43
    s_add_u32 s24, s24, s43
    s_add_u32 s25, s25, s43
    s_branch K2_wrap_68_ret
    s_nop 0
K2_z_67:
    v_mfma_f32_16x16x32_bf16 v[32:35], a[128:131], v[136:139], v[32:35]
    v_mfma_f32_16x16x32_bf16 v[36:39], a[132:135], v[136:139], v[36:39]
    v_mfma_f32_16x16x32_bf16 v[40:43], a[136:139], v[136:139], v[40:43]
    v_mfma_f32_16x16x32_bf16 v[44:47], a[140:143], v[136:139], v[44:47]
    v_mfma_f32_16x16x32_bf16 v[32:35], a[144:147], v[140:143], v[32:35]
    v_mfma_f32_16x16x32_bf16 v[36:39], a[148:151], v[140:143], v[36:39]
    v_mfma_f32_16x16x32_bf16 v[40:43], a[152:155], v[140:143], v[40:43]
    v_mfma_f32_16x16x32_bf16 v[44:47], a[156:159], v[140:143], v[44:47]
    v_mov_b32 v192, 0
    v_mov_b32 v193, 0
    v_mov_b32 v194, 0
    v_mov_b32 v195, 0
    v_mov_b32 v196, 0
    v_mov_b32 v197, 0
    v_mov_b32 v198, 0
    v_mov_b32 v199, 0
    v_mov_b32 v200, 0
    v_mov_b32 v201, 0
    v_mov_b32 v202, 0
    v_mov_b32 v203, 0
    v_mov_b32 v204, 0
    v_mov_b32 v205, 0
    v_mov_b32 v206, 0
    v_mov_b32 v207, 0
    s_branch K2_z_67_ret
    s_nop 0
K2_wrap_70:
    s_bitset0_b32 s45, 31
    s_add_u32 s31, s31, 1
    s_cmp_eq_u32 s31, 4
    s_cselect_b32 s43, 0x40000000, 128
    s_add_u32 s22, s22, s43
    s_add_u32 s23, s23, s43
    s_add_u32 s24, s24, s43
    s_add_u32 s25, s25, s43
    s_branch K2_wrap_70_ret
K2_z_69:
    v_mfma_f32_16x16x32_bf16 a[192:195], a[96:99], v[112:115], a[192:195]
    v_mfma_f32_16x16x32_bf16 a[196:199], a[100:103], v[112:115], a[196:199]
    v_mfma_f32_16x16x32_bf16 a[200:203], a[104:107], v[112:115], a[200:203]
    v_mfma_f32_16x16x32_bf16 a[204:207], a[108:111], v[112:115], a[204:207]
    v_mfma_f32_16x16x32_bf16 a[192:195], a[112:115], v[116:119], a[192:195]
    v_mfma_f32_16x16x32_bf16 a[196:199], a[116:119], v[116:119], a[196:199]
    v_mfma_f32_16x16x32_bf16 a[200:203], a[120:123], v[116:119], a[200:203]
    v_mfma_f32_16x16x32_bf16 a[204:207], a[124:127], v[116:119], a[204:207]
    v_mov_b32 v208, 0
    v_mov_b32 v209, 0
    v_mov_b32 v210, 0
    v_mov_b32 v211, 0
    v_mov_b32 v212, 0
    v_mov_b32 v213, 0
    v_mov_b32 v214, 0
    v_mov_b32 v215, 0
    v_mov_b32 v216, 0
    v_mov_b32 v217, 0
    v_mov_b32 v218, 0
    v_mov_b32 v219, 0
    v_mov_b32 v220, 0
    v_mov_b32 v221, 0
    v_mov_b32 v222, 0
    v_mov_b32 v223, 0
    s_branch K2_z_69_ret
K2_wrap_72:
    s_bitset0_b32 s45, 31
    s_add_u32 s31, s31, 1
    s_cmp_eq_u32 s31, 4
    s_cselect_b32 s43, 0x40000000, 128
    s_add_u32 s22, s22, s43
    s_add_u32 s23, s23, s43
    s_add_u32 s24, s24, s43
    s_add_u32 s25, s25, s43
    s_branch K2_wrap_72_ret
    s_nop 0
K2_z_71:
    v_mfma_f32_16x16x32_bf16 a[208:211], a[128:131], v[120:123], a[208:211]
    v_mfma_f32_16x16x32_bf16 a[212:215], a[132:135], v[120:123], a[212:215]
    v_mfma_f32_16x16x32_bf16 a[216:219], a[136:139], v[120:123], a[216:219]
    v_mfma_f32_16x16x32_bf16 a[220:223], a[140:143], v[120:123], a[220:223]
    v_mfma_f32_16x16x32_bf16 a[208:211], a[144:147], v[124:127], a[208:211]
    v_mfma_f32_16x16x32_bf16 a[212:215], a[148:151], v[124:127], a[212:215]
    v_mfma_f32_16x16x32_bf16 a[216:219], a[152:155], v[124:127], a[216:219]
    v_mfma_f32_16x16x32_bf16 a[220:223], a[156:159], v[124:127], a[220:223]
    v_mov_b32 v224, 0
    v_mov_b32 v225, 0
    v_mov_b32 v226, 0
    v_mov_b32 v227, 0
    v_mov_b32 v228, 0
    v_mov_b32 v229, 0
    v_mov_b32 v230, 0
    v_mov_b32 v231, 0
    v_mov_b32 v232, 0
    v_mov_b32 v233, 0
    v_mov_b32 v234, 0
    v_mov_b32 v235, 0
    v_mov_b32 v236, 0
    v_mov_b32 v237, 0
    v_mov_b32 v238, 0
    v_mov_b32 v239, 0
    s_branch K2_z_71_ret
K2_wrap_74:
    s_bitset0_b32 s45, 31
    s_add_u32 s31, s31, 1
    s_cmp_eq_u32 s31, 4
    s_cselect_b32 s43, 0x40000000, 128
    s_add_u32 s22, s22, s43
    s_add_u32 s23, s23, s43
    s_add_u32 s24, s24, s43
    s_add_u32 s25, s25, s43
    s_branch K2_wrap_74_ret
    s_nop 0
K2_z_73:
    v_mfma_f32_16x16x32_bf16 a[160:163], a[32:35], v[128:131], a[160:163]
    v_mfma_f32_16x16x32_bf16 a[164:167], a[36:39], v[128:131], a[164:167]
    v_mfma_f32_16x16x32_bf16 a[168:171], a[40:43], v[128:131], a[168:171]
    v_mfma_f32_16x16x32_bf16 a[172:175], a[44:47], v[128:131], a[172:175]
    v_mfma_f32_16x16x32_bf16 a[160:163], a[48:51], v[132:135], a[160:163]
    v_mfma_f32_16x16x32_bf16 a[164:167], a[52:55], v[132:135], a[164:167]
    v_mfma_f32_16x16x32_bf16 a[168:171], a[56:59], v[132:135], a[168:171]
    v_mfma_f32_16x16x32_bf16 a[172:175], a[60:63], v[132:135], a[172:175]
    v_mov_b32 v240, 0
    v_mov_b32 v241, 0
    v_mov_b32 v242, 0
    v_mov_b32 v243, 0
    v_mov_b32 v244, 0
    v_mov_b32 v245, 0
    v_mov_b32 v246, 0
    v_mov_b32 v247, 0
    v_mov_b32 v248, 0
    v_mov_b32 v249, 0
    v_mov_b32 v250, 0
    v_mov_b32 v251, 0
    v_mov_b32 v252, 0
    v_mov_b32 v253, 0
    v_mov_b32 v254, 0
    v_mov_b32 v255, 0
    s_branch K2_z_73_ret
.section .rodata,"a"
.p2align 6
.amdhsa_kernel gather_scatter__tensor_product_equiv_equiformer__graph_kernel
.amdhsa_next_free_vgpr 512
.amdhsa_next_free_sgpr 102
.amdhsa_accum_offset 256
.amdhsa_group_segment_fixed_size 0
.amdhsa_kernarg_size 96
.amdhsa_user_sgpr_count 2
.amdhsa_user_sgpr_kernarg_segment_ptr 1
.amdhsa_system_sgpr_workgroup_id_x 1
.amdhsa_float_denorm_mode_32 3
.end_amdhsa_kernel
```
